```python
import torch

def _softmax(x, axis=-1):
    return torch.softmax(x, dim=axis)
def _gelu(x):
    return torch.nn.functional.gelu(x, approximate="tanh")
def _silu(x):
    return torch.nn.functional.silu(x)
def _sigmoid(x):
    return torch.sigmoid(x)
def _layernorm(x, axis=-1, eps=1e-5):
    m = x.mean(dim=axis, keepdim=True)
    v = x.var(dim=axis, keepdim=True, unbiased=False)
    return (x - m) / torch.sqrt(v + eps)
def _scatter_add(tgt, idx, src, axis=0):
    return tgt.clone().index_add_(axis, idx, src)
def _segment_sum(src, seg, n):
    out = torch.zeros((n,) + src.shape[1:], dtype=src.dtype)
    return out.index_add_(0, seg, src)
def _pad(x, pw):
    flat = tuple(v for pair in reversed(pw) for v in pair)
    return torch.nn.functional.pad(x, flat)

kernel_name = 'standalone__mha_block_cached__near_ridge'

def setup_inputs():

    _w = (lambda a: (lambda t: t.to(torch.bfloat16) if t.is_floating_point() else t)(torch.as_tensor(a)))
    B, Sq, D = 8, 256, 448
    H, Sk, Dh = 16, 1024, 256
    return {
        "x": _w((lambda *s: torch.randn(*s, dtype=torch.bfloat16) * 0.8)(B, Sq, D)),
        "k_cache": _w((lambda *s: torch.randn(*s, dtype=torch.bfloat16) * 0.8)(B, H, Sk, Dh)),
        "v_cache": _w((lambda *s: torch.randn(*s, dtype=torch.bfloat16) * 0.05)(B, H, Sk, Dh)),
        "wq": _w((lambda *s: torch.randn(*s, dtype=torch.bfloat16) * 0.8)(D, H * Dh) * (D ** -0.5)),
        "wo": _w((lambda *s: torch.randn(*s, dtype=torch.bfloat16) * 0.05)(H * Dh, D) * ((H * Dh) ** -0.5)),
    }

def reference(x, k_cache, v_cache, wq, wo):
    B, Sq, D = x.shape
    H, Dh = 16, 256
    q = (lambda x, *d: x.permute(*d))((x @ wq).reshape(B, Sq, H, Dh), 0, 2, 1, 3)
    scores = torch.einsum("bhqd,bhkd->bhqk", q, k_cache) * (Dh ** -0.5)
    p = _softmax(scores, axis=-1)
    o = torch.einsum("bhqk,bhkd->bhqd", p, v_cache)
    return (lambda x, *d: x.permute(*d))(o, 0, 2, 1, 3).reshape(B, Sq, H * Dh) @ wo
```

```asm
; @launch grid=(256,1,1) block=(256,1,1) lds=163840
.amdgcn_target "amdgcn-amd-amdhsa--gfx950"
.text
.globl standalone__mha_block_cached__near_ridge_kernel
.p2align 8
.type standalone__mha_block_cached__near_ridge_kernel,@function
standalone__mha_block_cached__near_ridge_kernel:
	s_cmp_ge_u32 s2, 0x100
	s_cbranch_scc1 L_exit
	s_load_dwordx16 s[4:19], s[0:1], 0
	s_getpc_b64 s[62:63]
L_pc0:
	s_lshr_b32 s52, s2, 3
	s_mul_i32 s53, s52, 43
	s_lshr_b32 s53, s53, 8
	s_mul_i32 s53, s53, 6
	s_sub_u32 s52, s52, s53
	s_lshl_b32 s52, s52, 13
	v_lshl_add_u32 v105, v0, 5, s52
	v_min_u32 v106, L_code_end-L_pc0-4, v105
	global_load_dword v10, v106, s[62:63]
	v_lshrrev_b32 v107, 6, v0
	v_and_b32 v1, 63, v0
	v_readfirstlane_b32 s44, v107
	s_and_b32 s52, s2, 7
	s_bfe_u32 s56, s2, 0x30004
	s_lshr_b32 s53, s2, 7
	s_lshl_b32 s57, s52, 1
	s_add_u32 s57, s57, s53
	v_lshrrev_b32 v100, 5, v1
	v_and_b32 v101, 31, v1
	v_lshrrev_b32 v109, 3, v1
	v_lshrrev_b32 v104, 4, v1
	s_lshl_b32 s45, s44, 12
	v_lshl_add_u32 v105, v107, 5, v109
	v_mul_u32_u24 v105, 0x380, v105
	v_and_b32 v103, 7, v1
	v_xor_b32 v106, v103, v104
	v_lshl_add_u32 v68, v106, 4, v105
	v_add_u32 v70, 0x3000, v68
	v_xor_b32 v106, 4, v106
	v_lshl_add_u32 v69, v106, 4, v105
	v_add_u32 v69, 0x1800, v69
	v_add_u32 v71, 0x3000, v69
	v_lshl_add_u32 v105, v107, 3, v100
	v_and_b32 v110, 1, v107
	v_lshl_add_u32 v110, v110, 2, v100
	v_lshlrev_b32 v110, 1, v110
	v_xor_b32 v110, v110, v101
	v_lshlrev_b32 v106, 4, v110
	v_lshl_add_u32 v64, v105, 13, v106
	v_add_u32 v66, 0x7800, v64
	v_xor_b32 v110, 4, v110
	v_lshlrev_b32 v106, 4, v110
	v_lshl_add_u32 v65, v105, 13, v106
	v_add_u32 v65, 0x3c00, v65
	v_add_u32 v67, 0x7800, v65
	s_add_u32 s52, s52, s56
	s_cmp_ge_u32 s52, 7
	s_cselect_b32 s51, 7, 0
	s_sub_u32 s52, s52, s51
	s_cmp_ge_u32 s52, 7
	s_cselect_b32 s51, 7, 0
	s_sub_u32 s52, s52, s51
	s_sub_u32 s51, 5, s52
	s_cselect_b32 s50, 7, 0
	s_add_u32 s51, s51, s50
	s_mov_b32 s54, 0x60123456
	s_mov_b32 s55, 0x56012345
	s_cmp_eq_u32 s53, 0
	s_cselect_b32 s54, 0x06543210, s54
	s_cselect_b32 s55, 0x10654321, s55
	s_cselect_b32 s52, s52, s51
	s_lshl_b32 s52, s52, 2
	s_lshr_b64 s[54:55], s[54:55], s52
	s_bfe_u32 s59, s2, 0x40003
	s_mul_i32 s50, s59, 0x1c000
	s_lshl_b32 s52, s57, 9
	s_mov_b32 s22, 0x1c000
	s_mov_b32 s23, 0x20000
	s_sub_u32 s34, 0x380000, s52
	s_mov_b32 s35, 0x20000
	s_waitcnt lgkmcnt(0)
	s_add_u32 s20, s4, s50
	s_addc_u32 s21, s5, 0
	s_add_u32 s32, s10, s52
	s_addc_u32 s33, s11, 0
	s_add_u32 m0, s45, 0xc000
	s_bfe_u32 s52, s54, 0x30000
	s_lshl_b32 s52, s52, 7
	buffer_load_dwordx4 v68, s[20:23], s52 offen offset:0 lds
	buffer_load_dwordx4 v69, s[20:23], s52 offen offset:1024 lds
	buffer_load_dwordx4 v70, s[20:23], s52 offen offset:2048 lds
	buffer_load_dwordx4 v71, s[20:23], s52 offen offset:3072 lds
	s_add_u32 m0, s45, 0x18000
	s_bfe_u32 s52, s54, 0x30000
	s_lshl_b32 s52, s52, 19
	buffer_load_dwordx4 v64, s[32:35], s52 offen offset:0 lds
	buffer_load_dwordx4 v65, s[32:35], s52 offen offset:1024 lds
	buffer_load_dwordx4 v66, s[32:35], s52 offen offset:2048 lds
	buffer_load_dwordx4 v67, s[32:35], s52 offen offset:3072 lds
	s_add_u32 m0, s45, 0x1c000
	s_bfe_u32 s52, s54, 0x30000
	s_lshl_b32 s52, s52, 19
	s_add_u32 s52, s52, 0x40000
	buffer_load_dwordx4 v64, s[32:35], s52 offen offset:0 lds
	buffer_load_dwordx4 v65, s[32:35], s52 offen offset:1024 lds
	buffer_load_dwordx4 v66, s[32:35], s52 offen offset:2048 lds
	buffer_load_dwordx4 v67, s[32:35], s52 offen offset:3072 lds
	s_lshl_b32 s46, s44, 13
	s_mov_b32 s47, 0x45800000
	s_mov_b32 s48, 0x3db8aa3b
	s_mov_b32 s49, s48
	s_mul_i32 s52, s59, 0x1c0000
	s_lshl_b32 s53, s57, 10
	s_add_u32 s52, s52, s53
	s_add_u32 s40, s18, s52
	s_addc_u32 s41, s19, 0
	s_mov_b32 s42, 0x1bc400
	s_mov_b32 s43, 0x20000
	s_lshl_b32 s52, s56, 4
	s_add_u32 s52, s52, s57
	s_lshl_b32 s52, s52, 19
	s_add_u32 s24, s6, s52
	s_addc_u32 s25, s7, 0
	s_mov_b32 s26, 0x80000
	s_mov_b32 s27, 0x20000
	s_add_u32 s28, s8, s52
	s_addc_u32 s29, s9, 0
	s_mov_b32 s30, 0x80000
	s_mov_b32 s31, 0x20000
	s_mul_i32 s52, s57, 0x38000
	s_add_u32 s36, s12, s52
	s_addc_u32 s37, s13, 0
	s_mov_b32 s38, 0x38000
	s_mov_b32 s39, 0x20000
	s_lshl_b32 s52, s59, 9
	s_add_u32 s52, s52, 0x1c00000
	s_add_u32 s4, s18, s52
	s_addc_u32 s5, s19, 0
	s_mov_b32 s6, 0x200
	s_mov_b32 s7, 0x20000
	s_lshl_b32 s52, s59, 2
	s_add_u32 s52, s52, 0x80
	s_add_u32 s8, s16, s52
	s_addc_u32 s9, s17, 0
	s_mov_b32 s10, 0x4
	s_mov_b32 s11, 0x20000
	v_mov_b32 v89, 0
	v_mov_b32 v92, 1
	v_lshlrev_b32 v90, 12, v0
	v_lshlrev_b32 v105, 7, v0
	v_lshl_add_u32 v105, s57, 12, v105
	v_lshl_add_u32 v91, s57, 12, v90
	buffer_store_dword v89, v105, s[4:7], 0 offen sc1
	v_and_b32 v108, 15, v1
	v_bfe_u32 v102, v1, 2, 2
	v_and_b32 v103, 3, v1
	v_lshrrev_b32 v105, 1, v108
	v_xor_b32 v105, v105, v104
	v_lshlrev_b32 v106, 12, v107
	v_lshl_add_u32 v106, v108, 7, v106
	v_lshl_add_u32 v72, v105, 4, v106
	v_xor_b32 v73, 64, v72
	v_lshl_add_u32 v105, v104, 3, v102
	v_lshlrev_b32 v105, 9, v105
	v_lshl_add_u32 v105, v103, 3, v105
	v_add_u32 v105, 0x10000, v105
	v_and_b32 v110, 1, v104
	v_lshl_add_u32 v110, v110, 2, v102
	v_lshl_add_u32 v48, v110, 5, v105
	v_xor_b32 v49, 32, v48
	v_xor_b32 v50, 64, v48
	v_xor_b32 v51, 0x60, v48
	v_xor_b32 v52, 0x80, v48
	v_xor_b32 v53, 0xa0, v48
	v_xor_b32 v54, 0xc0, v48
	v_xor_b32 v55, 0xe0, v48
	v_add_u32 v56, 0x10000, v48
	v_add_u32 v57, 0x10000, v49
	v_add_u32 v58, 0x10000, v50
	v_add_u32 v59, 0x10000, v51
	v_add_u32 v60, 0x10000, v52
	v_add_u32 v61, 0x10000, v53
	v_add_u32 v62, 0x10000, v54
	v_add_u32 v63, 0x10000, v55
	v_lshl_add_u32 v105, v107, 3, v100
	v_and_b32 v106, 15, v105
	v_xor_b32 v106, v106, v101
	v_lshlrev_b32 v106, 4, v106
	v_lshl_add_u32 v36, v105, 9, v106
	v_xor_b32 v37, 32, v36
	v_xor_b32 v38, 64, v36
	v_xor_b32 v39, 0x60, v36
	v_lshlrev_b32 v106, 1, v100
	v_xor_b32 v106, v106, v101
	v_lshlrev_b32 v106, 4, v106
	v_lshl_add_u32 v40, v105, 9, v106
	v_xor_b32 v41, 64, v40
	v_xor_b32 v42, 0x80, v40
	v_xor_b32 v43, 0xc0, v40
	s_add_u32 m0, s45, 0x8000
	s_bfe_u32 s52, s54, 0x30004
	s_lshl_b32 s52, s52, 7
	buffer_load_dwordx4 v68, s[20:23], s52 offen offset:0 lds
	buffer_load_dwordx4 v69, s[20:23], s52 offen offset:1024 lds
	buffer_load_dwordx4 v70, s[20:23], s52 offen offset:2048 lds
	buffer_load_dwordx4 v71, s[20:23], s52 offen offset:3072 lds
	s_add_u32 m0, s45, 0x20000
	s_bfe_u32 s52, s54, 0x30004
	s_lshl_b32 s52, s52, 19
	buffer_load_dwordx4 v64, s[32:35], s52 offen offset:0 lds
	buffer_load_dwordx4 v65, s[32:35], s52 offen offset:1024 lds
	buffer_load_dwordx4 v66, s[32:35], s52 offen offset:2048 lds
	buffer_load_dwordx4 v67, s[32:35], s52 offen offset:3072 lds
	s_add_u32 m0, s45, 0x24000
	s_bfe_u32 s52, s54, 0x30004
	s_lshl_b32 s52, s52, 19
	s_add_u32 s52, s52, 0x40000
	buffer_load_dwordx4 v64, s[32:35], s52 offen offset:0 lds
	buffer_load_dwordx4 v65, s[32:35], s52 offen offset:1024 lds
	buffer_load_dwordx4 v66, s[32:35], s52 offen offset:2048 lds
	buffer_load_dwordx4 v67, s[32:35], s52 offen offset:3072 lds
	s_waitcnt vmcnt(21)
	ds_read_b128 a[64:67], v72 offset:49152
	ds_read_b128 a[68:71], v72 offset:51200
	ds_read_b128 a[72:75], v73 offset:49152
	ds_read_b128 a[76:79], v73 offset:51200
	s_waitcnt vmcnt(17)
	s_barrier
	ds_read_b64_tr_b16 a[192:193], v48 offset:32768
	ds_read_b64_tr_b16 a[194:195], v48 offset:34816
	ds_read_b64_tr_b16 a[196:197], v49 offset:32768
	ds_read_b64_tr_b16 a[198:199], v49 offset:34816
	ds_read_b64_tr_b16 a[200:201], v50 offset:32768
	ds_read_b64_tr_b16 a[202:203], v50 offset:34816
	ds_read_b64_tr_b16 a[204:205], v51 offset:32768
	ds_read_b64_tr_b16 a[206:207], v51 offset:34816
	ds_read_b64_tr_b16 a[208:209], v52 offset:32768
	ds_read_b64_tr_b16 a[210:211], v52 offset:34816
	ds_read_b64_tr_b16 a[212:213], v53 offset:32768
	ds_read_b64_tr_b16 a[214:215], v53 offset:34816
	ds_read_b64_tr_b16 a[216:217], v54 offset:32768
	ds_read_b64_tr_b16 a[218:219], v54 offset:34816
	ds_read_b64_tr_b16 a[220:221], v55 offset:32768
	ds_read_b64_tr_b16 a[222:223], v55 offset:34816
	ds_read_b64_tr_b16 a[224:225], v48 offset:33024
	ds_read_b64_tr_b16 a[226:227], v48 offset:35072
	ds_read_b64_tr_b16 a[228:229], v49 offset:33024
	ds_read_b64_tr_b16 a[230:231], v49 offset:35072
	ds_read_b64_tr_b16 a[232:233], v50 offset:33024
	ds_read_b64_tr_b16 a[234:235], v50 offset:35072
	ds_read_b64_tr_b16 a[236:237], v51 offset:33024
	ds_read_b64_tr_b16 a[238:239], v51 offset:35072
	s_waitcnt lgkmcnt(15)
	v_mfma_f32_16x16x32_bf16 v[128:131], a[192:195], a[64:67], 0
	s_add_u32 m0, s45, 0x14000
	s_bfe_u32 s52, s54, 0x30008
	s_lshl_b32 s52, s52, 19
	buffer_load_dwordx4 v64, s[32:35], s52 offen offset:0 lds
	ds_read_b64_tr_b16 a[240:241], v52 offset:33024
	v_mfma_f32_16x16x32_bf16 v[136:139], a[192:195], a[68:71], 0
	ds_read_b64_tr_b16 a[242:243], v52 offset:35072
	v_lshl_add_u32 v105, v104, 2, v102
	v_mfma_f32_16x16x32_bf16 v[132:135], a[196:199], a[64:67], 0
	buffer_load_dwordx4 v65, s[32:35], s52 offen offset:1024 lds
	ds_read_b64_tr_b16 a[244:245], v53 offset:33024
	v_mfma_f32_16x16x32_bf16 v[140:143], a[196:199], a[68:71], 0
	ds_read_b64_tr_b16 a[246:247], v53 offset:35072
	v_lshlrev_b32 v106, 9, v105
	v_mfma_f32_16x16x32_bf16 v[144:147], a[200:203], a[64:67], 0
	buffer_load_dwordx4 v66, s[32:35], s52 offen offset:2048 lds
	ds_read_b64_tr_b16 a[248:249], v54 offset:33024
	v_mfma_f32_16x16x32_bf16 v[152:155], a[200:203], a[68:71], 0
	ds_read_b64_tr_b16 a[250:251], v54 offset:35072
	v_lshl_add_u32 v106, v103, 3, v106
	v_mfma_f32_16x16x32_bf16 v[148:151], a[204:207], a[64:67], 0
	s_waitcnt vmcnt(16)
	s_barrier
	buffer_load_dwordx4 v67, s[32:35], s52 offen offset:3072 lds
	ds_read_b64_tr_b16 a[252:253], v55 offset:33024
	v_mfma_f32_16x16x32_bf16 v[156:159], a[204:207], a[68:71], 0
	ds_read_b64_tr_b16 a[254:255], v55 offset:35072
	v_add_u32 v106, 0x10000, v106
	s_waitcnt lgkmcnt(15)
	v_mfma_f32_16x16x32_bf16 v[160:163], a[208:211], a[64:67], 0
	s_add_u32 m0, s45, 0xc000
	s_bfe_u32 s52, s54, 0x30008
	s_lshl_b32 s52, s52, 7
	buffer_load_dwordx4 v68, s[20:23], s52 offen offset:0 lds
	ds_read_b64_tr_b16 a[192:193], v48 offset:49152
	v_mfma_f32_16x16x32_bf16 v[168:171], a[208:211], a[68:71], 0
	ds_read_b64_tr_b16 a[194:195], v48 offset:51200
	v_lshl_add_u32 v16, v110, 5, v106
	v_mfma_f32_16x16x32_bf16 v[164:167], a[212:215], a[64:67], 0
	buffer_load_dwordx4 v69, s[20:23], s52 offen offset:1024 lds
	ds_read_b64_tr_b16 a[196:197], v49 offset:49152
	v_mfma_f32_16x16x32_bf16 v[172:175], a[212:215], a[68:71], 0
	ds_read_b64_tr_b16 a[198:199], v49 offset:51200
	v_xor_b32 v17, 32, v16
	v_mfma_f32_16x16x32_bf16 v[176:179], a[216:219], a[64:67], 0
	buffer_load_dwordx4 v70, s[20:23], s52 offen offset:2048 lds
	ds_read_b64_tr_b16 a[200:201], v50 offset:49152
	v_mfma_f32_16x16x32_bf16 v[184:187], a[216:219], a[68:71], 0
	ds_read_b64_tr_b16 a[202:203], v50 offset:51200
	v_xor_b32 v18, 64, v16
	v_mfma_f32_16x16x32_bf16 v[180:183], a[220:223], a[64:67], 0
	buffer_load_dwordx4 v71, s[20:23], s52 offen offset:3072 lds
	ds_read_b64_tr_b16 a[204:205], v51 offset:49152
	v_mfma_f32_16x16x32_bf16 v[188:191], a[220:223], a[68:71], 0
	ds_read_b64_tr_b16 a[206:207], v51 offset:51200
	v_xor_b32 v19, 0x60, v16
	s_waitcnt lgkmcnt(12)
	v_mfma_f32_16x16x32_bf16 v[192:195], a[224:227], a[64:67], 0
	ds_read_b64_tr_b16 a[208:209], v52 offset:49152
	v_xor_b32 v20, 0x80, v16
	v_mfma_f32_16x16x32_bf16 v[200:203], a[224:227], a[68:71], 0
	ds_read_b64_tr_b16 a[210:211], v52 offset:51200
	v_xor_b32 v21, 0xa0, v16
	v_mfma_f32_16x16x32_bf16 v[196:199], a[228:231], a[64:67], 0
	ds_read_b64_tr_b16 a[212:213], v53 offset:49152
	v_xor_b32 v22, 0xc0, v16
	v_mfma_f32_16x16x32_bf16 v[204:207], a[228:231], a[68:71], 0
	ds_read_b64_tr_b16 a[214:215], v53 offset:51200
	v_xor_b32 v23, 0xe0, v16
	v_mfma_f32_16x16x32_bf16 v[208:211], a[232:235], a[64:67], 0
	ds_read_b64_tr_b16 a[216:217], v54 offset:49152
	v_lshrrev_b32 v106, 1, v110
	v_mfma_f32_16x16x32_bf16 v[216:219], a[232:235], a[68:71], 0
	ds_read_b64_tr_b16 a[218:219], v54 offset:51200
	v_lshlrev_b32 v105, 7, v105
	v_mfma_f32_16x16x32_bf16 v[212:215], a[236:239], a[64:67], 0
	ds_read_b64_tr_b16 a[220:221], v55 offset:49152
	v_lshl_add_u32 v105, v103, 3, v105
	v_mfma_f32_16x16x32_bf16 v[220:223], a[236:239], a[68:71], 0
	ds_read_b64_tr_b16 a[222:223], v55 offset:51200
	v_lshl_add_u32 v24, v106, 5, v105
	v_mfma_f32_16x16x32_bf16 v[224:227], a[240:243], a[64:67], 0
	ds_read_b64_tr_b16 a[224:225], v48 offset:49408
	v_xor_b32 v25, 32, v24
	v_mfma_f32_16x16x32_bf16 v[232:235], a[240:243], a[68:71], 0
	ds_read_b64_tr_b16 a[226:227], v48 offset:51456
	v_xor_b32 v26, 64, v24
	v_mfma_f32_16x16x32_bf16 v[228:231], a[244:247], a[64:67], 0
	ds_read_b64_tr_b16 a[228:229], v49 offset:49408
	v_xor_b32 v27, 0x60, v24
	v_mfma_f32_16x16x32_bf16 v[236:239], a[244:247], a[68:71], 0
	ds_read_b64_tr_b16 a[230:231], v49 offset:51456
	v_add_u32 v28, 0x10000, v24
	s_waitcnt lgkmcnt(12)
	v_mfma_f32_16x16x32_bf16 v[240:243], a[248:251], a[64:67], 0
	ds_read_b64_tr_b16 a[232:233], v50 offset:49408
	v_add_u32 v32, 0x20000, v24
	v_mfma_f32_16x16x32_bf16 v[248:251], a[248:251], a[68:71], 0
	ds_read_b64_tr_b16 a[234:235], v50 offset:51456
	v_add_u32 v29, 0x10000, v25
	v_mfma_f32_16x16x32_bf16 v[244:247], a[252:255], a[64:67], 0
	ds_read_b64_tr_b16 a[236:237], v51 offset:49408
	v_add_u32 v33, 0x20000, v25
	v_mfma_f32_16x16x32_bf16 v[252:255], a[252:255], a[68:71], 0
	ds_read_b64_tr_b16 a[238:239], v51 offset:51456
	v_add_u32 v30, 0x10000, v26
	v_mfma_f32_16x16x32_bf16 v[128:131], a[192:195], a[72:75], v[128:131]
	ds_read_b64_tr_b16 a[240:241], v52 offset:49408
	v_add_u32 v34, 0x20000, v26
	v_mfma_f32_16x16x32_bf16 v[136:139], a[192:195], a[76:79], v[136:139]
	ds_read_b64_tr_b16 a[242:243], v52 offset:51456
	v_add_u32 v31, 0x10000, v27
	v_mfma_f32_16x16x32_bf16 v[132:135], a[196:199], a[72:75], v[132:135]
	ds_read_b64_tr_b16 a[244:245], v53 offset:49408
	v_add_u32 v35, 0x20000, v27
	v_mfma_f32_16x16x32_bf16 v[140:143], a[196:199], a[76:79], v[140:143]
	ds_read_b64_tr_b16 a[246:247], v53 offset:51456
	v_xor_b32 v105, v104, v108
	v_mfma_f32_16x16x32_bf16 v[144:147], a[200:203], a[72:75], v[144:147]
	ds_read_b64_tr_b16 a[248:249], v54 offset:49408
	v_lshlrev_b32 v105, 4, v105
	v_mfma_f32_16x16x32_bf16 v[152:155], a[200:203], a[76:79], v[152:155]
	ds_read_b64_tr_b16 a[250:251], v54 offset:51456
	v_lshl_add_u32 v12, v108, 9, v105
	v_mfma_f32_16x16x32_bf16 v[148:151], a[204:207], a[72:75], v[148:151]
	s_waitcnt vmcnt(12)
	s_barrier
	ds_read_b64_tr_b16 a[252:253], v55 offset:49408
	v_xor_b32 v13, 64, v12
	v_mfma_f32_16x16x32_bf16 v[156:159], a[204:207], a[76:79], v[156:159]
	s_add_u32 m0, s45, 0x18000
	s_bfe_u32 s52, s54, 0x30008
	s_lshl_b32 s52, s52, 19
	s_add_u32 s52, s52, 0x40000
	ds_read_b128 a[80:83], v72 offset:32768
	buffer_load_dwordx4 v64, s[32:35], s52 offen offset:0 lds
	ds_read_b64_tr_b16 a[254:255], v55 offset:51456
	s_waitcnt lgkmcnt(12)
	v_mfma_f32_16x16x32_bf16 v[160:163], a[208:211], a[72:75], v[160:163]
	ds_read_b64_tr_b16 a[192:193], v56 offset:0
	v_xor_b32 v14, 0x80, v12
	v_mfma_f32_16x16x32_bf16 v[168:171], a[208:211], a[76:79], v[168:171]
	ds_read_b128 a[84:87], v72 offset:34816
	buffer_load_dwordx4 v65, s[32:35], s52 offen offset:1024 lds
	ds_read_b64_tr_b16 a[194:195], v56 offset:2048
	v_mfma_f32_16x16x32_bf16 v[164:167], a[212:215], a[72:75], v[164:167]
	ds_read_b64_tr_b16 a[196:197], v57 offset:0
	v_xor_b32 v15, 0xc0, v12
	v_mfma_f32_16x16x32_bf16 v[172:175], a[212:215], a[76:79], v[172:175]
	ds_read_b128 a[88:91], v73 offset:32768
	buffer_load_dwordx4 v66, s[32:35], s52 offen offset:2048 lds
	ds_read_b64_tr_b16 a[198:199], v57 offset:2048
	v_mfma_f32_16x16x32_bf16 v[176:179], a[216:219], a[72:75], v[176:179]
	ds_read_b64_tr_b16 a[200:201], v58 offset:0
	v_lshl_add_u32 v105, v107, 6, v109
	v_mfma_f32_16x16x32_bf16 v[184:187], a[216:219], a[76:79], v[184:187]
	ds_read_b128 a[92:95], v73 offset:34816
	buffer_load_dwordx4 v67, s[32:35], s52 offen offset:3072 lds
	ds_read_b64_tr_b16 a[202:203], v58 offset:2048
	v_mfma_f32_16x16x32_bf16 v[180:183], a[220:223], a[72:75], v[180:183]
	ds_read_b64_tr_b16 a[204:205], v59 offset:0
	v_mul_u32_u24 v105, 0x380, v105
	v_mfma_f32_16x16x32_bf16 v[188:191], a[220:223], a[76:79], v[188:191]
	ds_read_b64_tr_b16 a[206:207], v59 offset:2048
	v_and_b32 v106, 7, v1
	v_mfma_f32_16x16x32_bf16 v[192:195], a[224:227], a[72:75], v[192:195]
	ds_read_b64_tr_b16 a[208:209], v60 offset:0
	v_lshlrev_b32 v103, 1, v104
	v_mfma_f32_16x16x32_bf16 v[200:203], a[224:227], a[76:79], v[200:203]
	ds_read_b64_tr_b16 a[210:211], v60 offset:2048
	v_xor_b32 v106, v106, v103
	v_mfma_f32_16x16x32_bf16 v[196:199], a[228:231], a[72:75], v[196:199]
	ds_read_b64_tr_b16 a[212:213], v61 offset:0
	v_lshl_add_u32 v44, v106, 4, v105
	v_mfma_f32_16x16x32_bf16 v[204:207], a[228:231], a[76:79], v[204:207]
	s_add_u32 m0, s45, 0x8000
	s_bfe_u32 s52, s54, 0x3000c
	s_lshl_b32 s52, s52, 7
	s_waitcnt lgkmcnt(6)
	buffer_load_dwordx4 v68, s[20:23], s52 offen offset:0 lds
	ds_read_b64_tr_b16 a[214:215], v61 offset:2048
	v_mfma_f32_16x16x32_bf16 v[208:211], a[232:235], a[72:75], v[208:211]
	ds_read_b64_tr_b16 a[216:217], v62 offset:0
	v_add_u32 v45, 0x1800, v44
	v_mfma_f32_16x16x32_bf16 v[216:219], a[232:235], a[76:79], v[216:219]
	buffer_load_dwordx4 v69, s[20:23], s52 offen offset:1024 lds
	ds_read_b64_tr_b16 a[218:219], v62 offset:2048
	v_mfma_f32_16x16x32_bf16 v[212:215], a[236:239], a[72:75], v[212:215]
	ds_read_b64_tr_b16 a[220:221], v63 offset:0
	v_add_u32 v46, 0x3000, v44
	v_mfma_f32_16x16x32_bf16 v[220:223], a[236:239], a[76:79], v[220:223]
	buffer_load_dwordx4 v70, s[20:23], s52 offen offset:2048 lds
	ds_read_b64_tr_b16 a[222:223], v63 offset:2048
	v_mfma_f32_16x16x32_bf16 v[224:227], a[240:243], a[72:75], v[224:227]
	ds_read_b64_tr_b16 a[224:225], v56 offset:256
	v_add_u32 v47, 0x4800, v44
	v_mfma_f32_16x16x32_bf16 v[232:235], a[240:243], a[76:79], v[232:235]
	buffer_load_dwordx4 v71, s[20:23], s52 offen offset:3072 lds
	ds_read_b64_tr_b16 a[226:227], v56 offset:2304
	v_mfma_f32_16x16x32_bf16 v[228:231], a[244:247], a[72:75], v[228:231]
	ds_read_b64_tr_b16 a[228:229], v57 offset:256
	v_mul_u32_u24 v105, 0x70000, v107
	v_mfma_f32_16x16x32_bf16 v[236:239], a[244:247], a[76:79], v[236:239]
	ds_read_b64_tr_b16 a[230:231], v57 offset:2304
	v_lshl_add_u32 v88, v1, 4, v105
	v_mfma_f32_16x16x32_bf16 v[240:243], a[248:251], a[72:75], v[240:243]
	ds_read_b64_tr_b16 a[232:233], v58 offset:256
	v_lshlrev_b32 v95, 4, v0
	v_mfma_f32_16x16x32_bf16 v[248:251], a[248:251], a[76:79], v[248:251]
	ds_read_b64_tr_b16 a[234:235], v58 offset:2304
	v_mov_b32 v2, 0
	v_mfma_f32_16x16x32_bf16 v[244:247], a[252:255], a[72:75], v[244:247]
	ds_read_b64_tr_b16 a[236:237], v59 offset:256
	v_mov_b32 v3, 0
	v_mfma_f32_16x16x32_bf16 v[252:255], a[252:255], a[76:79], v[252:255]
	ds_read_b64_tr_b16 a[238:239], v59 offset:2304
	v_mfma_f32_16x16x32_bf16 v[128:131], a[192:195], a[80:83], v[128:131]
	ds_read_b64_tr_b16 a[240:241], v60 offset:256
	v_mfma_f32_16x16x32_bf16 v[136:139], a[192:195], a[84:87], v[136:139]
	ds_read_b64_tr_b16 a[242:243], v60 offset:2304
	v_mfma_f32_16x16x32_bf16 v[132:135], a[196:199], a[80:83], v[132:135]
	ds_read_b64_tr_b16 a[244:245], v61 offset:256
	v_mfma_f32_16x16x32_bf16 v[140:143], a[196:199], a[84:87], v[140:143]
	ds_read_b64_tr_b16 a[246:247], v61 offset:2304
	s_waitcnt lgkmcnt(13)
	v_mfma_f32_16x16x32_bf16 v[144:147], a[200:203], a[80:83], v[144:147]
	ds_read_b64_tr_b16 a[248:249], v62 offset:256
	v_mfma_f32_16x16x32_bf16 v[152:155], a[200:203], a[84:87], v[152:155]
	ds_read_b64_tr_b16 a[250:251], v62 offset:2304
	v_mfma_f32_16x16x32_bf16 v[148:151], a[204:207], a[80:83], v[148:151]
	s_waitcnt vmcnt(16)
	s_barrier
	ds_read_b64_tr_b16 a[252:253], v63 offset:256
	v_mfma_f32_16x16x32_bf16 v[156:159], a[204:207], a[84:87], v[156:159]
	s_add_u32 m0, s45, 0x1c000
	s_bfe_u32 s52, s54, 0x3000c
	s_lshl_b32 s52, s52, 19
	buffer_load_dwordx4 v64, s[32:35], s52 offen offset:0 lds
	ds_read_b64_tr_b16 a[254:255], v63 offset:2304
	v_mfma_f32_16x16x32_bf16 v[160:163], a[208:211], a[80:83], v[160:163]
	ds_read_b64_tr_b16 a[192:193], v56 offset:16384
	v_mfma_f32_16x16x32_bf16 v[168:171], a[208:211], a[84:87], v[168:171]
	buffer_load_dwordx4 v65, s[32:35], s52 offen offset:1024 lds
	ds_read_b64_tr_b16 a[194:195], v56 offset:18432
	v_mfma_f32_16x16x32_bf16 v[164:167], a[212:215], a[80:83], v[164:167]
	ds_read_b64_tr_b16 a[196:197], v57 offset:16384
	v_mfma_f32_16x16x32_bf16 v[172:175], a[212:215], a[84:87], v[172:175]
	buffer_load_dwordx4 v66, s[32:35], s52 offen offset:2048 lds
	ds_read_b64_tr_b16 a[198:199], v57 offset:18432
	v_mfma_f32_16x16x32_bf16 v[176:179], a[216:219], a[80:83], v[176:179]
	ds_read_b64_tr_b16 a[200:201], v58 offset:16384
	v_mfma_f32_16x16x32_bf16 v[184:187], a[216:219], a[84:87], v[184:187]
	buffer_load_dwordx4 v67, s[32:35], s52 offen offset:3072 lds
	ds_read_b64_tr_b16 a[202:203], v58 offset:18432
	s_waitcnt lgkmcnt(12)
	v_mfma_f32_16x16x32_bf16 v[180:183], a[220:223], a[80:83], v[180:183]
	ds_read_b64_tr_b16 a[204:205], v59 offset:16384
	v_mfma_f32_16x16x32_bf16 v[188:191], a[220:223], a[84:87], v[188:191]
	ds_read_b64_tr_b16 a[206:207], v59 offset:18432
	v_mfma_f32_16x16x32_bf16 v[192:195], a[224:227], a[80:83], v[192:195]
	ds_read_b64_tr_b16 a[208:209], v60 offset:16384
	v_mfma_f32_16x16x32_bf16 v[200:203], a[224:227], a[84:87], v[200:203]
	ds_read_b64_tr_b16 a[210:211], v60 offset:18432
	v_mfma_f32_16x16x32_bf16 v[196:199], a[228:231], a[80:83], v[196:199]
	ds_read_b64_tr_b16 a[212:213], v61 offset:16384
	v_mfma_f32_16x16x32_bf16 v[204:207], a[228:231], a[84:87], v[204:207]
	ds_read_b64_tr_b16 a[214:215], v61 offset:18432
	v_mfma_f32_16x16x32_bf16 v[208:211], a[232:235], a[80:83], v[208:211]
	ds_read_b64_tr_b16 a[216:217], v62 offset:16384
	v_mfma_f32_16x16x32_bf16 v[216:219], a[232:235], a[84:87], v[216:219]
	ds_read_b64_tr_b16 a[218:219], v62 offset:18432
	v_mfma_f32_16x16x32_bf16 v[212:215], a[236:239], a[80:83], v[212:215]
	ds_read_b64_tr_b16 a[220:221], v63 offset:16384
	v_mfma_f32_16x16x32_bf16 v[220:223], a[236:239], a[84:87], v[220:223]
	ds_read_b64_tr_b16 a[222:223], v63 offset:18432
	v_mfma_f32_16x16x32_bf16 v[224:227], a[240:243], a[80:83], v[224:227]
	ds_read_b64_tr_b16 a[224:225], v56 offset:16640
	v_mfma_f32_16x16x32_bf16 v[232:235], a[240:243], a[84:87], v[232:235]
	ds_read_b64_tr_b16 a[226:227], v56 offset:18688
	s_waitcnt lgkmcnt(13)
	v_mfma_f32_16x16x32_bf16 v[228:231], a[244:247], a[80:83], v[228:231]
	ds_read_b64_tr_b16 a[228:229], v57 offset:16640
	v_mfma_f32_16x16x32_bf16 v[236:239], a[244:247], a[84:87], v[236:239]
	ds_read_b64_tr_b16 a[230:231], v57 offset:18688
	v_mfma_f32_16x16x32_bf16 v[240:243], a[248:251], a[80:83], v[240:243]
	ds_read_b64_tr_b16 a[232:233], v58 offset:16640
	v_mfma_f32_16x16x32_bf16 v[248:251], a[248:251], a[84:87], v[248:251]
	ds_read_b64_tr_b16 a[234:235], v58 offset:18688
	v_mfma_f32_16x16x32_bf16 v[244:247], a[252:255], a[80:83], v[244:247]
	ds_read_b64_tr_b16 a[236:237], v59 offset:16640
	v_mfma_f32_16x16x32_bf16 v[252:255], a[252:255], a[84:87], v[252:255]
	ds_read_b64_tr_b16 a[238:239], v59 offset:18688
	v_mfma_f32_16x16x32_bf16 v[128:131], a[192:195], a[88:91], v[128:131]
	ds_read_b64_tr_b16 a[240:241], v60 offset:16640
	v_mfma_f32_16x16x32_bf16 v[136:139], a[192:195], a[92:95], v[136:139]
	ds_read_b64_tr_b16 a[242:243], v60 offset:18688
	v_mfma_f32_16x16x32_bf16 v[132:135], a[196:199], a[88:91], v[132:135]
	ds_read_b64_tr_b16 a[244:245], v61 offset:16640
	v_mfma_f32_16x16x32_bf16 v[140:143], a[196:199], a[92:95], v[140:143]
	ds_read_b64_tr_b16 a[246:247], v61 offset:18688
	s_waitcnt lgkmcnt(13)
	v_mfma_f32_16x16x32_bf16 v[144:147], a[200:203], a[88:91], v[144:147]
	ds_read_b64_tr_b16 a[248:249], v62 offset:16640
	v_mfma_f32_16x16x32_bf16 v[152:155], a[200:203], a[92:95], v[152:155]
	ds_read_b64_tr_b16 a[250:251], v62 offset:18688
	v_mfma_f32_16x16x32_bf16 v[148:151], a[204:207], a[88:91], v[148:151]
	s_waitcnt vmcnt(16)
	s_barrier
	ds_read_b64_tr_b16 a[252:253], v63 offset:16640
	v_mfma_f32_16x16x32_bf16 v[156:159], a[204:207], a[92:95], v[156:159]
	s_add_u32 m0, s45, 0x20000
	s_bfe_u32 s52, s54, 0x3000c
	s_lshl_b32 s52, s52, 19
	s_add_u32 s52, s52, 0x40000
	buffer_load_dwordx4 v64, s[32:35], s52 offen offset:0 lds
	ds_read_b64_tr_b16 a[254:255], v63 offset:18688
	v_mfma_f32_16x16x32_bf16 v[160:163], a[208:211], a[88:91], v[160:163]
	ds_read_b64_tr_b16 a[192:193], v48 offset:16384
	v_mfma_f32_16x16x32_bf16 v[168:171], a[208:211], a[92:95], v[168:171]
	buffer_load_dwordx4 v65, s[32:35], s52 offen offset:1024 lds
	ds_read_b64_tr_b16 a[194:195], v48 offset:18432
	v_mfma_f32_16x16x32_bf16 v[164:167], a[212:215], a[88:91], v[164:167]
	ds_read_b64_tr_b16 a[196:197], v49 offset:16384
	v_mfma_f32_16x16x32_bf16 v[172:175], a[212:215], a[92:95], v[172:175]
	buffer_load_dwordx4 v66, s[32:35], s52 offen offset:2048 lds
	ds_read_b64_tr_b16 a[198:199], v49 offset:18432
	v_mfma_f32_16x16x32_bf16 v[176:179], a[216:219], a[88:91], v[176:179]
	ds_read_b64_tr_b16 a[200:201], v50 offset:16384
	v_mfma_f32_16x16x32_bf16 v[184:187], a[216:219], a[92:95], v[184:187]
	buffer_load_dwordx4 v67, s[32:35], s52 offen offset:3072 lds
	ds_read_b64_tr_b16 a[202:203], v50 offset:18432
	s_waitcnt lgkmcnt(12)
	v_mfma_f32_16x16x32_bf16 v[180:183], a[220:223], a[88:91], v[180:183]
	ds_read_b64_tr_b16 a[204:205], v51 offset:16384
	v_mfma_f32_16x16x32_bf16 v[188:191], a[220:223], a[92:95], v[188:191]
	ds_read_b64_tr_b16 a[206:207], v51 offset:18432
	buffer_store_dword v92, v91, s[8:11], 0 offen sc1
	v_mfma_f32_16x16x32_bf16 v[192:195], a[224:227], a[88:91], v[192:195]
	s_waitcnt vmcnt(17)
	ds_read_b128 a[96:99], v72 offset:49152
	ds_read_b64_tr_b16 a[208:209], v52 offset:16384
	v_mfma_f32_16x16x32_bf16 v[200:203], a[224:227], a[92:95], v[200:203]
	ds_read_b64_tr_b16 a[210:211], v52 offset:18432
	v_mfma_f32_16x16x32_bf16 v[196:199], a[228:231], a[88:91], v[196:199]
	ds_read_b128 a[100:103], v72 offset:51200
	ds_read_b64_tr_b16 a[212:213], v53 offset:16384
	v_mfma_f32_16x16x32_bf16 v[204:207], a[228:231], a[92:95], v[204:207]
	ds_read_b64_tr_b16 a[214:215], v53 offset:18432
	v_mfma_f32_16x16x32_bf16 v[208:211], a[232:235], a[88:91], v[208:211]
	ds_read_b128 a[104:107], v73 offset:49152
	ds_read_b64_tr_b16 a[216:217], v54 offset:16384
	v_mfma_f32_16x16x32_bf16 v[216:219], a[232:235], a[92:95], v[216:219]
	ds_read_b64_tr_b16 a[218:219], v54 offset:18432
	v_mfma_f32_16x16x32_bf16 v[212:215], a[236:239], a[88:91], v[212:215]
	ds_read_b128 a[108:111], v73 offset:51200
	ds_read_b64_tr_b16 a[220:221], v55 offset:16384
	v_mfma_f32_16x16x32_bf16 v[220:223], a[236:239], a[92:95], v[220:223]
	ds_read_b64_tr_b16 a[222:223], v55 offset:18432
	v_mfma_f32_16x16x32_bf16 v[224:227], a[240:243], a[88:91], v[224:227]
	ds_read_b64_tr_b16 a[224:225], v48 offset:16640
	v_mfma_f32_16x16x32_bf16 v[232:235], a[240:243], a[92:95], v[232:235]
	ds_read_b64_tr_b16 a[226:227], v48 offset:18688
	s_waitcnt lgkmcnt(15)
	v_mfma_f32_16x16x32_bf16 v[228:231], a[244:247], a[88:91], v[228:231]
	ds_read_b64_tr_b16 a[228:229], v49 offset:16640
	v_mfma_f32_16x16x32_bf16 v[236:239], a[244:247], a[92:95], v[236:239]
	ds_read_b64_tr_b16 a[230:231], v49 offset:18688
	v_mfma_f32_16x16x32_bf16 v[240:243], a[248:251], a[88:91], v[240:243]
	s_add_u32 m0, s45, 0xc000
	s_bfe_u32 s52, s54, 0x30010
	s_lshl_b32 s52, s52, 7
	s_waitcnt lgkmcnt(6)
	buffer_load_dwordx4 v68, s[20:23], s52 offen offset:0 lds
	ds_read_b64_tr_b16 a[232:233], v50 offset:16640
	v_mfma_f32_16x16x32_bf16 v[248:251], a[248:251], a[92:95], v[248:251]
	ds_read_b64_tr_b16 a[234:235], v50 offset:18688
	v_mfma_f32_16x16x32_bf16 v[244:247], a[252:255], a[88:91], v[244:247]
	buffer_load_dwordx4 v69, s[20:23], s52 offen offset:1024 lds
	ds_read_b64_tr_b16 a[236:237], v51 offset:16640
	v_mfma_f32_16x16x32_bf16 v[252:255], a[252:255], a[92:95], v[252:255]
	ds_read_b64_tr_b16 a[238:239], v51 offset:18688
	v_mfma_f32_16x16x32_bf16 v[128:131], a[192:195], a[96:99], v[128:131]
	buffer_load_dwordx4 v70, s[20:23], s52 offen offset:2048 lds
	ds_read_b64_tr_b16 a[240:241], v52 offset:16640
	v_mfma_f32_16x16x32_bf16 v[136:139], a[192:195], a[100:103], v[136:139]
	ds_read_b64_tr_b16 a[242:243], v52 offset:18688
	v_mfma_f32_16x16x32_bf16 v[132:135], a[196:199], a[96:99], v[132:135]
	buffer_load_dwordx4 v71, s[20:23], s52 offen offset:3072 lds
	ds_read_b64_tr_b16 a[244:245], v53 offset:16640
	v_mfma_f32_16x16x32_bf16 v[140:143], a[196:199], a[100:103], v[140:143]
	ds_read_b64_tr_b16 a[246:247], v53 offset:18688
	v_mfma_f32_16x16x32_bf16 v[144:147], a[200:203], a[96:99], v[144:147]
	ds_read_b64_tr_b16 a[248:249], v54 offset:16640
	v_mfma_f32_16x16x32_bf16 v[152:155], a[200:203], a[100:103], v[152:155]
	ds_read_b64_tr_b16 a[250:251], v54 offset:18688
	v_mfma_f32_16x16x32_bf16 v[148:151], a[204:207], a[96:99], v[148:151]
	s_waitcnt vmcnt(17)
	s_barrier
	ds_read_b64_tr_b16 a[252:253], v55 offset:16640
	v_mfma_f32_16x16x32_bf16 v[156:159], a[204:207], a[100:103], v[156:159]
	s_add_u32 m0, s45, 0x24000
	s_bfe_u32 s52, s54, 0x30010
	s_lshl_b32 s52, s52, 19
	buffer_load_dwordx4 v64, s[32:35], s52 offen offset:0 lds
	ds_read_b64_tr_b16 a[254:255], v55 offset:18688
	v_mfma_f32_16x16x32_bf16 v[160:163], a[208:211], a[96:99], v[160:163]
	ds_read_b64_tr_b16 a[192:193], v48 offset:32768
	v_mfma_f32_16x16x32_bf16 v[168:171], a[208:211], a[100:103], v[168:171]
	buffer_load_dwordx4 v65, s[32:35], s52 offen offset:1024 lds
	ds_read_b64_tr_b16 a[194:195], v48 offset:34816
	v_mfma_f32_16x16x32_bf16 v[164:167], a[212:215], a[96:99], v[164:167]
	ds_read_b64_tr_b16 a[196:197], v49 offset:32768
	v_mfma_f32_16x16x32_bf16 v[172:175], a[212:215], a[100:103], v[172:175]
	buffer_load_dwordx4 v66, s[32:35], s52 offen offset:2048 lds
	ds_read_b64_tr_b16 a[198:199], v49 offset:34816
	v_mfma_f32_16x16x32_bf16 v[176:179], a[216:219], a[96:99], v[176:179]
	ds_read_b64_tr_b16 a[200:201], v50 offset:32768
	v_mfma_f32_16x16x32_bf16 v[184:187], a[216:219], a[100:103], v[184:187]
	buffer_load_dwordx4 v67, s[32:35], s52 offen offset:3072 lds
	ds_read_b64_tr_b16 a[202:203], v50 offset:34816
	s_waitcnt lgkmcnt(12)
	v_mfma_f32_16x16x32_bf16 v[180:183], a[220:223], a[96:99], v[180:183]
	ds_read_b64_tr_b16 a[204:205], v51 offset:32768
	v_mfma_f32_16x16x32_bf16 v[188:191], a[220:223], a[100:103], v[188:191]
	ds_read_b64_tr_b16 a[206:207], v51 offset:34816
	v_mfma_f32_16x16x32_bf16 v[192:195], a[224:227], a[96:99], v[192:195]
	s_add_u32 m0, s45, 0
	s_mov_b32 s50, 0
	buffer_load_dwordx4 v36, s[24:27], s50 offen offset:0 nt lds
	ds_read_b64_tr_b16 a[208:209], v52 offset:32768
	v_mfma_f32_16x16x32_bf16 v[200:203], a[224:227], a[100:103], v[200:203]
	ds_read_b64_tr_b16 a[210:211], v52 offset:34816
	v_mfma_f32_16x16x32_bf16 v[196:199], a[228:231], a[96:99], v[196:199]
	buffer_load_dwordx4 v37, s[24:27], s50 offen offset:1024 nt lds
	ds_read_b64_tr_b16 a[212:213], v53 offset:32768
	v_mfma_f32_16x16x32_bf16 v[204:207], a[228:231], a[100:103], v[204:207]
	ds_read_b64_tr_b16 a[214:215], v53 offset:34816
	v_mfma_f32_16x16x32_bf16 v[208:211], a[232:235], a[96:99], v[208:211]
	buffer_load_dwordx4 v38, s[24:27], s50 offen offset:2048 nt lds
	ds_read_b64_tr_b16 a[216:217], v54 offset:32768
	v_mfma_f32_16x16x32_bf16 v[216:219], a[232:235], a[100:103], v[216:219]
	ds_read_b64_tr_b16 a[218:219], v54 offset:34816
	v_mfma_f32_16x16x32_bf16 v[212:215], a[236:239], a[96:99], v[212:215]
	buffer_load_dwordx4 v39, s[24:27], s50 offen offset:3072 nt lds
	ds_read_b64_tr_b16 a[220:221], v55 offset:32768
	v_mfma_f32_16x16x32_bf16 v[220:223], a[236:239], a[100:103], v[220:223]
	ds_read_b64_tr_b16 a[222:223], v55 offset:34816
	v_mfma_f32_16x16x32_bf16 v[224:227], a[240:243], a[96:99], v[224:227]
	ds_read_b64_tr_b16 a[224:225], v48 offset:33024
	v_mfma_f32_16x16x32_bf16 v[232:235], a[240:243], a[100:103], v[232:235]
	ds_read_b64_tr_b16 a[226:227], v48 offset:35072
	s_waitcnt lgkmcnt(13)
	v_mfma_f32_16x16x32_bf16 v[228:231], a[244:247], a[96:99], v[228:231]
	ds_read_b64_tr_b16 a[228:229], v49 offset:33024
	v_mfma_f32_16x16x32_bf16 v[236:239], a[244:247], a[100:103], v[236:239]
	ds_read_b64_tr_b16 a[230:231], v49 offset:35072
	v_mfma_f32_16x16x32_bf16 v[240:243], a[248:251], a[96:99], v[240:243]
	ds_read_b64_tr_b16 a[232:233], v50 offset:33024
	v_mfma_f32_16x16x32_bf16 v[248:251], a[248:251], a[100:103], v[248:251]
	ds_read_b64_tr_b16 a[234:235], v50 offset:35072
	v_mfma_f32_16x16x32_bf16 v[244:247], a[252:255], a[96:99], v[244:247]
	ds_read_b64_tr_b16 a[236:237], v51 offset:33024
	v_mfma_f32_16x16x32_bf16 v[252:255], a[252:255], a[100:103], v[252:255]
	ds_read_b64_tr_b16 a[238:239], v51 offset:35072
	v_mfma_f32_16x16x32_bf16 v[128:131], a[192:195], a[104:107], v[128:131]
	ds_read_b64_tr_b16 a[240:241], v52 offset:33024
	v_mfma_f32_16x16x32_bf16 v[136:139], a[192:195], a[108:111], v[136:139]
	ds_read_b64_tr_b16 a[242:243], v52 offset:35072
	v_mfma_f32_16x16x32_bf16 v[132:135], a[196:199], a[104:107], v[132:135]
	ds_read_b64_tr_b16 a[244:245], v53 offset:33024
	v_mfma_f32_16x16x32_bf16 v[140:143], a[196:199], a[108:111], v[140:143]
	ds_read_b64_tr_b16 a[246:247], v53 offset:35072
	s_waitcnt lgkmcnt(13)
	v_mfma_f32_16x16x32_bf16 v[144:147], a[200:203], a[104:107], v[144:147]
	ds_read_b64_tr_b16 a[248:249], v54 offset:33024
	v_mfma_f32_16x16x32_bf16 v[152:155], a[200:203], a[108:111], v[152:155]
	ds_read_b64_tr_b16 a[250:251], v54 offset:35072
	v_mfma_f32_16x16x32_bf16 v[148:151], a[204:207], a[104:107], v[148:151]
	s_waitcnt vmcnt(17)
	s_barrier
	ds_read_b64_tr_b16 a[252:253], v55 offset:33024
	v_mfma_f32_16x16x32_bf16 v[156:159], a[204:207], a[108:111], v[156:159]
	s_add_u32 m0, s45, 0x14000
	s_bfe_u32 s52, s54, 0x30010
	s_lshl_b32 s52, s52, 19
	s_add_u32 s52, s52, 0x40000
	buffer_load_dwordx4 v64, s[32:35], s52 offen offset:0 lds
	ds_read_b64_tr_b16 a[254:255], v55 offset:35072
	v_mfma_f32_16x16x32_bf16 v[160:163], a[208:211], a[104:107], v[160:163]
	ds_read_b64_tr_b16 a[192:193], v48 offset:49152
	v_mfma_f32_16x16x32_bf16 v[168:171], a[208:211], a[108:111], v[168:171]
	buffer_load_dwordx4 v65, s[32:35], s52 offen offset:1024 lds
	ds_read_b64_tr_b16 a[194:195], v48 offset:51200
	v_mfma_f32_16x16x32_bf16 v[164:167], a[212:215], a[104:107], v[164:167]
	ds_read_b64_tr_b16 a[196:197], v49 offset:49152
	v_mfma_f32_16x16x32_bf16 v[172:175], a[212:215], a[108:111], v[172:175]
	buffer_load_dwordx4 v66, s[32:35], s52 offen offset:2048 lds
	ds_read_b64_tr_b16 a[198:199], v49 offset:51200
	v_mfma_f32_16x16x32_bf16 v[176:179], a[216:219], a[104:107], v[176:179]
	ds_read_b64_tr_b16 a[200:201], v50 offset:49152
	v_mfma_f32_16x16x32_bf16 v[184:187], a[216:219], a[108:111], v[184:187]
	buffer_load_dwordx4 v67, s[32:35], s52 offen offset:3072 lds
	ds_read_b64_tr_b16 a[202:203], v50 offset:51200
	s_waitcnt lgkmcnt(12)
	v_mfma_f32_16x16x32_bf16 v[180:183], a[220:223], a[104:107], v[180:183]
	ds_read_b64_tr_b16 a[204:205], v51 offset:49152
	v_mfma_f32_16x16x32_bf16 v[188:191], a[220:223], a[108:111], v[188:191]
	ds_read_b64_tr_b16 a[206:207], v51 offset:51200
	v_mfma_f32_16x16x32_bf16 v[192:195], a[224:227], a[104:107], v[192:195]
	ds_read_b128 a[112:115], v72 offset:32768
	ds_read_b64_tr_b16 a[208:209], v52 offset:49152
	v_mfma_f32_16x16x32_bf16 v[200:203], a[224:227], a[108:111], v[200:203]
	ds_read_b64_tr_b16 a[210:211], v52 offset:51200
	v_mfma_f32_16x16x32_bf16 v[196:199], a[228:231], a[104:107], v[196:199]
	ds_read_b128 a[116:119], v72 offset:34816
	ds_read_b64_tr_b16 a[212:213], v53 offset:49152
	v_mfma_f32_16x16x32_bf16 v[204:207], a[228:231], a[108:111], v[204:207]
	ds_read_b64_tr_b16 a[214:215], v53 offset:51200
	v_mfma_f32_16x16x32_bf16 v[208:211], a[232:235], a[104:107], v[208:211]
	ds_read_b128 a[120:123], v73 offset:32768
	ds_read_b64_tr_b16 a[216:217], v54 offset:49152
	v_mfma_f32_16x16x32_bf16 v[216:219], a[232:235], a[108:111], v[216:219]
	ds_read_b64_tr_b16 a[218:219], v54 offset:51200
	v_mfma_f32_16x16x32_bf16 v[212:215], a[236:239], a[104:107], v[212:215]
	ds_read_b128 a[124:127], v73 offset:34816
	ds_read_b64_tr_b16 a[220:221], v55 offset:49152
	v_mfma_f32_16x16x32_bf16 v[220:223], a[236:239], a[108:111], v[220:223]
	ds_read_b64_tr_b16 a[222:223], v55 offset:51200
	v_mfma_f32_16x16x32_bf16 v[224:227], a[240:243], a[104:107], v[224:227]
	ds_read_b64_tr_b16 a[224:225], v48 offset:49408
	v_mfma_f32_16x16x32_bf16 v[232:235], a[240:243], a[108:111], v[232:235]
	ds_read_b64_tr_b16 a[226:227], v48 offset:51456
	s_waitcnt lgkmcnt(15)
	v_mfma_f32_16x16x32_bf16 v[228:231], a[244:247], a[104:107], v[228:231]
	ds_read_b64_tr_b16 a[228:229], v49 offset:49408
	v_mfma_f32_16x16x32_bf16 v[236:239], a[244:247], a[108:111], v[236:239]
	ds_read_b64_tr_b16 a[230:231], v49 offset:51456
	v_mfma_f32_16x16x32_bf16 v[240:243], a[248:251], a[104:107], v[240:243]
	s_add_u32 m0, s45, 0x8000
	s_bfe_u32 s52, s54, 0x30014
	s_lshl_b32 s52, s52, 7
	s_waitcnt lgkmcnt(6)
	buffer_load_dwordx4 v68, s[20:23], s52 offen offset:0 lds
	ds_read_b64_tr_b16 a[232:233], v50 offset:49408
	v_mfma_f32_16x16x32_bf16 v[248:251], a[248:251], a[108:111], v[248:251]
	ds_read_b64_tr_b16 a[234:235], v50 offset:51456
	v_mfma_f32_16x16x32_bf16 v[244:247], a[252:255], a[104:107], v[244:247]
	buffer_load_dwordx4 v69, s[20:23], s52 offen offset:1024 lds
	ds_read_b64_tr_b16 a[236:237], v51 offset:49408
	v_mfma_f32_16x16x32_bf16 v[252:255], a[252:255], a[108:111], v[252:255]
	ds_read_b64_tr_b16 a[238:239], v51 offset:51456
	v_mfma_f32_16x16x32_bf16 v[128:131], a[192:195], a[112:115], v[128:131]
	buffer_load_dwordx4 v70, s[20:23], s52 offen offset:2048 lds
	ds_read_b64_tr_b16 a[240:241], v52 offset:49408
	v_mfma_f32_16x16x32_bf16 v[136:139], a[192:195], a[116:119], v[136:139]
	ds_read_b64_tr_b16 a[242:243], v52 offset:51456
	v_mfma_f32_16x16x32_bf16 v[132:135], a[196:199], a[112:115], v[132:135]
	buffer_load_dwordx4 v71, s[20:23], s52 offen offset:3072 lds
	ds_read_b64_tr_b16 a[244:245], v53 offset:49408
	v_mfma_f32_16x16x32_bf16 v[140:143], a[196:199], a[116:119], v[140:143]
	ds_read_b64_tr_b16 a[246:247], v53 offset:51456
	v_mfma_f32_16x16x32_bf16 v[144:147], a[200:203], a[112:115], v[144:147]
	ds_read_b64_tr_b16 a[248:249], v54 offset:49408
	v_mfma_f32_16x16x32_bf16 v[152:155], a[200:203], a[116:119], v[152:155]
	ds_read_b64_tr_b16 a[250:251], v54 offset:51456
	v_mfma_f32_16x16x32_bf16 v[148:151], a[204:207], a[112:115], v[148:151]
	s_waitcnt vmcnt(21)
	s_barrier
	ds_read_b64_tr_b16 a[252:253], v55 offset:49408
	v_mfma_f32_16x16x32_bf16 v[156:159], a[204:207], a[116:119], v[156:159]
	s_add_u32 m0, s45, 0x18000
	s_bfe_u32 s52, s54, 0x30014
	s_lshl_b32 s52, s52, 19
	buffer_load_dwordx4 v64, s[32:35], s52 offen offset:0 lds
	ds_read_b64_tr_b16 a[254:255], v55 offset:51456
	v_mfma_f32_16x16x32_bf16 v[160:163], a[208:211], a[112:115], v[160:163]
	ds_read_b64_tr_b16 a[192:193], v56 offset:0
	v_mfma_f32_16x16x32_bf16 v[168:171], a[208:211], a[116:119], v[168:171]
	buffer_load_dwordx4 v65, s[32:35], s52 offen offset:1024 lds
	ds_read_b64_tr_b16 a[194:195], v56 offset:2048
	v_mfma_f32_16x16x32_bf16 v[164:167], a[212:215], a[112:115], v[164:167]
	ds_read_b64_tr_b16 a[196:197], v57 offset:0
	v_mfma_f32_16x16x32_bf16 v[172:175], a[212:215], a[116:119], v[172:175]
	buffer_load_dwordx4 v66, s[32:35], s52 offen offset:2048 lds
	ds_read_b64_tr_b16 a[198:199], v57 offset:2048
	v_mfma_f32_16x16x32_bf16 v[176:179], a[216:219], a[112:115], v[176:179]
	ds_read_b64_tr_b16 a[200:201], v58 offset:0
	v_mfma_f32_16x16x32_bf16 v[184:187], a[216:219], a[116:119], v[184:187]
	buffer_load_dwordx4 v67, s[32:35], s52 offen offset:3072 lds
	ds_read_b64_tr_b16 a[202:203], v58 offset:2048
	s_waitcnt lgkmcnt(12)
	v_mfma_f32_16x16x32_bf16 v[180:183], a[220:223], a[112:115], v[180:183]
	ds_read_b64_tr_b16 a[204:205], v59 offset:0
	v_mfma_f32_16x16x32_bf16 v[188:191], a[220:223], a[116:119], v[188:191]
	ds_read_b64_tr_b16 a[206:207], v59 offset:2048
	v_mfma_f32_16x16x32_bf16 v[192:195], a[224:227], a[112:115], v[192:195]
	s_add_u32 m0, s45, 0x4000
	s_add_u32 s50, s50, 0x4000
	buffer_load_dwordx4 v36, s[24:27], s50 offen offset:0 nt lds
	ds_read_b64_tr_b16 a[208:209], v60 offset:0
	v_mfma_f32_16x16x32_bf16 v[200:203], a[224:227], a[116:119], v[200:203]
	ds_read_b64_tr_b16 a[210:211], v60 offset:2048
	v_mfma_f32_16x16x32_bf16 v[196:199], a[228:231], a[112:115], v[196:199]
	buffer_load_dwordx4 v37, s[24:27], s50 offen offset:1024 nt lds
	ds_read_b64_tr_b16 a[212:213], v61 offset:0
	v_mfma_f32_16x16x32_bf16 v[204:207], a[228:231], a[116:119], v[204:207]
	ds_read_b64_tr_b16 a[214:215], v61 offset:2048
	v_mfma_f32_16x16x32_bf16 v[208:211], a[232:235], a[112:115], v[208:211]
	buffer_load_dwordx4 v38, s[24:27], s50 offen offset:2048 nt lds
	ds_read_b64_tr_b16 a[216:217], v62 offset:0
	v_mfma_f32_16x16x32_bf16 v[216:219], a[232:235], a[116:119], v[216:219]
	ds_read_b64_tr_b16 a[218:219], v62 offset:2048
	v_mfma_f32_16x16x32_bf16 v[212:215], a[236:239], a[112:115], v[212:215]
	buffer_load_dwordx4 v39, s[24:27], s50 offen offset:3072 nt lds
	ds_read_b64_tr_b16 a[220:221], v63 offset:0
	v_mfma_f32_16x16x32_bf16 v[220:223], a[236:239], a[116:119], v[220:223]
	ds_read_b64_tr_b16 a[222:223], v63 offset:2048
	v_mfma_f32_16x16x32_bf16 v[224:227], a[240:243], a[112:115], v[224:227]
	ds_read_b64_tr_b16 a[224:225], v56 offset:256
	v_mfma_f32_16x16x32_bf16 v[232:235], a[240:243], a[116:119], v[232:235]
	ds_read_b64_tr_b16 a[226:227], v56 offset:2304
	s_waitcnt lgkmcnt(13)
	v_mfma_f32_16x16x32_bf16 v[228:231], a[244:247], a[112:115], v[228:231]
	ds_read_b64_tr_b16 a[228:229], v57 offset:256
	v_mfma_f32_16x16x32_bf16 v[236:239], a[244:247], a[116:119], v[236:239]
	ds_read_b64_tr_b16 a[230:231], v57 offset:2304
	v_mfma_f32_16x16x32_bf16 v[240:243], a[248:251], a[112:115], v[240:243]
	ds_read_b64_tr_b16 a[232:233], v58 offset:256
	v_mfma_f32_16x16x32_bf16 v[248:251], a[248:251], a[116:119], v[248:251]
	ds_read_b64_tr_b16 a[234:235], v58 offset:2304
	v_mfma_f32_16x16x32_bf16 v[244:247], a[252:255], a[112:115], v[244:247]
	ds_read_b64_tr_b16 a[236:237], v59 offset:256
	v_mfma_f32_16x16x32_bf16 v[252:255], a[252:255], a[116:119], v[252:255]
	ds_read_b64_tr_b16 a[238:239], v59 offset:2304
	v_mfma_f32_16x16x32_bf16 v[128:131], a[192:195], a[120:123], v[128:131]
	ds_read_b64_tr_b16 a[240:241], v60 offset:256
	v_mfma_f32_16x16x32_bf16 v[136:139], a[192:195], a[124:127], v[136:139]
	ds_read_b64_tr_b16 a[242:243], v60 offset:2304
	v_mfma_f32_16x16x32_bf16 v[132:135], a[196:199], a[120:123], v[132:135]
	ds_read_b64_tr_b16 a[244:245], v61 offset:256
	v_mfma_f32_16x16x32_bf16 v[140:143], a[196:199], a[124:127], v[140:143]
	ds_read_b64_tr_b16 a[246:247], v61 offset:2304
	s_waitcnt lgkmcnt(13)
	v_mfma_f32_16x16x32_bf16 v[144:147], a[200:203], a[120:123], v[144:147]
	ds_read_b64_tr_b16 a[248:249], v62 offset:256
	v_mfma_f32_16x16x32_bf16 v[152:155], a[200:203], a[124:127], v[152:155]
	ds_read_b64_tr_b16 a[250:251], v62 offset:2304
	v_mfma_f32_16x16x32_bf16 v[148:151], a[204:207], a[120:123], v[148:151]
	s_waitcnt vmcnt(20)
	s_barrier
	ds_read_b64_tr_b16 a[252:253], v63 offset:256
	v_mfma_f32_16x16x32_bf16 v[156:159], a[204:207], a[124:127], v[156:159]
	s_add_u32 m0, s45, 0x1c000
	s_bfe_u32 s52, s54, 0x30014
	s_lshl_b32 s52, s52, 19
	s_add_u32 s52, s52, 0x40000
	buffer_load_dwordx4 v64, s[32:35], s52 offen offset:0 lds
	ds_read_b64_tr_b16 a[254:255], v63 offset:2304
	v_mfma_f32_16x16x32_bf16 v[160:163], a[208:211], a[120:123], v[160:163]
	ds_read_b64_tr_b16 a[192:193], v56 offset:16384
	v_mfma_f32_16x16x32_bf16 v[168:171], a[208:211], a[124:127], v[168:171]
	buffer_load_dwordx4 v65, s[32:35], s52 offen offset:1024 lds
	ds_read_b64_tr_b16 a[194:195], v56 offset:18432
	v_mfma_f32_16x16x32_bf16 v[164:167], a[212:215], a[120:123], v[164:167]
	ds_read_b64_tr_b16 a[196:197], v57 offset:16384
	v_mfma_f32_16x16x32_bf16 v[172:175], a[212:215], a[124:127], v[172:175]
	buffer_load_dwordx4 v66, s[32:35], s52 offen offset:2048 lds
	ds_read_b64_tr_b16 a[198:199], v57 offset:18432
	v_mfma_f32_16x16x32_bf16 v[176:179], a[216:219], a[120:123], v[176:179]
	ds_read_b64_tr_b16 a[200:201], v58 offset:16384
	v_mfma_f32_16x16x32_bf16 v[184:187], a[216:219], a[124:127], v[184:187]
	buffer_load_dwordx4 v67, s[32:35], s52 offen offset:3072 lds
	ds_read_b64_tr_b16 a[202:203], v58 offset:18432
	s_waitcnt lgkmcnt(12)
	v_mfma_f32_16x16x32_bf16 v[180:183], a[220:223], a[120:123], v[180:183]
	ds_read_b64_tr_b16 a[204:205], v59 offset:16384
	v_mfma_f32_16x16x32_bf16 v[188:191], a[220:223], a[124:127], v[188:191]
	ds_read_b64_tr_b16 a[206:207], v59 offset:18432
	v_mfma_f32_16x16x32_bf16 v[192:195], a[224:227], a[120:123], v[192:195]
	ds_read_b128 a[128:131], v72 offset:49152
	ds_read_b64_tr_b16 a[208:209], v60 offset:16384
	v_mfma_f32_16x16x32_bf16 v[200:203], a[224:227], a[124:127], v[200:203]
	ds_read_b64_tr_b16 a[210:211], v60 offset:18432
	v_mfma_f32_16x16x32_bf16 v[196:199], a[228:231], a[120:123], v[196:199]
	ds_read_b128 a[132:135], v72 offset:51200
	ds_read_b64_tr_b16 a[212:213], v61 offset:16384
	v_mfma_f32_16x16x32_bf16 v[204:207], a[228:231], a[124:127], v[204:207]
	ds_read_b64_tr_b16 a[214:215], v61 offset:18432
	v_mfma_f32_16x16x32_bf16 v[208:211], a[232:235], a[120:123], v[208:211]
	ds_read_b128 a[136:139], v73 offset:49152
	ds_read_b64_tr_b16 a[216:217], v62 offset:16384
	v_mfma_f32_16x16x32_bf16 v[216:219], a[232:235], a[124:127], v[216:219]
	ds_read_b64_tr_b16 a[218:219], v62 offset:18432
	v_mfma_f32_16x16x32_bf16 v[212:215], a[236:239], a[120:123], v[212:215]
	ds_read_b128 a[140:143], v73 offset:51200
	ds_read_b64_tr_b16 a[220:221], v63 offset:16384
	v_mfma_f32_16x16x32_bf16 v[220:223], a[236:239], a[124:127], v[220:223]
	ds_read_b64_tr_b16 a[222:223], v63 offset:18432
	v_mfma_f32_16x16x32_bf16 v[224:227], a[240:243], a[120:123], v[224:227]
	ds_read_b64_tr_b16 a[224:225], v56 offset:16640
	v_mfma_f32_16x16x32_bf16 v[232:235], a[240:243], a[124:127], v[232:235]
	ds_read_b64_tr_b16 a[226:227], v56 offset:18688
	s_waitcnt lgkmcnt(15)
	v_mfma_f32_16x16x32_bf16 v[228:231], a[244:247], a[120:123], v[228:231]
	ds_read_b64_tr_b16 a[228:229], v57 offset:16640
	v_mfma_f32_16x16x32_bf16 v[236:239], a[244:247], a[124:127], v[236:239]
	ds_read_b64_tr_b16 a[230:231], v57 offset:18688
	v_mfma_f32_16x16x32_bf16 v[240:243], a[248:251], a[120:123], v[240:243]
	s_add_u32 m0, s45, 0xc000
	s_bfe_u32 s52, s54, 0x30018
	s_lshl_b32 s52, s52, 7
	s_waitcnt lgkmcnt(6)
	buffer_load_dwordx4 v68, s[20:23], s52 offen offset:0 lds
	ds_read_b64_tr_b16 a[232:233], v58 offset:16640
	v_mfma_f32_16x16x32_bf16 v[248:251], a[248:251], a[124:127], v[248:251]
	ds_read_b64_tr_b16 a[234:235], v58 offset:18688
	v_mfma_f32_16x16x32_bf16 v[244:247], a[252:255], a[120:123], v[244:247]
	buffer_load_dwordx4 v69, s[20:23], s52 offen offset:1024 lds
	ds_read_b64_tr_b16 a[236:237], v59 offset:16640
	v_mfma_f32_16x16x32_bf16 v[252:255], a[252:255], a[124:127], v[252:255]
	ds_read_b64_tr_b16 a[238:239], v59 offset:18688
	v_mfma_f32_16x16x32_bf16 v[128:131], a[192:195], a[128:131], v[128:131]
	buffer_load_dwordx4 v70, s[20:23], s52 offen offset:2048 lds
	ds_read_b64_tr_b16 a[240:241], v60 offset:16640
	v_mfma_f32_16x16x32_bf16 v[136:139], a[192:195], a[132:135], v[136:139]
	ds_read_b64_tr_b16 a[242:243], v60 offset:18688
	v_mfma_f32_16x16x32_bf16 v[132:135], a[196:199], a[128:131], v[132:135]
	buffer_load_dwordx4 v71, s[20:23], s52 offen offset:3072 lds
	ds_read_b64_tr_b16 a[244:245], v61 offset:16640
	v_mfma_f32_16x16x32_bf16 v[140:143], a[196:199], a[132:135], v[140:143]
	ds_read_b64_tr_b16 a[246:247], v61 offset:18688
	v_mfma_f32_16x16x32_bf16 v[144:147], a[200:203], a[128:131], v[144:147]
	ds_read_b64_tr_b16 a[248:249], v62 offset:16640
	v_mfma_f32_16x16x32_bf16 v[152:155], a[200:203], a[132:135], v[152:155]
	ds_read_b64_tr_b16 a[250:251], v62 offset:18688
	v_mfma_f32_16x16x32_bf16 v[148:151], a[204:207], a[128:131], v[148:151]
	s_waitcnt vmcnt(20)
	s_barrier
	ds_read_b64_tr_b16 a[252:253], v63 offset:16640
	v_mfma_f32_16x16x32_bf16 v[156:159], a[204:207], a[132:135], v[156:159]
	s_add_u32 m0, s45, 0x20000
	s_bfe_u32 s52, s54, 0x30018
	s_lshl_b32 s52, s52, 19
	buffer_load_dwordx4 v64, s[32:35], s52 offen offset:0 lds
	ds_read_b64_tr_b16 a[254:255], v63 offset:18688
	v_mfma_f32_16x16x32_bf16 v[160:163], a[208:211], a[128:131], v[160:163]
	ds_read_b64_tr_b16 a[192:193], v48 offset:16384
	v_mfma_f32_16x16x32_bf16 v[168:171], a[208:211], a[132:135], v[168:171]
	buffer_load_dwordx4 v65, s[32:35], s52 offen offset:1024 lds
	ds_read_b64_tr_b16 a[194:195], v48 offset:18432
	v_mfma_f32_16x16x32_bf16 v[164:167], a[212:215], a[128:131], v[164:167]
	ds_read_b64_tr_b16 a[196:197], v49 offset:16384
	v_mfma_f32_16x16x32_bf16 v[172:175], a[212:215], a[132:135], v[172:175]
	buffer_load_dwordx4 v66, s[32:35], s52 offen offset:2048 lds
	ds_read_b64_tr_b16 a[198:199], v49 offset:18432
	v_mfma_f32_16x16x32_bf16 v[176:179], a[216:219], a[128:131], v[176:179]
	ds_read_b64_tr_b16 a[200:201], v50 offset:16384
	v_mfma_f32_16x16x32_bf16 v[184:187], a[216:219], a[132:135], v[184:187]
	buffer_load_dwordx4 v67, s[32:35], s52 offen offset:3072 lds
	ds_read_b64_tr_b16 a[202:203], v50 offset:18432
	s_waitcnt lgkmcnt(12)
	v_mfma_f32_16x16x32_bf16 v[180:183], a[220:223], a[128:131], v[180:183]
	ds_read_b64_tr_b16 a[204:205], v51 offset:16384
	v_mfma_f32_16x16x32_bf16 v[188:191], a[220:223], a[132:135], v[188:191]
	ds_read_b64_tr_b16 a[206:207], v51 offset:18432
	v_mfma_f32_16x16x32_bf16 v[192:195], a[224:227], a[128:131], v[192:195]
	s_add_u32 m0, s45, 0x10000
	s_mov_b32 s51, 0
	buffer_load_dwordx4 v40, s[28:31], s51 offen offset:0 nt lds
	ds_read_b64_tr_b16 a[208:209], v52 offset:16384
	v_mfma_f32_16x16x32_bf16 v[200:203], a[224:227], a[132:135], v[200:203]
	ds_read_b64_tr_b16 a[210:211], v52 offset:18432
	v_mfma_f32_16x16x32_bf16 v[196:199], a[228:231], a[128:131], v[196:199]
	buffer_load_dwordx4 v41, s[28:31], s51 offen offset:1024 nt lds
	ds_read_b64_tr_b16 a[212:213], v53 offset:16384
	v_mfma_f32_16x16x32_bf16 v[204:207], a[228:231], a[132:135], v[204:207]
	ds_read_b64_tr_b16 a[214:215], v53 offset:18432
	v_mfma_f32_16x16x32_bf16 v[208:211], a[232:235], a[128:131], v[208:211]
	buffer_load_dwordx4 v42, s[28:31], s51 offen offset:2048 nt lds
	ds_read_b64_tr_b16 a[216:217], v54 offset:16384
	v_mfma_f32_16x16x32_bf16 v[216:219], a[232:235], a[132:135], v[216:219]
	ds_read_b64_tr_b16 a[218:219], v54 offset:18432
	v_mfma_f32_16x16x32_bf16 v[212:215], a[236:239], a[128:131], v[212:215]
	buffer_load_dwordx4 v43, s[28:31], s51 offen offset:3072 nt lds
	ds_read_b64_tr_b16 a[220:221], v55 offset:16384
	v_mfma_f32_16x16x32_bf16 v[220:223], a[236:239], a[132:135], v[220:223]
	ds_read_b64_tr_b16 a[222:223], v55 offset:18432
	v_mfma_f32_16x16x32_bf16 v[224:227], a[240:243], a[128:131], v[224:227]
	ds_read_b64_tr_b16 a[224:225], v48 offset:16640
	v_mfma_f32_16x16x32_bf16 v[232:235], a[240:243], a[132:135], v[232:235]
	ds_read_b64_tr_b16 a[226:227], v48 offset:18688
	s_waitcnt lgkmcnt(13)
	v_mfma_f32_16x16x32_bf16 v[228:231], a[244:247], a[128:131], v[228:231]
	ds_read_b64_tr_b16 a[228:229], v49 offset:16640
	v_mfma_f32_16x16x32_bf16 v[236:239], a[244:247], a[132:135], v[236:239]
	ds_read_b64_tr_b16 a[230:231], v49 offset:18688
	v_mfma_f32_16x16x32_bf16 v[240:243], a[248:251], a[128:131], v[240:243]
	ds_read_b64_tr_b16 a[232:233], v50 offset:16640
	v_mfma_f32_16x16x32_bf16 v[248:251], a[248:251], a[132:135], v[248:251]
	ds_read_b64_tr_b16 a[234:235], v50 offset:18688
	v_mfma_f32_16x16x32_bf16 v[244:247], a[252:255], a[128:131], v[244:247]
	ds_read_b64_tr_b16 a[236:237], v51 offset:16640
	v_mfma_f32_16x16x32_bf16 v[252:255], a[252:255], a[132:135], v[252:255]
	ds_read_b64_tr_b16 a[238:239], v51 offset:18688
	v_mfma_f32_16x16x32_bf16 v[128:131], a[192:195], a[136:139], v[128:131]
	ds_read_b64_tr_b16 a[240:241], v52 offset:16640
	v_mfma_f32_16x16x32_bf16 v[136:139], a[192:195], a[140:143], v[136:139]
	ds_read_b64_tr_b16 a[242:243], v52 offset:18688
	v_mfma_f32_16x16x32_bf16 v[132:135], a[196:199], a[136:139], v[132:135]
	ds_read_b64_tr_b16 a[244:245], v53 offset:16640
	v_mfma_f32_16x16x32_bf16 v[140:143], a[196:199], a[140:143], v[140:143]
	ds_read_b64_tr_b16 a[246:247], v53 offset:18688
	s_waitcnt lgkmcnt(13)
	v_mfma_f32_16x16x32_bf16 v[144:147], a[200:203], a[136:139], v[144:147]
	ds_read_b64_tr_b16 a[248:249], v54 offset:16640
	v_mfma_f32_16x16x32_bf16 v[152:155], a[200:203], a[140:143], v[152:155]
	ds_read_b64_tr_b16 a[250:251], v54 offset:18688
	v_mfma_f32_16x16x32_bf16 v[148:151], a[204:207], a[136:139], v[148:151]
	s_waitcnt vmcnt(20)
	s_barrier
	ds_read_b64_tr_b16 a[252:253], v55 offset:16640
	v_mfma_f32_16x16x32_bf16 v[156:159], a[204:207], a[140:143], v[156:159]
	s_add_u32 m0, s45, 0x24000
	s_bfe_u32 s52, s54, 0x30018
	s_lshl_b32 s52, s52, 19
	s_add_u32 s52, s52, 0x40000
	buffer_load_dwordx4 v64, s[32:35], s52 offen offset:0 lds
	ds_read_b64_tr_b16 a[254:255], v55 offset:18688
	v_mfma_f32_16x16x32_bf16 v[160:163], a[208:211], a[136:139], v[160:163]
	ds_read_b64_tr_b16 a[192:193], v48 offset:32768
	v_mfma_f32_16x16x32_bf16 v[168:171], a[208:211], a[140:143], v[168:171]
	buffer_load_dwordx4 v65, s[32:35], s52 offen offset:1024 lds
	ds_read_b64_tr_b16 a[194:195], v48 offset:34816
	v_mfma_f32_16x16x32_bf16 v[164:167], a[212:215], a[136:139], v[164:167]
	ds_read_b64_tr_b16 a[196:197], v49 offset:32768
	v_mfma_f32_16x16x32_bf16 v[172:175], a[212:215], a[140:143], v[172:175]
	buffer_load_dwordx4 v66, s[32:35], s52 offen offset:2048 lds
	ds_read_b64_tr_b16 a[198:199], v49 offset:34816
	v_mfma_f32_16x16x32_bf16 v[176:179], a[216:219], a[136:139], v[176:179]
	ds_read_b128 a[144:147], v72 offset:32768
	ds_read_b64_tr_b16 a[200:201], v50 offset:32768
	v_mfma_f32_16x16x32_bf16 v[184:187], a[216:219], a[140:143], v[184:187]
	buffer_load_dwordx4 v67, s[32:35], s52 offen offset:3072 lds
	ds_read_b64_tr_b16 a[202:203], v50 offset:34816
	s_waitcnt lgkmcnt(13)
	v_mfma_f32_16x16x32_bf16 v[180:183], a[220:223], a[136:139], v[180:183]
	ds_read_b128 a[148:151], v72 offset:34816
	ds_read_b64_tr_b16 a[204:205], v51 offset:32768
	v_mfma_f32_16x16x32_bf16 v[188:191], a[220:223], a[140:143], v[188:191]
	ds_read_b64_tr_b16 a[206:207], v51 offset:34816
	v_mfma_f32_16x16x32_bf16 v[192:195], a[224:227], a[136:139], v[192:195]
	ds_read_b128 a[152:155], v73 offset:32768
	ds_read_b64_tr_b16 a[208:209], v52 offset:32768
	v_mfma_f32_16x16x32_bf16 v[200:203], a[224:227], a[140:143], v[200:203]
	s_mul_i32 s52, s59, 0x3800
	buffer_load_dwordx4 a[176:179], v95, s[36:39], s52 offen offset:0
	ds_read_b64_tr_b16 a[210:211], v52 offset:34816
	v_mfma_f32_16x16x32_bf16 v[196:199], a[228:231], a[136:139], v[196:199]
	ds_read_b128 a[156:159], v73 offset:34816
	ds_read_b64_tr_b16 a[212:213], v53 offset:32768
	v_mfma_f32_16x16x32_bf16 v[204:207], a[228:231], a[140:143], v[204:207]
	s_add_u32 s52, s52, 0x1000
	buffer_load_dwordx4 a[176:179], v95, s[36:39], s52 offen offset:0
	ds_read_b64_tr_b16 a[214:215], v53 offset:34816
	v_mfma_f32_16x16x32_bf16 v[208:211], a[232:235], a[136:139], v[208:211]
	ds_read_b64_tr_b16 a[216:217], v54 offset:32768
	v_mfma_f32_16x16x32_bf16 v[216:219], a[232:235], a[140:143], v[216:219]
	s_add_u32 s52, s52, 0x1000
	buffer_load_dwordx4 a[176:179], v95, s[36:39], s52 offen offset:0
	ds_read_b64_tr_b16 a[218:219], v54 offset:34816
	v_mfma_f32_16x16x32_bf16 v[212:215], a[236:239], a[136:139], v[212:215]
	ds_read_b64_tr_b16 a[220:221], v55 offset:32768
	v_mfma_f32_16x16x32_bf16 v[220:223], a[236:239], a[140:143], v[220:223]
	s_add_u32 s52, s52, 0x1000
	buffer_load_dwordx4 a[176:179], v95, s[36:39], s52 offen offset:0
	ds_read_b64_tr_b16 a[222:223], v55 offset:34816
	v_mfma_f32_16x16x32_bf16 v[224:227], a[240:243], a[136:139], v[224:227]
	ds_read_b64_tr_b16 a[224:225], v48 offset:33024
	v_mfma_f32_16x16x32_bf16 v[232:235], a[240:243], a[140:143], v[232:235]
	ds_read_b64_tr_b16 a[226:227], v48 offset:35072
	s_waitcnt lgkmcnt(15)
	v_mfma_f32_16x16x32_bf16 v[228:231], a[244:247], a[136:139], v[228:231]
	ds_read_b64_tr_b16 a[228:229], v49 offset:33024
	v_mfma_f32_16x16x32_bf16 v[236:239], a[244:247], a[140:143], v[236:239]
	ds_read_b64_tr_b16 a[230:231], v49 offset:35072
	v_mfma_f32_16x16x32_bf16 v[240:243], a[248:251], a[136:139], v[240:243]
	ds_read_b64_tr_b16 a[232:233], v50 offset:33024
	v_mfma_f32_16x16x32_bf16 v[248:251], a[248:251], a[140:143], v[248:251]
	ds_read_b64_tr_b16 a[234:235], v50 offset:35072
	v_mfma_f32_16x16x32_bf16 v[244:247], a[252:255], a[136:139], v[244:247]
	ds_read_b64_tr_b16 a[236:237], v51 offset:33024
	v_mfma_f32_16x16x32_bf16 v[252:255], a[252:255], a[140:143], v[252:255]
	ds_read_b64_tr_b16 a[238:239], v51 offset:35072
	v_mfma_f32_16x16x32_bf16 v[128:131], a[192:195], a[144:147], v[128:131]
	ds_read_b64_tr_b16 a[240:241], v52 offset:33024
	s_waitcnt lgkmcnt(13)
	v_mfma_f32_16x16x32_bf16 v[136:139], a[192:195], a[148:151], v[136:139]
	ds_read_b64_tr_b16 a[242:243], v52 offset:35072
	v_mfma_f32_16x16x32_bf16 v[132:135], a[196:199], a[144:147], v[132:135]
	ds_read_b64_tr_b16 a[244:245], v53 offset:33024
	v_mfma_f32_16x16x32_bf16 v[140:143], a[196:199], a[148:151], v[140:143]
	ds_read_b64_tr_b16 a[246:247], v53 offset:35072
	v_mfma_f32_16x16x32_bf16 v[144:147], a[200:203], a[144:147], v[144:147]
	ds_read_b64_tr_b16 a[248:249], v54 offset:33024
	v_mfma_f32_16x16x32_bf16 v[152:155], a[200:203], a[148:151], v[152:155]
	ds_read_b64_tr_b16 a[250:251], v54 offset:35072
	v_mfma_f32_16x16x32_bf16 v[148:151], a[204:207], a[144:147], v[148:151]
	s_waitcnt vmcnt(20)
	s_barrier
	ds_read_b64_tr_b16 a[252:253], v55 offset:33024
	v_mfma_f32_16x16x32_bf16 v[156:159], a[204:207], a[148:151], v[156:159]
	s_add_u32 m0, s45, 0x8000
	s_add_u32 s50, s50, 0x4000
	buffer_load_dwordx4 v36, s[24:27], s50 offen offset:0 nt lds
	ds_read_b64_tr_b16 a[254:255], v55 offset:35072
	v_mfma_f32_16x16x32_bf16 v[160:163], a[208:211], a[144:147], v[160:163]
	ds_read_b64_tr_b16 a[192:193], v48 offset:49152
	v_mfma_f32_16x16x32_bf16 v[168:171], a[208:211], a[148:151], v[168:171]
	buffer_load_dwordx4 v37, s[24:27], s50 offen offset:1024 nt lds
	ds_read_b64_tr_b16 a[194:195], v48 offset:51200
	v_mfma_f32_16x16x32_bf16 v[164:167], a[212:215], a[144:147], v[164:167]
	ds_read_b64_tr_b16 a[196:197], v49 offset:49152
	v_mfma_f32_16x16x32_bf16 v[172:175], a[212:215], a[148:151], v[172:175]
	buffer_load_dwordx4 v38, s[24:27], s50 offen offset:2048 nt lds
	ds_read_b64_tr_b16 a[198:199], v49 offset:51200
	s_waitcnt lgkmcnt(12)
	v_mfma_f32_16x16x32_bf16 v[176:179], a[216:219], a[144:147], v[176:179]
	ds_read_b64_tr_b16 a[200:201], v50 offset:49152
	v_mfma_f32_16x16x32_bf16 v[184:187], a[216:219], a[148:151], v[184:187]
	buffer_load_dwordx4 v39, s[24:27], s50 offen offset:3072 nt lds
	ds_read_b64_tr_b16 a[202:203], v50 offset:51200
	v_mfma_f32_16x16x32_bf16 v[180:183], a[220:223], a[144:147], v[180:183]
	ds_read_b64_tr_b16 a[204:205], v51 offset:49152
	v_mfma_f32_16x16x32_bf16 v[188:191], a[220:223], a[148:151], v[188:191]
	ds_read_b64_tr_b16 a[206:207], v51 offset:51200
	v_mfma_f32_16x16x32_bf16 v[192:195], a[224:227], a[144:147], v[192:195]
	ds_read_b64_tr_b16 a[208:209], v52 offset:49152
	v_mfma_f32_16x16x32_bf16 v[200:203], a[224:227], a[148:151], v[200:203]
	ds_read_b64_tr_b16 a[210:211], v52 offset:51200
	v_mfma_f32_16x16x32_bf16 v[196:199], a[228:231], a[144:147], v[196:199]
	ds_read_b64_tr_b16 a[212:213], v53 offset:49152
	v_mfma_f32_16x16x32_bf16 v[204:207], a[228:231], a[148:151], v[204:207]
	ds_read_b64_tr_b16 a[214:215], v53 offset:51200
	v_mfma_f32_16x16x32_bf16 v[208:211], a[232:235], a[144:147], v[208:211]
	ds_read_b64_tr_b16 a[216:217], v54 offset:49152
	v_mfma_f32_16x16x32_bf16 v[216:219], a[232:235], a[148:151], v[216:219]
	ds_read_b64_tr_b16 a[218:219], v54 offset:51200
	v_mfma_f32_16x16x32_bf16 v[212:215], a[236:239], a[144:147], v[212:215]
	ds_read_b64_tr_b16 a[220:221], v55 offset:49152
	v_mfma_f32_16x16x32_bf16 v[220:223], a[236:239], a[148:151], v[220:223]
	ds_read_b64_tr_b16 a[222:223], v55 offset:51200
	s_waitcnt lgkmcnt(13)
	v_mfma_f32_16x16x32_bf16 v[224:227], a[240:243], a[144:147], v[224:227]
	ds_read_b64_tr_b16 a[224:225], v48 offset:49408
	v_mfma_f32_16x16x32_bf16 v[232:235], a[240:243], a[148:151], v[232:235]
	ds_read_b64_tr_b16 a[226:227], v48 offset:51456
	v_mfma_f32_16x16x32_bf16 v[228:231], a[244:247], a[144:147], v[228:231]
	ds_read_b64_tr_b16 a[228:229], v49 offset:49408
	v_mfma_f32_16x16x32_bf16 v[236:239], a[244:247], a[148:151], v[236:239]
	ds_read_b64_tr_b16 a[230:231], v49 offset:51456
	v_mfma_f32_16x16x32_bf16 v[240:243], a[248:251], a[144:147], v[240:243]
	ds_read_b64_tr_b16 a[232:233], v50 offset:49408
	v_mfma_f32_16x16x32_bf16 v[248:251], a[248:251], a[148:151], v[248:251]
	ds_read_b64_tr_b16 a[234:235], v50 offset:51456
	v_mfma_f32_16x16x32_bf16 v[244:247], a[252:255], a[144:147], v[244:247]
	ds_read_b64_tr_b16 a[236:237], v51 offset:49408
	v_mfma_f32_16x16x32_bf16 v[252:255], a[252:255], a[148:151], v[252:255]
	ds_read_b64_tr_b16 a[238:239], v51 offset:51456
	v_mfma_f32_16x16x32_bf16 v[128:131], a[192:195], a[152:155], v[128:131]
	ds_read_b64_tr_b16 a[240:241], v52 offset:49408
	v_mfma_f32_16x16x32_bf16 v[136:139], a[192:195], a[156:159], v[136:139]
	ds_read_b64_tr_b16 a[242:243], v52 offset:51456
	s_waitcnt lgkmcnt(13)
	v_mfma_f32_16x16x32_bf16 v[132:135], a[196:199], a[152:155], v[132:135]
	ds_read_b64_tr_b16 a[244:245], v53 offset:49408
	v_mfma_f32_16x16x32_bf16 v[140:143], a[196:199], a[156:159], v[140:143]
	ds_read_b64_tr_b16 a[246:247], v53 offset:51456
	v_mfma_f32_16x16x32_bf16 v[144:147], a[200:203], a[152:155], v[144:147]
	ds_read_b64_tr_b16 a[248:249], v54 offset:49408
	v_mfma_f32_16x16x32_bf16 v[152:155], a[200:203], a[156:159], v[152:155]
	ds_read_b64_tr_b16 a[250:251], v54 offset:51456
	v_mfma_f32_16x16x32_bf16 v[148:151], a[204:207], a[152:155], v[148:151]
	s_waitcnt vmcnt(8)
	s_barrier
	ds_read_b64_tr_b16 a[252:253], v55 offset:49408
	v_mfma_f32_16x16x32_bf16 v[156:159], a[204:207], a[156:159], v[156:159]
	s_add_u32 m0, s45, 0x14000
	s_add_u32 s51, s51, 0x4000
	buffer_load_dwordx4 v40, s[28:31], s51 offen offset:0 nt lds
	ds_read_b64_tr_b16 a[254:255], v55 offset:51456
	v_mfma_f32_16x16x32_bf16 v[160:163], a[208:211], a[152:155], v[160:163]
	ds_read_b64_tr_b16 a[192:193], v56 offset:0
	v_mfma_f32_16x16x32_bf16 v[168:171], a[208:211], a[156:159], v[168:171]
	buffer_load_dwordx4 v41, s[28:31], s51 offen offset:1024 nt lds
	ds_read_b64_tr_b16 a[194:195], v56 offset:2048
	v_mfma_f32_16x16x32_bf16 v[164:167], a[212:215], a[152:155], v[164:167]
	ds_read_b64_tr_b16 a[196:197], v56 offset:16384
	v_mfma_f32_16x16x32_bf16 v[172:175], a[212:215], a[156:159], v[172:175]
	buffer_load_dwordx4 v42, s[28:31], s51 offen offset:2048 nt lds
	ds_read_b64_tr_b16 a[198:199], v56 offset:18432
	s_waitcnt lgkmcnt(12)
	v_mfma_f32_16x16x32_bf16 v[176:179], a[216:219], a[152:155], v[176:179]
	ds_read_b64_tr_b16 a[200:201], v57 offset:0
	v_mfma_f32_16x16x32_bf16 v[184:187], a[216:219], a[156:159], v[184:187]
	buffer_load_dwordx4 v43, s[28:31], s51 offen offset:3072 nt lds
	ds_read_b64_tr_b16 a[202:203], v57 offset:2048
	v_mfma_f32_16x16x32_bf16 v[180:183], a[220:223], a[152:155], v[180:183]
	ds_read_b128 a[160:163], v72 offset:49152
	ds_read_b64_tr_b16 a[204:205], v57 offset:16384
	v_mfma_f32_16x16x32_bf16 v[188:191], a[220:223], a[156:159], v[188:191]
	ds_read_b64_tr_b16 a[206:207], v57 offset:18432
	v_mfma_f32_16x16x32_bf16 v[192:195], a[224:227], a[152:155], v[192:195]
	ds_read_b128 a[164:167], v72 offset:51200
	ds_read_b64_tr_b16 a[208:209], v58 offset:0
	v_mfma_f32_16x16x32_bf16 v[200:203], a[224:227], a[156:159], v[200:203]
	ds_read_b64_tr_b16 a[210:211], v58 offset:2048
	v_mfma_f32_16x16x32_bf16 v[196:199], a[228:231], a[152:155], v[196:199]
	ds_read_b128 a[168:171], v73 offset:49152
	ds_read_b64_tr_b16 a[212:213], v58 offset:16384
	v_mfma_f32_16x16x32_bf16 v[204:207], a[228:231], a[156:159], v[204:207]
	ds_read_b64_tr_b16 a[214:215], v58 offset:18432
	v_mfma_f32_16x16x32_bf16 v[208:211], a[232:235], a[152:155], v[208:211]
	ds_read_b128 a[172:175], v73 offset:51200
	ds_read_b64_tr_b16 a[216:217], v59 offset:0
	v_mfma_f32_16x16x32_bf16 v[216:219], a[232:235], a[156:159], v[216:219]
	ds_read_b64_tr_b16 a[218:219], v59 offset:2048
	v_mfma_f32_16x16x32_bf16 v[212:215], a[236:239], a[152:155], v[212:215]
	ds_read_b64_tr_b16 a[220:221], v59 offset:16384
	v_mfma_f32_16x16x32_bf16 v[220:223], a[236:239], a[156:159], v[220:223]
	ds_read_b64_tr_b16 a[222:223], v59 offset:18432
	s_waitcnt lgkmcnt(15)
	v_mfma_f32_16x16x32_bf16 v[224:227], a[240:243], a[152:155], v[224:227]
	ds_read_b64_tr_b16 a[224:225], v60 offset:0
	v_mfma_f32_16x16x32_bf16 v[232:235], a[240:243], a[156:159], v[232:235]
	ds_read_b64_tr_b16 a[226:227], v60 offset:2048
	v_mfma_f32_16x16x32_bf16 v[228:231], a[244:247], a[152:155], v[228:231]
	ds_read_b64_tr_b16 a[228:229], v60 offset:16384
	v_mfma_f32_16x16x32_bf16 v[236:239], a[244:247], a[156:159], v[236:239]
	ds_read_b64_tr_b16 a[230:231], v60 offset:18432
	v_mfma_f32_16x16x32_bf16 v[240:243], a[248:251], a[152:155], v[240:243]
	ds_read_b64_tr_b16 a[232:233], v61 offset:0
	v_mfma_f32_16x16x32_bf16 v[248:251], a[248:251], a[156:159], v[248:251]
	ds_read_b64_tr_b16 a[234:235], v61 offset:2048
	v_mfma_f32_16x16x32_bf16 v[244:247], a[252:255], a[152:155], v[244:247]
	ds_read_b64_tr_b16 a[236:237], v61 offset:16384
	v_mfma_f32_16x16x32_bf16 v[252:255], a[252:255], a[156:159], v[252:255]
	ds_read_b64_tr_b16 a[238:239], v61 offset:18432
	s_waitcnt lgkmcnt(14)
	v_mfma_f32_16x16x32_bf16 v[128:131], a[192:195], a[160:163], v[128:131]
	ds_read_b64_tr_b16 a[240:241], v62 offset:0
	v_mfma_f32_16x16x32_bf16 v[136:139], a[192:195], a[164:167], v[136:139]
	ds_read_b64_tr_b16 a[242:243], v62 offset:2048
	v_mfma_f32_16x16x32_bf16 v[128:131], a[196:199], a[168:171], v[128:131]
	ds_read_b64_tr_b16 a[244:245], v62 offset:16384
	s_waitcnt lgkmcnt(13)
	v_mfma_f32_16x16x32_bf16 v[136:139], a[196:199], a[172:175], v[136:139]
	ds_read_b64_tr_b16 a[246:247], v62 offset:18432
	v_mfma_f32_16x16x32_bf16 v[132:135], a[200:203], a[160:163], v[132:135]
	ds_read_b64_tr_b16 a[248:249], v63 offset:0
	v_mfma_f32_16x16x32_bf16 v[140:143], a[200:203], a[164:167], v[140:143]
	ds_read_b64_tr_b16 a[250:251], v63 offset:2048
	v_mfma_f32_16x16x32_bf16 v[132:135], a[204:207], a[168:171], v[132:135]
	ds_read_b64_tr_b16 a[252:253], v63 offset:16384
	v_mfma_f32_16x16x32_bf16 v[140:143], a[204:207], a[172:175], v[140:143]
	ds_read_b64_tr_b16 a[254:255], v63 offset:18432
	v_mfma_f32_16x16x32_bf16 v[144:147], a[208:211], a[160:163], v[144:147]
	ds_read_b64_tr_b16 a[192:193], v56 offset:256
	v_mfma_f32_16x16x32_bf16 v[152:155], a[208:211], a[164:167], v[152:155]
	ds_read_b64_tr_b16 a[194:195], v56 offset:2304
	v_mfma_f32_16x16x32_bf16 v[144:147], a[212:215], a[168:171], v[144:147]
	ds_read_b64_tr_b16 a[196:197], v56 offset:16640
	v_mul_f32 v128, s48, v128
	v_mfma_f32_16x16x32_bf16 v[152:155], a[212:215], a[172:175], v[152:155]
	ds_read_b64_tr_b16 a[198:199], v56 offset:18688
	v_mul_f32 v129, s48, v129
	v_mfma_f32_16x16x32_bf16 v[148:151], a[216:219], a[160:163], v[148:151]
	ds_read_b64_tr_b16 a[200:201], v57 offset:256
	v_mul_f32 v130, s48, v130
	v_mfma_f32_16x16x32_bf16 v[156:159], a[216:219], a[164:167], v[156:159]
	ds_read_b64_tr_b16 a[202:203], v57 offset:2304
	v_mul_f32 v131, s48, v131
	s_waitcnt lgkmcnt(13)
	v_mfma_f32_16x16x32_bf16 v[148:151], a[220:223], a[168:171], v[148:151]
	ds_read_b64_tr_b16 a[204:205], v57 offset:16640
	v_mul_f32 v132, s48, v132
	v_mfma_f32_16x16x32_bf16 v[156:159], a[220:223], a[172:175], v[156:159]
	ds_read_b64_tr_b16 a[206:207], v57 offset:18688
	v_mul_f32 v133, s48, v133
	v_mfma_f32_16x16x32_bf16 v[160:163], a[224:227], a[160:163], v[160:163]
	ds_read_b64_tr_b16 a[208:209], v58 offset:256
	v_mul_f32 v134, s48, v134
	v_mfma_f32_16x16x32_bf16 v[168:171], a[224:227], a[164:167], v[168:171]
	ds_read_b64_tr_b16 a[210:211], v58 offset:2304
	v_mul_f32 v135, s48, v135
	v_mfma_f32_16x16x32_bf16 v[160:163], a[228:231], a[168:171], v[160:163]
	ds_read_b64_tr_b16 a[212:213], v58 offset:16640
	v_cvt_pk_bf16_f32 v128, v128, v129
	v_mfma_f32_16x16x32_bf16 v[168:171], a[228:231], a[172:175], v[168:171]
	ds_read_b64_tr_b16 a[214:215], v58 offset:18688
	v_cvt_pk_bf16_f32 v129, v130, v131
	v_mfma_f32_16x16x32_bf16 v[164:167], a[232:235], a[160:163], v[164:167]
	ds_read_b64_tr_b16 a[216:217], v59 offset:256
	v_cvt_pk_bf16_f32 v130, v132, v133
	v_mfma_f32_16x16x32_bf16 v[172:175], a[232:235], a[164:167], v[172:175]
	ds_read_b64_tr_b16 a[218:219], v59 offset:2304
	v_cvt_pk_bf16_f32 v131, v134, v135
	v_mfma_f32_16x16x32_bf16 v[164:167], a[236:239], a[168:171], v[164:167]
	ds_read_b64_tr_b16 a[220:221], v59 offset:16640
	v_mul_f32 v136, s48, v136
	v_mfma_f32_16x16x32_bf16 v[172:175], a[236:239], a[172:175], v[172:175]
	ds_read_b64_tr_b16 a[222:223], v59 offset:18688
	v_mul_f32 v137, s48, v137
	s_waitcnt lgkmcnt(12)
	v_mfma_f32_16x16x32_bf16 v[176:179], a[240:243], a[160:163], v[176:179]
	ds_read_b64_tr_b16 a[224:225], v60 offset:256
	v_mul_f32 v138, s48, v138
	v_mfma_f32_16x16x32_bf16 v[184:187], a[240:243], a[164:167], v[184:187]
	ds_read_b64_tr_b16 a[226:227], v60 offset:2304
	v_mul_f32 v139, s48, v139
	v_mfma_f32_16x16x32_bf16 v[176:179], a[244:247], a[168:171], v[176:179]
	ds_read_b64_tr_b16 a[228:229], v60 offset:16640
	v_mul_f32 v140, s48, v140
	v_mfma_f32_16x16x32_bf16 v[184:187], a[244:247], a[172:175], v[184:187]
	ds_read_b64_tr_b16 a[230:231], v60 offset:18688
	v_mul_f32 v141, s48, v141
	v_mfma_f32_16x16x32_bf16 v[180:183], a[248:251], a[160:163], v[180:183]
	ds_read_b64_tr_b16 a[232:233], v61 offset:256
	v_mul_f32 v142, s48, v142
	v_mfma_f32_16x16x32_bf16 v[188:191], a[248:251], a[164:167], v[188:191]
	ds_read_b64_tr_b16 a[234:235], v61 offset:2304
	v_mul_f32 v143, s48, v143
	v_mfma_f32_16x16x32_bf16 v[180:183], a[252:255], a[168:171], v[180:183]
	ds_read_b64_tr_b16 a[236:237], v61 offset:16640
	v_cvt_pk_bf16_f32 v136, v136, v137
	v_mfma_f32_16x16x32_bf16 v[188:191], a[252:255], a[172:175], v[188:191]
	ds_read_b64_tr_b16 a[238:239], v61 offset:18688
	v_cvt_pk_bf16_f32 v137, v138, v139
	v_mfma_f32_16x16x32_bf16 v[192:195], a[192:195], a[160:163], v[192:195]
	ds_read_b64_tr_b16 a[240:241], v62 offset:256
	v_cvt_pk_bf16_f32 v138, v140, v141
	v_mfma_f32_16x16x32_bf16 v[200:203], a[192:195], a[164:167], v[200:203]
	ds_read_b64_tr_b16 a[242:243], v62 offset:2304
	v_cvt_pk_bf16_f32 v139, v142, v143
	v_mfma_f32_16x16x32_bf16 v[192:195], a[196:199], a[168:171], v[192:195]
	ds_read_b64_tr_b16 a[244:245], v62 offset:16640
	v_permlane32_swap_b32 v128, v130
	v_mfma_f32_16x16x32_bf16 v[200:203], a[196:199], a[172:175], v[200:203]
	ds_read_b64_tr_b16 a[246:247], v62 offset:18688
	v_permlane32_swap_b32 v129, v131
	s_waitcnt lgkmcnt(12)
	v_mfma_f32_16x16x32_bf16 v[196:199], a[200:203], a[160:163], v[196:199]
	ds_read_b64_tr_b16 a[248:249], v63 offset:256
	v_permlane32_swap_b32 v136, v138
	v_mfma_f32_16x16x32_bf16 v[204:207], a[200:203], a[164:167], v[204:207]
	ds_read_b64_tr_b16 a[250:251], v63 offset:2304
	v_permlane32_swap_b32 v137, v139
	v_mfma_f32_16x16x32_bf16 v[196:199], a[204:207], a[168:171], v[196:199]
	ds_read_b64_tr_b16 a[252:253], v63 offset:16640
	v_permlane16_swap_b32 v128, v130
	v_mfma_f32_16x16x32_bf16 v[204:207], a[204:207], a[172:175], v[204:207]
	ds_read_b64_tr_b16 a[254:255], v63 offset:18688
	v_permlane16_swap_b32 v129, v131
	v_mfma_f32_16x16x32_bf16 v[208:211], a[208:211], a[160:163], v[208:211]
	v_permlane16_swap_b32 v136, v138
	v_permlane16_swap_b32 v137, v139
	v_mfma_f32_16x16x32_bf16 v[216:219], a[208:211], a[164:167], v[216:219]
	v_accvgpr_write_b32 a0, v128
	v_accvgpr_write_b32 a1, v129
	v_mfma_f32_16x16x32_bf16 v[208:211], a[212:215], a[168:171], v[208:211]
	v_accvgpr_write_b32 a2, v130
	v_accvgpr_write_b32 a3, v131
	v_mfma_f32_16x16x32_bf16 v[216:219], a[212:215], a[172:175], v[216:219]
	v_accvgpr_write_b32 a4, v136
	v_accvgpr_write_b32 a5, v137
	v_mfma_f32_16x16x32_bf16 v[212:215], a[216:219], a[160:163], v[212:215]
	v_accvgpr_write_b32 a6, v138
	v_accvgpr_write_b32 a7, v139
	v_mul_f32 v144, s48, v144
	v_mfma_f32_16x16x32_bf16 v[220:223], a[216:219], a[164:167], v[220:223]
	v_mul_f32 v145, s48, v145
	v_mul_f32 v146, s48, v146
	v_mul_f32 v147, s48, v147
	v_mfma_f32_16x16x32_bf16 v[212:215], a[220:223], a[168:171], v[212:215]
	s_barrier
	v_mul_f32 v148, s48, v148
	v_mul_f32 v149, s48, v149
	v_mul_f32 v150, s48, v150
	v_mfma_f32_16x16x32_bf16 v[220:223], a[220:223], a[172:175], v[220:223]
	s_add_u32 m0, s45, 0xc000
	s_add_u32 s50, s50, 0x4000
	buffer_load_dwordx4 v36, s[24:27], s50 offen offset:0 nt lds
	ds_read_b128 a[64:67], v12 offset:0
	v_mul_f32 v151, s48, v151
	s_waitcnt lgkmcnt(4)
	v_mfma_f32_16x16x32_bf16 v[224:227], a[224:227], a[160:163], v[224:227]
	ds_read_b128 a[68:71], v12 offset:8192
	v_cvt_pk_bf16_f32 v144, v144, v145
	v_cvt_pk_bf16_f32 v145, v146, v147
	v_mfma_f32_16x16x32_bf16 v[232:235], a[224:227], a[164:167], v[232:235]
	buffer_load_dwordx4 v37, s[24:27], s50 offen offset:1024 nt lds
	ds_read_b128 a[72:75], v13 offset:0
	v_cvt_pk_bf16_f32 v146, v148, v149
	v_mfma_f32_16x16x32_bf16 v[224:227], a[228:231], a[168:171], v[224:227]
	ds_read_b128 a[76:79], v13 offset:8192
	v_cvt_pk_bf16_f32 v147, v150, v151
	v_mul_f32 v152, s48, v152
	v_mfma_f32_16x16x32_bf16 v[232:235], a[228:231], a[172:175], v[232:235]
	buffer_load_dwordx4 v38, s[24:27], s50 offen offset:2048 nt lds
	ds_read_b128 a[80:83], v14 offset:0
	v_mul_f32 v153, s48, v153
	v_mfma_f32_16x16x32_bf16 v[228:231], a[232:235], a[160:163], v[228:231]
	ds_read_b128 a[84:87], v14 offset:8192
	v_mul_f32 v154, s48, v154
	v_mul_f32 v155, s48, v155
	v_mfma_f32_16x16x32_bf16 v[236:239], a[232:235], a[164:167], v[236:239]
	buffer_load_dwordx4 v39, s[24:27], s50 offen offset:3072 nt lds
	ds_read_b128 a[88:91], v15 offset:0
	v_mul_f32 v156, s48, v156
	v_mfma_f32_16x16x32_bf16 v[228:231], a[236:239], a[168:171], v[228:231]
	ds_read_b128 a[92:95], v15 offset:8192
	v_mul_f32 v157, s48, v157
	v_mul_f32 v158, s48, v158
	v_mfma_f32_16x16x32_bf16 v[236:239], a[236:239], a[172:175], v[236:239]
	ds_read_b128 a[96:99], v12 offset:256
	v_mul_f32 v159, s48, v159
	v_cvt_pk_bf16_f32 v152, v152, v153
	v_mfma_f32_16x16x32_bf16 v[240:243], a[240:243], a[160:163], v[240:243]
	ds_read_b128 a[100:103], v12 offset:8448
	v_cvt_pk_bf16_f32 v153, v154, v155
	v_cvt_pk_bf16_f32 v154, v156, v157
	v_mfma_f32_16x16x32_bf16 v[248:251], a[240:243], a[164:167], v[248:251]
	ds_read_b128 a[104:107], v13 offset:256
	v_cvt_pk_bf16_f32 v155, v158, v159
	v_permlane32_swap_b32 v144, v146
	v_mfma_f32_16x16x32_bf16 v[240:243], a[244:247], a[168:171], v[240:243]
	ds_read_b128 a[108:111], v13 offset:8448
	v_permlane32_swap_b32 v145, v147
	v_mfma_f32_16x16x32_bf16 v[248:251], a[244:247], a[172:175], v[248:251]
	ds_read_b128 a[112:115], v14 offset:256
	v_permlane32_swap_b32 v152, v154
	s_waitcnt lgkmcnt(11)
	v_mfma_f32_16x16x32_bf16 v[244:247], a[248:251], a[160:163], v[244:247]
	ds_read_b128 a[116:119], v14 offset:8448
	v_permlane32_swap_b32 v153, v155
	v_mfma_f32_16x16x32_bf16 v[252:255], a[248:251], a[164:167], v[252:255]
	ds_read_b128 a[120:123], v15 offset:256
	v_permlane16_swap_b32 v144, v146
	v_mfma_f32_16x16x32_bf16 v[244:247], a[252:255], a[168:171], v[244:247]
	ds_read_b128 a[124:127], v15 offset:8448
	v_permlane16_swap_b32 v145, v147
	v_mfma_f32_16x16x32_bf16 v[252:255], a[252:255], a[172:175], v[252:255]
	v_permlane16_swap_b32 v152, v154
	v_permlane16_swap_b32 v153, v155
	v_mfma_f32_16x16x32_bf16 v[96:99], a[64:67], a[0:3], 0
	v_accvgpr_write_b32 a8, v144
	v_accvgpr_write_b32 a9, v145
	v_mfma_f32_16x16x32_bf16 v[104:107], a[64:67], a[4:7], 0
	v_accvgpr_write_b32 a10, v146
	v_accvgpr_write_b32 a11, v147
	v_mfma_f32_16x16x32_bf16 v[100:103], a[68:71], a[0:3], 0
	v_accvgpr_write_b32 a12, v152
	v_accvgpr_write_b32 a13, v153
	v_mfma_f32_16x16x32_bf16 v[108:111], a[68:71], a[4:7], 0
	v_accvgpr_write_b32 a14, v154
	v_accvgpr_write_b32 a15, v155
	v_mul_f32 v160, s48, v160
	v_mul_f32 v161, s48, v161
	v_mul_f32 v162, s48, v162
	v_mul_f32 v163, s48, v163
	v_mul_f32 v164, s48, v164
	v_mul_f32 v165, s48, v165
	s_waitcnt lgkmcnt(6)
	v_mfma_f32_16x16x32_bf16 v[96:99], a[72:75], a[8:11], v[96:99]
	v_mul_f32 v166, s48, v166
	v_mul_f32 v167, s48, v167
	v_cvt_pk_bf16_f32 v160, v160, v161
	v_cvt_pk_bf16_f32 v161, v162, v163
	v_cvt_pk_bf16_f32 v162, v164, v165
	v_cvt_pk_bf16_f32 v163, v166, v167
	v_mul_f32 v168, s48, v168
	v_mul_f32 v169, s48, v169
	v_mfma_f32_16x16x32_bf16 v[104:107], a[72:75], a[12:15], v[104:107]
	v_mul_f32 v170, s48, v170
	v_mul_f32 v171, s48, v171
	v_mul_f32 v172, s48, v172
	v_mul_f32 v173, s48, v173
	v_mul_f32 v174, s48, v174
	v_mul_f32 v175, s48, v175
	v_cvt_pk_bf16_f32 v168, v168, v169
	v_mfma_f32_16x16x32_bf16 v[100:103], a[76:79], a[8:11], v[100:103]
	v_cvt_pk_bf16_f32 v169, v170, v171
	v_cvt_pk_bf16_f32 v170, v172, v173
	v_cvt_pk_bf16_f32 v171, v174, v175
	v_permlane32_swap_b32 v160, v162
	v_permlane32_swap_b32 v161, v163
	v_permlane32_swap_b32 v168, v170
	v_permlane32_swap_b32 v169, v171
	v_mfma_f32_16x16x32_bf16 v[108:111], a[76:79], a[12:15], v[108:111]
	v_permlane16_swap_b32 v160, v162
	v_permlane16_swap_b32 v161, v163
	v_permlane16_swap_b32 v168, v170
	v_permlane16_swap_b32 v169, v171
	v_accvgpr_write_b32 a16, v160
	v_accvgpr_write_b32 a17, v161
	v_accvgpr_write_b32 a18, v162
	v_accvgpr_write_b32 a19, v163
	v_accvgpr_write_b32 a20, v168
	v_accvgpr_write_b32 a21, v169
	v_accvgpr_write_b32 a22, v170
	v_accvgpr_write_b32 a23, v171
	v_mfma_f32_16x16x32_bf16 v[96:99], a[80:83], a[16:19], v[96:99]
	v_mul_f32 v176, s48, v176
	v_mul_f32 v177, s48, v177
	v_mul_f32 v178, s48, v178
	v_mul_f32 v179, s48, v179
	v_mul_f32 v180, s48, v180
	v_mul_f32 v181, s48, v181
	v_mul_f32 v182, s48, v182
	v_mul_f32 v183, s48, v183
	v_cvt_pk_bf16_f32 v176, v176, v177
	v_mfma_f32_16x16x32_bf16 v[104:107], a[80:83], a[20:23], v[104:107]
	v_cvt_pk_bf16_f32 v177, v178, v179
	v_cvt_pk_bf16_f32 v178, v180, v181
	v_cvt_pk_bf16_f32 v179, v182, v183
	v_mul_f32 v184, s48, v184
	v_mul_f32 v185, s48, v185
	v_mul_f32 v186, s48, v186
	v_mul_f32 v187, s48, v187
	v_mul_f32 v188, s48, v188
	v_mul_f32 v189, s48, v189
	v_mfma_f32_16x16x32_bf16 v[100:103], a[84:87], a[16:19], v[100:103]
	v_mul_f32 v190, s48, v190
	v_mul_f32 v191, s48, v191
	v_cvt_pk_bf16_f32 v184, v184, v185
	v_cvt_pk_bf16_f32 v185, v186, v187
	v_cvt_pk_bf16_f32 v186, v188, v189
	v_cvt_pk_bf16_f32 v187, v190, v191
	v_permlane32_swap_b32 v176, v178
	v_permlane32_swap_b32 v177, v179
	v_mfma_f32_16x16x32_bf16 v[108:111], a[84:87], a[20:23], v[108:111]
	v_permlane32_swap_b32 v184, v186
	v_permlane32_swap_b32 v185, v187
	v_permlane16_swap_b32 v176, v178
	v_permlane16_swap_b32 v177, v179
	v_permlane16_swap_b32 v184, v186
	v_permlane16_swap_b32 v185, v187
	v_accvgpr_write_b32 a24, v176
	v_accvgpr_write_b32 a25, v177
	v_accvgpr_write_b32 a26, v178
	v_accvgpr_write_b32 a27, v179
	v_accvgpr_write_b32 a28, v184
	v_accvgpr_write_b32 a29, v185
	v_accvgpr_write_b32 a30, v186
	v_accvgpr_write_b32 a31, v187
	v_mfma_f32_16x16x32_bf16 v[96:99], a[88:91], a[24:27], v[96:99]
	v_mul_f32 v192, s48, v192
	v_mul_f32 v193, s48, v193
	v_mul_f32 v194, s48, v194
	v_mul_f32 v195, s48, v195
	v_mul_f32 v196, s48, v196
	v_mul_f32 v197, s48, v197
	v_mul_f32 v198, s48, v198
	v_mul_f32 v199, s48, v199
	v_cvt_pk_bf16_f32 v192, v192, v193
	v_mfma_f32_16x16x32_bf16 v[104:107], a[88:91], a[28:31], v[104:107]
	v_cvt_pk_bf16_f32 v193, v194, v195
	v_cvt_pk_bf16_f32 v194, v196, v197
	v_cvt_pk_bf16_f32 v195, v198, v199
	v_mul_f32 v200, s48, v200
	v_mul_f32 v201, s48, v201
	v_mul_f32 v202, s48, v202
	v_mul_f32 v203, s48, v203
	v_mul_f32 v204, s48, v204
	v_mul_f32 v205, s48, v205
	v_mfma_f32_16x16x32_bf16 v[100:103], a[92:95], a[24:27], v[100:103]
	v_mul_f32 v206, s48, v206
	v_mul_f32 v207, s48, v207
	v_cvt_pk_bf16_f32 v200, v200, v201
	v_cvt_pk_bf16_f32 v201, v202, v203
	v_cvt_pk_bf16_f32 v202, v204, v205
	v_cvt_pk_bf16_f32 v203, v206, v207
	v_permlane32_swap_b32 v192, v194
	v_permlane32_swap_b32 v193, v195
	v_permlane32_swap_b32 v200, v202
	v_mfma_f32_16x16x32_bf16 v[108:111], a[92:95], a[28:31], v[108:111]
	ds_read_b128 a[64:67], v12 offset:16384
	v_permlane32_swap_b32 v201, v203
	v_permlane16_swap_b32 v192, v194
	v_permlane16_swap_b32 v193, v195
	v_permlane16_swap_b32 v200, v202
	v_permlane16_swap_b32 v201, v203
	v_accvgpr_write_b32 a32, v192
	v_accvgpr_write_b32 a33, v193
	v_accvgpr_write_b32 a34, v194
	v_accvgpr_write_b32 a35, v195
	v_accvgpr_write_b32 a36, v200
	v_accvgpr_write_b32 a37, v201
	v_accvgpr_write_b32 a38, v202
	v_accvgpr_write_b32 a39, v203
	v_mfma_f32_16x16x32_bf16 v[96:99], a[96:99], a[32:35], v[96:99]
	s_add_u32 m0, s45, 0x18000
	s_add_u32 s51, s51, 0x4000
	buffer_load_dwordx4 v40, s[28:31], s51 offen offset:0 nt lds
	ds_read_b128 a[68:71], v12 offset:24576
	v_mul_f32 v208, s48, v208
	v_mul_f32 v209, s48, v209
	v_mul_f32 v210, s48, v210
	v_mul_f32 v211, s48, v211
	v_mul_f32 v212, s48, v212
	v_mul_f32 v213, s48, v213
	v_mul_f32 v214, s48, v214
	v_mul_f32 v215, s48, v215
	v_mfma_f32_16x16x32_bf16 v[104:107], a[96:99], a[36:39], v[104:107]
	ds_read_b128 a[72:75], v13 offset:16384
	v_cvt_pk_bf16_f32 v208, v208, v209
	v_cvt_pk_bf16_f32 v209, v210, v211
	v_cvt_pk_bf16_f32 v210, v212, v213
	v_cvt_pk_bf16_f32 v211, v214, v215
	v_mul_f32 v216, s48, v216
	v_mul_f32 v217, s48, v217
	v_mul_f32 v218, s48, v218
	v_mul_f32 v219, s48, v219
	v_mul_f32 v220, s48, v220
	v_mfma_f32_16x16x32_bf16 v[100:103], a[100:103], a[32:35], v[100:103]
	buffer_load_dwordx4 v41, s[28:31], s51 offen offset:1024 nt lds
	ds_read_b128 a[76:79], v13 offset:24576
	v_mul_f32 v221, s48, v221
	v_mul_f32 v222, s48, v222
	v_mul_f32 v223, s48, v223
	v_cvt_pk_bf16_f32 v216, v216, v217
	v_cvt_pk_bf16_f32 v217, v218, v219
	v_cvt_pk_bf16_f32 v218, v220, v221
	v_cvt_pk_bf16_f32 v219, v222, v223
	v_permlane32_swap_b32 v208, v210
	v_mfma_f32_16x16x32_bf16 v[108:111], a[100:103], a[36:39], v[108:111]
	ds_read_b128 a[80:83], v14 offset:16384
	v_permlane32_swap_b32 v209, v211
	v_permlane32_swap_b32 v216, v218
	v_permlane32_swap_b32 v217, v219
	v_permlane16_swap_b32 v208, v210
	v_permlane16_swap_b32 v209, v211
	v_permlane16_swap_b32 v216, v218
	v_permlane16_swap_b32 v217, v219
	v_accvgpr_write_b32 a40, v208
	v_accvgpr_write_b32 a41, v209
	v_accvgpr_write_b32 a42, v210
	v_accvgpr_write_b32 a43, v211
	v_accvgpr_write_b32 a44, v216
	v_accvgpr_write_b32 a45, v217
	v_accvgpr_write_b32 a46, v218
	v_accvgpr_write_b32 a47, v219
	s_waitcnt lgkmcnt(3)
	v_mfma_f32_16x16x32_bf16 v[96:99], a[104:107], a[40:43], v[96:99]
	buffer_load_dwordx4 v42, s[28:31], s51 offen offset:2048 nt lds
	ds_read_b128 a[84:87], v14 offset:24576
	v_mul_f32 v224, s48, v224
	v_mul_f32 v225, s48, v225
	v_mul_f32 v226, s48, v226
	v_mul_f32 v227, s48, v227
	v_mul_f32 v228, s48, v228
	v_mul_f32 v229, s48, v229
	v_mul_f32 v230, s48, v230
	v_mul_f32 v231, s48, v231
	v_mfma_f32_16x16x32_bf16 v[104:107], a[104:107], a[44:47], v[104:107]
	ds_read_b128 a[88:91], v15 offset:16384
	v_cvt_pk_bf16_f32 v224, v224, v225
	v_cvt_pk_bf16_f32 v225, v226, v227
	v_cvt_pk_bf16_f32 v226, v228, v229
	v_cvt_pk_bf16_f32 v227, v230, v231
	v_mul_f32 v232, s48, v232
	v_mul_f32 v233, s48, v233
	v_mul_f32 v234, s48, v234
	v_mul_f32 v235, s48, v235
	v_mul_f32 v236, s48, v236
	v_mfma_f32_16x16x32_bf16 v[100:103], a[108:111], a[40:43], v[100:103]
	buffer_load_dwordx4 v43, s[28:31], s51 offen offset:3072 nt lds
	ds_read_b128 a[92:95], v15 offset:24576
	v_mul_f32 v237, s48, v237
	v_mul_f32 v238, s48, v238
	v_mul_f32 v239, s48, v239
	v_cvt_pk_bf16_f32 v232, v232, v233
	v_cvt_pk_bf16_f32 v233, v234, v235
	v_cvt_pk_bf16_f32 v234, v236, v237
	v_cvt_pk_bf16_f32 v235, v238, v239
	v_permlane32_swap_b32 v224, v226
	v_mfma_f32_16x16x32_bf16 v[108:111], a[108:111], a[44:47], v[108:111]
	ds_read_b128 a[96:99], v12 offset:16640
	v_permlane32_swap_b32 v225, v227
	v_permlane32_swap_b32 v232, v234
	v_permlane32_swap_b32 v233, v235
	v_permlane16_swap_b32 v224, v226
	v_permlane16_swap_b32 v225, v227
	v_permlane16_swap_b32 v232, v234
	v_permlane16_swap_b32 v233, v235
	v_accvgpr_write_b32 a48, v224
	v_accvgpr_write_b32 a49, v225
	v_accvgpr_write_b32 a50, v226
	v_accvgpr_write_b32 a51, v227
	v_accvgpr_write_b32 a52, v232
	v_accvgpr_write_b32 a53, v233
	v_accvgpr_write_b32 a54, v234
	v_accvgpr_write_b32 a55, v235
	v_mfma_f32_16x16x32_bf16 v[96:99], a[112:115], a[48:51], v[96:99]
	ds_read_b128 a[100:103], v12 offset:24832
	v_mul_f32 v240, s48, v240
	v_mul_f32 v241, s48, v241
	v_mul_f32 v242, s48, v242
	v_mul_f32 v243, s48, v243
	v_mul_f32 v244, s48, v244
	v_mul_f32 v245, s48, v245
	v_mul_f32 v246, s48, v246
	v_mul_f32 v247, s48, v247
	v_cvt_pk_bf16_f32 v240, v240, v241
	v_mfma_f32_16x16x32_bf16 v[104:107], a[112:115], a[52:55], v[104:107]
	ds_read_b128 a[104:107], v13 offset:16640
	v_cvt_pk_bf16_f32 v241, v242, v243
	v_cvt_pk_bf16_f32 v242, v244, v245
	v_cvt_pk_bf16_f32 v243, v246, v247
	v_mul_f32 v248, s48, v248
	v_mul_f32 v249, s48, v249
	v_mul_f32 v250, s48, v250
	v_mul_f32 v251, s48, v251
	v_mul_f32 v252, s48, v252
	v_mfma_f32_16x16x32_bf16 v[100:103], a[116:119], a[48:51], v[100:103]
	ds_read_b128 a[108:111], v13 offset:24832
	v_mul_f32 v253, s48, v253
	v_mul_f32 v254, s48, v254
	v_mul_f32 v255, s48, v255
	v_cvt_pk_bf16_f32 v248, v248, v249
	v_cvt_pk_bf16_f32 v249, v250, v251
	v_cvt_pk_bf16_f32 v250, v252, v253
	v_cvt_pk_bf16_f32 v251, v254, v255
	v_permlane32_swap_b32 v240, v242
	v_mfma_f32_16x16x32_bf16 v[108:111], a[116:119], a[52:55], v[108:111]
	ds_read_b128 a[112:115], v14 offset:16640
	v_permlane32_swap_b32 v241, v243
	v_permlane32_swap_b32 v248, v250
	v_permlane32_swap_b32 v249, v251
	v_permlane16_swap_b32 v240, v242
	v_permlane16_swap_b32 v241, v243
	v_permlane16_swap_b32 v248, v250
	v_permlane16_swap_b32 v249, v251
	v_accvgpr_write_b32 a56, v240
	v_accvgpr_write_b32 a57, v241
	v_accvgpr_write_b32 a58, v242
	v_accvgpr_write_b32 a59, v243
	v_accvgpr_write_b32 a60, v248
	v_accvgpr_write_b32 a61, v249
	v_accvgpr_write_b32 a62, v250
	v_accvgpr_write_b32 a63, v251
	v_mfma_f32_16x16x32_bf16 v[96:99], a[120:123], a[56:59], v[96:99]
	ds_read_b128 a[116:119], v14 offset:24832
	v_mfma_f32_16x16x32_bf16 v[104:107], a[120:123], a[60:63], v[104:107]
	v_mfma_f32_16x16x32_bf16 v[100:103], a[124:127], a[56:59], v[100:103]
	ds_read_b128 a[120:123], v15 offset:16640
	v_mfma_f32_16x16x32_bf16 v[108:111], a[124:127], a[60:63], v[108:111]
	v_mfma_f32_16x16x32_bf16 v[112:115], a[64:67], a[0:3], 0
	ds_read_b128 a[124:127], v15 offset:24832
	v_mfma_f32_16x16x32_bf16 v[120:123], a[64:67], a[4:7], 0
	v_mfma_f32_16x16x32_bf16 v[116:119], a[68:71], a[0:3], 0
	v_max3_f32 v6, v96, v97, v98
	v_max3_f32 v7, v104, v105, v106
	v_max3_f32 v6, v6, v99, v100
	s_nop 0
	v_max3_f32 v7, v7, v107, v108
	v_max3_f32 v6, v6, v101, v102
	v_mfma_f32_16x16x32_bf16 v[124:127], a[68:71], a[4:7], 0
	v_max3_f32 v7, v7, v109, v110
	v_max_f32 v6, v6, v103
	v_max_f32 v7, v7, v111
	v_mov_b32 v10, v6
	v_mov_b32 v11, v7
	s_waitcnt lgkmcnt(3)
	v_mfma_f32_16x16x32_bf16 v[112:115], a[72:75], a[8:11], v[112:115]
	v_permlane16_swap_b32 v6, v10
	v_permlane16_swap_b32 v7, v11
	v_max_f32 v6, v6, v10
	v_max_f32 v7, v7, v11
	v_mov_b32 v10, v6
	v_mfma_f32_16x16x32_bf16 v[120:123], a[72:75], a[12:15], v[120:123]
	v_mov_b32 v11, v7
	v_permlane32_swap_b32 v6, v10
	s_nop 0
	v_permlane32_swap_b32 v7, v11
	v_max_f32 v6, v6, v10
	v_mfma_f32_16x16x32_bf16 v[116:119], a[76:79], a[8:11], v[116:119]
	s_barrier
	v_max_f32 v7, v7, v11
	v_sub_f32 v96, v96, v6
	v_sub_f32 v97, v97, v6
	v_sub_f32 v98, v98, v6
	v_mfma_f32_16x16x32_bf16 v[124:127], a[76:79], a[12:15], v[124:127]
	v_exp_f32 v48, v96
	v_exp_f32 v49, v97
	v_mfma_f32_16x16x32_bf16 v[112:115], a[80:83], a[16:19], v[112:115]
	s_add_u32 m0, s45, 0x1c000
	s_add_u32 s51, s51, 0x4000
	ds_read_b64_tr_b16 a[192:193], v16 offset:0
	v_exp_f32 v50, v98
	v_sub_f32 v99, v99, v6
	v_mfma_f32_16x16x32_bf16 v[120:123], a[80:83], a[20:23], v[120:123]
	ds_read_b64_tr_b16 a[194:195], v16 offset:8192
	buffer_load_dwordx4 v40, s[28:31], s51 offen offset:0 nt lds
	v_exp_f32 v51, v99
	v_mfma_f32_16x16x32_bf16 v[116:119], a[84:87], a[16:19], v[116:119]
	ds_read_b64_tr_b16 a[196:197], v17 offset:0
	v_sub_f32 v100, v100, v6
	v_sub_f32 v101, v101, v6
	v_sub_f32 v102, v102, v6
	v_mfma_f32_16x16x32_bf16 v[124:127], a[84:87], a[20:23], v[124:127]
	ds_read_b64_tr_b16 a[198:199], v17 offset:8192
	buffer_load_dwordx4 v41, s[28:31], s51 offen offset:1024 nt lds
	v_exp_f32 v52, v100
	v_mfma_f32_16x16x32_bf16 v[112:115], a[88:91], a[24:27], v[112:115]
	ds_read_b64_tr_b16 a[200:201], v18 offset:0
	v_exp_f32 v53, v101
	v_exp_f32 v54, v102
	v_mfma_f32_16x16x32_bf16 v[120:123], a[88:91], a[28:31], v[120:123]
	ds_read_b64_tr_b16 a[202:203], v18 offset:8192
	buffer_load_dwordx4 v42, s[28:31], s51 offen offset:2048 nt lds
	v_sub_f32 v103, v103, v6
	v_sub_f32 v104, v104, v7
	v_mfma_f32_16x16x32_bf16 v[116:119], a[92:95], a[24:27], v[116:119]
	ds_read_b64_tr_b16 a[204:205], v19 offset:0
	v_exp_f32 v55, v103
	v_exp_f32 v56, v104
	v_mfma_f32_16x16x32_bf16 v[124:127], a[92:95], a[28:31], v[124:127]
	ds_read_b64_tr_b16 a[206:207], v19 offset:8192
	buffer_load_dwordx4 v43, s[28:31], s51 offen offset:3072 nt lds
	v_sub_f32 v105, v105, v7
	v_sub_f32 v106, v106, v7
	v_mfma_f32_16x16x32_bf16 v[112:115], a[96:99], a[32:35], v[112:115]
	s_add_u32 m0, s45, 0
	s_add_u32 s50, s50, 0x4000
	ds_read_b64_tr_b16 a[208:209], v20 offset:0
	v_exp_f32 v57, v105
	v_exp_f32 v58, v106
	v_mfma_f32_16x16x32_bf16 v[120:123], a[96:99], a[36:39], v[120:123]
	ds_read_b64_tr_b16 a[210:211], v20 offset:8192
	buffer_load_dwordx4 v36, s[24:27], s50 offen offset:0 nt lds
	v_sub_f32 v107, v107, v7
	v_sub_f32 v108, v108, v7
	v_mfma_f32_16x16x32_bf16 v[116:119], a[100:103], a[32:35], v[116:119]
	ds_read_b64_tr_b16 a[212:213], v21 offset:0
	v_exp_f32 v59, v107
	v_exp_f32 v60, v108
	v_mfma_f32_16x16x32_bf16 v[124:127], a[100:103], a[36:39], v[124:127]
	ds_read_b64_tr_b16 a[214:215], v21 offset:8192
	buffer_load_dwordx4 v37, s[24:27], s50 offen offset:1024 nt lds
	v_sub_f32 v109, v109, v7
	v_sub_f32 v110, v110, v7
	v_mfma_f32_16x16x32_bf16 v[112:115], a[104:107], a[40:43], v[112:115]
	ds_read_b64_tr_b16 a[216:217], v22 offset:0
	v_exp_f32 v61, v109
	v_exp_f32 v62, v110
	v_mfma_f32_16x16x32_bf16 v[120:123], a[104:107], a[44:47], v[120:123]
	ds_read_b64_tr_b16 a[218:219], v22 offset:8192
	buffer_load_dwordx4 v38, s[24:27], s50 offen offset:2048 nt lds
	v_sub_f32 v111, v111, v7
	v_add_f32 v4, v48, v49
	v_mfma_f32_16x16x32_bf16 v[116:119], a[108:111], a[40:43], v[116:119]
	ds_read_b64_tr_b16 a[220:221], v23 offset:0
	v_exp_f32 v63, v111
	v_cvt_pk_bf16_f32 v64, v48, v49
	v_mfma_f32_16x16x32_bf16 v[124:127], a[108:111], a[44:47], v[124:127]
	ds_read_b64_tr_b16 a[222:223], v23 offset:8192
	buffer_load_dwordx4 v39, s[24:27], s50 offen offset:3072 nt lds
	v_add_f32 v4, v4, v50
	v_add_f32 v4, v4, v51
	v_mfma_f32_16x16x32_bf16 v[112:115], a[112:115], a[48:51], v[112:115]
	ds_read_b64_tr_b16 a[224:225], v16 offset:256
	v_cvt_pk_bf16_f32 v65, v50, v51
	v_add_f32 v4, v4, v52
	v_add_f32 v4, v4, v53
	v_mfma_f32_16x16x32_bf16 v[120:123], a[112:115], a[52:55], v[120:123]
	ds_read_b64_tr_b16 a[226:227], v16 offset:8448
	v_cvt_pk_bf16_f32 v66, v52, v53
	v_add_f32 v4, v4, v54
	v_add_f32 v4, v4, v55
	s_waitcnt lgkmcnt(8)
	v_mfma_f32_16x16x32_bf16 v[116:119], a[116:119], a[48:51], v[116:119]
	ds_read_b64_tr_b16 a[228:229], v17 offset:256
	v_cvt_pk_bf16_f32 v67, v54, v55
	v_add_f32 v5, v56, v57
	v_cvt_pk_bf16_f32 v68, v56, v57
	v_mfma_f32_16x16x32_bf16 v[124:127], a[116:119], a[52:55], v[124:127]
	ds_read_b64_tr_b16 a[230:231], v17 offset:8448
	v_add_f32 v5, v5, v58
	v_add_f32 v5, v5, v59
	v_mfma_f32_16x16x32_bf16 v[112:115], a[120:123], a[56:59], v[112:115]
	ds_read_b64_tr_b16 a[232:233], v18 offset:256
	v_cvt_pk_bf16_f32 v69, v58, v59
	v_add_f32 v5, v5, v60
	v_mfma_f32_16x16x32_bf16 v[120:123], a[120:123], a[60:63], v[120:123]
	ds_read_b64_tr_b16 a[234:235], v18 offset:8448
	v_add_f32 v5, v5, v61
	v_cvt_pk_bf16_f32 v70, v60, v61
	v_mfma_f32_16x16x32_bf16 v[116:119], a[124:127], a[56:59], v[116:119]
	ds_read_b64_tr_b16 a[236:237], v19 offset:256
	v_add_f32 v5, v5, v62
	v_add_f32 v5, v5, v63
	v_cvt_pk_bf16_f32 v71, v62, v63
	v_mfma_f32_16x16x32_bf16 v[124:127], a[124:127], a[60:63], v[124:127]
	ds_read_b64_tr_b16 a[238:239], v19 offset:8448
	v_mfma_f32_16x16x32_bf16 v[128:131], a[192:195], v[64:67], 0
	ds_read_b64_tr_b16 a[240:241], v20 offset:256
	v_add_f32 v2, v2, v4
	v_mfma_f32_16x16x32_bf16 v[136:139], a[192:195], v[68:71], 0
	ds_read_b64_tr_b16 a[242:243], v20 offset:8448
	v_add_f32 v3, v3, v5
	v_mfma_f32_16x16x32_bf16 v[132:135], a[196:199], v[64:67], 0
	ds_read_b64_tr_b16 a[244:245], v21 offset:256
	v_sub_f32 v80, 0, v6
	v_sub_f32 v112, v112, v6
	v_mfma_f32_16x16x32_bf16 v[140:143], a[196:199], v[68:71], 0
	ds_read_b64_tr_b16 a[246:247], v21 offset:8448
	v_sub_f32 v81, 0, v6
	v_exp_f32 v48, v112
	v_mfma_f32_16x16x32_bf16 v[144:147], a[200:203], v[64:67], 0
	ds_read_b64_tr_b16 a[248:249], v22 offset:256
	v_sub_f32 v82, 0, v6
	v_sub_f32 v113, v113, v6
	v_mfma_f32_16x16x32_bf16 v[152:155], a[200:203], v[68:71], 0
	ds_read_b64_tr_b16 a[250:251], v22 offset:8448
	v_sub_f32 v83, 0, v6
	v_exp_f32 v49, v113
	v_mfma_f32_16x16x32_bf16 v[148:151], a[204:207], v[64:67], 0
	ds_read_b64_tr_b16 a[252:253], v23 offset:256
	v_sub_f32 v84, 0, v7
	v_sub_f32 v114, v114, v6
	v_mfma_f32_16x16x32_bf16 v[156:159], a[204:207], v[68:71], 0
	ds_read_b64_tr_b16 a[254:255], v23 offset:8448
	v_sub_f32 v85, 0, v7
	v_exp_f32 v50, v114
	v_mfma_f32_16x16x32_bf16 v[160:163], a[208:211], v[64:67], 0
	v_sub_f32 v86, 0, v7
	v_sub_f32 v87, 0, v7
	v_sub_f32 v115, v115, v6
	v_mfma_f32_16x16x32_bf16 v[168:171], a[208:211], v[68:71], 0
	v_exp_f32 v51, v115
	s_waitcnt lgkmcnt(8)
	v_mfma_f32_16x16x32_bf16 v[164:167], a[212:215], v[64:67], 0
	v_sub_f32 v116, v116, v6
	v_sub_f32 v117, v117, v6
	v_mfma_f32_16x16x32_bf16 v[172:175], a[212:215], v[68:71], 0
	v_exp_f32 v52, v116
	v_mfma_f32_16x16x32_bf16 v[176:179], a[216:219], v[64:67], 0
	v_exp_f32 v53, v117
	v_mfma_f32_16x16x32_bf16 v[184:187], a[216:219], v[68:71], 0
	v_sub_f32 v118, v118, v6
	v_sub_f32 v119, v119, v6
	v_mfma_f32_16x16x32_bf16 v[180:183], a[220:223], v[64:67], 0
	s_waitcnt vmcnt(16) lgkmcnt(0)
	s_barrier
	v_exp_f32 v54, v118
	v_mfma_f32_16x16x32_bf16 v[188:191], a[220:223], v[68:71], 0
	s_add_u32 m0, s45, 0x4000
	s_add_u32 s50, s50, 0x4000
	ds_read_b128 a[64:67], v12 offset:32768
	v_exp_f32 v55, v119
	v_mfma_f32_16x16x32_bf16 v[192:195], a[224:227], v[64:67], 0
	ds_read_b128 a[68:71], v12 offset:40960
	buffer_load_dwordx4 v36, s[24:27], s50 offen offset:0 nt lds
	v_mfma_f32_16x16x32_bf16 v[200:203], a[224:227], v[68:71], 0
	ds_read_b128 a[72:75], v13 offset:32768
	v_sub_f32 v120, v120, v7
	v_mfma_f32_16x16x32_bf16 v[196:199], a[228:231], v[64:67], 0
	ds_read_b128 a[76:79], v13 offset:40960
	v_sub_f32 v121, v121, v7
	v_mfma_f32_16x16x32_bf16 v[204:207], a[228:231], v[68:71], 0
	ds_read_b128 a[80:83], v14 offset:32768
	v_sub_f32 v122, v122, v7
	v_mfma_f32_16x16x32_bf16 v[208:211], a[232:235], v[64:67], 0
	ds_read_b128 a[84:87], v14 offset:40960
	v_sub_f32 v123, v123, v7
	v_mfma_f32_16x16x32_bf16 v[216:219], a[232:235], v[68:71], 0
	ds_read_b128 a[88:91], v15 offset:32768
	v_sub_f32 v124, v124, v7
	v_mfma_f32_16x16x32_bf16 v[212:215], a[236:239], v[64:67], 0
	ds_read_b128 a[92:95], v15 offset:40960
	buffer_load_dwordx4 v37, s[24:27], s50 offen offset:1024 nt lds
	v_mfma_f32_16x16x32_bf16 v[220:223], a[236:239], v[68:71], 0
	ds_read_b128 a[96:99], v12 offset:33024
	v_sub_f32 v125, v125, v7
	v_mfma_f32_16x16x32_bf16 v[224:227], a[240:243], v[64:67], 0
	ds_read_b128 a[100:103], v12 offset:41216
	v_sub_f32 v126, v126, v7
	v_mfma_f32_16x16x32_bf16 v[232:235], a[240:243], v[68:71], 0
	ds_read_b128 a[104:107], v13 offset:33024
	v_sub_f32 v127, v127, v7
	v_mfma_f32_16x16x32_bf16 v[228:231], a[244:247], v[64:67], 0
	ds_read_b128 a[108:111], v13 offset:41216
	v_add_f32 v4, v48, v49
	v_mfma_f32_16x16x32_bf16 v[236:239], a[244:247], v[68:71], 0
	ds_read_b128 a[112:115], v14 offset:33024
	v_cvt_pk_bf16_f32 v72, v48, v49
	v_mfma_f32_16x16x32_bf16 v[240:243], a[248:251], v[64:67], 0
	ds_read_b128 a[116:119], v14 offset:41216
	buffer_load_dwordx4 v38, s[24:27], s50 offen offset:2048 nt lds
	v_mfma_f32_16x16x32_bf16 v[248:251], a[248:251], v[68:71], 0
	ds_read_b128 a[120:123], v15 offset:33024
	v_add_f32 v4, v4, v50
	v_mfma_f32_16x16x32_bf16 v[244:247], a[252:255], v[64:67], 0
	ds_read_b128 a[124:127], v15 offset:41216
	v_add_f32 v4, v4, v51
	v_mfma_f32_16x16x32_bf16 v[252:255], a[252:255], v[68:71], 0
	v_exp_f32 v56, v120
	s_waitcnt lgkmcnt(12)
	v_mfma_f32_16x16x32_bf16 v[96:99], a[64:67], a[0:3], v[80:83]
	v_exp_f32 v57, v121
	v_mfma_f32_16x16x32_bf16 v[104:107], a[64:67], a[4:7], v[84:87]
	v_exp_f32 v58, v122
	v_mfma_f32_16x16x32_bf16 v[100:103], a[68:71], a[0:3], v[80:83]
	v_exp_f32 v59, v123
	v_mfma_f32_16x16x32_bf16 v[108:111], a[68:71], a[4:7], v[84:87]
	v_exp_f32 v60, v124
	v_mfma_f32_16x16x32_bf16 v[96:99], a[72:75], a[8:11], v[96:99]
	v_exp_f32 v61, v125
	v_mfma_f32_16x16x32_bf16 v[104:107], a[72:75], a[12:15], v[104:107]
	v_exp_f32 v62, v126
	v_mfma_f32_16x16x32_bf16 v[100:103], a[76:79], a[8:11], v[100:103]
	v_exp_f32 v63, v127
	v_mfma_f32_16x16x32_bf16 v[108:111], a[76:79], a[12:15], v[108:111]
	v_cvt_pk_bf16_f32 v73, v50, v51
	v_add_f32 v4, v4, v52
	s_waitcnt lgkmcnt(3)
	v_mfma_f32_16x16x32_bf16 v[96:99], a[80:83], a[16:19], v[96:99]
	ds_read_b64_tr_b16 a[192:193], v16 offset:16384
	v_add_f32 v4, v4, v53
	v_mfma_f32_16x16x32_bf16 v[104:107], a[80:83], a[20:23], v[104:107]
	ds_read_b64_tr_b16 a[194:195], v16 offset:24576
	buffer_load_dwordx4 v39, s[24:27], s50 offen offset:3072 nt lds
	v_mfma_f32_16x16x32_bf16 v[100:103], a[84:87], a[16:19], v[100:103]
	ds_read_b64_tr_b16 a[196:197], v17 offset:16384
	v_cvt_pk_bf16_f32 v74, v52, v53
	v_mfma_f32_16x16x32_bf16 v[108:111], a[84:87], a[20:23], v[108:111]
	ds_read_b64_tr_b16 a[198:199], v17 offset:24576
	v_add_f32 v4, v4, v54
	v_mfma_f32_16x16x32_bf16 v[96:99], a[88:91], a[24:27], v[96:99]
	ds_read_b64_tr_b16 a[200:201], v18 offset:16384
	v_add_f32 v4, v4, v55
	v_mfma_f32_16x16x32_bf16 v[104:107], a[88:91], a[28:31], v[104:107]
	ds_read_b64_tr_b16 a[202:203], v18 offset:24576
	v_cvt_pk_bf16_f32 v75, v54, v55
	v_mfma_f32_16x16x32_bf16 v[100:103], a[92:95], a[24:27], v[100:103]
	s_add_u32 m0, s45, 0x10000
	s_add_u32 s51, s51, 0x4000
	ds_read_b64_tr_b16 a[204:205], v19 offset:16384
	v_add_f32 v5, v56, v57
	v_mfma_f32_16x16x32_bf16 v[108:111], a[92:95], a[28:31], v[108:111]
	ds_read_b64_tr_b16 a[206:207], v19 offset:24576
	buffer_load_dwordx4 v40, s[28:31], s51 offen offset:0 nt lds
	v_mfma_f32_16x16x32_bf16 v[96:99], a[96:99], a[32:35], v[96:99]
	ds_read_b64_tr_b16 a[208:209], v20 offset:16384
	v_cvt_pk_bf16_f32 v76, v56, v57
	v_mfma_f32_16x16x32_bf16 v[104:107], a[96:99], a[36:39], v[104:107]
	ds_read_b64_tr_b16 a[210:211], v20 offset:24576
	v_add_f32 v5, v5, v58
	v_mfma_f32_16x16x32_bf16 v[100:103], a[100:103], a[32:35], v[100:103]
	ds_read_b64_tr_b16 a[212:213], v21 offset:16384
	v_add_f32 v5, v5, v59
	v_mfma_f32_16x16x32_bf16 v[108:111], a[100:103], a[36:39], v[108:111]
	ds_read_b64_tr_b16 a[214:215], v21 offset:24576
	v_cvt_pk_bf16_f32 v77, v58, v59
	v_mfma_f32_16x16x32_bf16 v[96:99], a[104:107], a[40:43], v[96:99]
	ds_read_b64_tr_b16 a[216:217], v22 offset:16384
	v_add_f32 v5, v5, v60
	v_mfma_f32_16x16x32_bf16 v[104:107], a[104:107], a[44:47], v[104:107]
	ds_read_b64_tr_b16 a[218:219], v22 offset:24576
	buffer_load_dwordx4 v41, s[28:31], s51 offen offset:1024 nt lds
	v_mfma_f32_16x16x32_bf16 v[100:103], a[108:111], a[40:43], v[100:103]
	ds_read_b64_tr_b16 a[220:221], v23 offset:16384
	v_add_f32 v5, v5, v61
	v_mfma_f32_16x16x32_bf16 v[108:111], a[108:111], a[44:47], v[108:111]
	ds_read_b64_tr_b16 a[222:223], v23 offset:24576
	v_cvt_pk_bf16_f32 v78, v60, v61
	v_mfma_f32_16x16x32_bf16 v[96:99], a[112:115], a[48:51], v[96:99]
	ds_read_b64_tr_b16 a[224:225], v16 offset:16640
	v_add_f32 v5, v5, v62
	v_mfma_f32_16x16x32_bf16 v[104:107], a[112:115], a[52:55], v[104:107]
	ds_read_b64_tr_b16 a[226:227], v16 offset:24832
	v_add_f32 v5, v5, v63
	s_waitcnt lgkmcnt(12)
	v_mfma_f32_16x16x32_bf16 v[100:103], a[116:119], a[48:51], v[100:103]
	ds_read_b64_tr_b16 a[228:229], v17 offset:16640
	v_cvt_pk_bf16_f32 v79, v62, v63
	v_mfma_f32_16x16x32_bf16 v[108:111], a[116:119], a[52:55], v[108:111]
	ds_read_b64_tr_b16 a[230:231], v17 offset:24832
	buffer_load_dwordx4 v42, s[28:31], s51 offen offset:2048 nt lds
	v_mfma_f32_16x16x32_bf16 v[96:99], a[120:123], a[56:59], v[96:99]
	ds_read_b64_tr_b16 a[232:233], v18 offset:16640
	v_max_f32 v10, v4, v5
	v_mfma_f32_16x16x32_bf16 v[104:107], a[120:123], a[60:63], v[104:107]
	ds_read_b64_tr_b16 a[234:235], v18 offset:24832
	v_cmp_lt_f32 vcc, s47, v10
	v_mfma_f32_16x16x32_bf16 v[100:103], a[124:127], a[56:59], v[100:103]
	ds_read_b64_tr_b16 a[236:237], v19 offset:16640
	v_mfma_f32_16x16x32_bf16 v[108:111], a[124:127], a[60:63], v[108:111]
	ds_read_b64_tr_b16 a[238:239], v19 offset:24832
	s_cbranch_vccnz L_tramp1
L_back1:
	s_mov_b32 s56, 6
L_loop:
	v_mfma_f32_16x16x32_bf16 v[128:131], a[192:195], v[72:75], v[128:131]
	ds_read_b64_tr_b16 a[240:241], v20 offset:16640
	v_add_f32 v2, v2, v4
	v_mfma_f32_16x16x32_bf16 v[136:139], a[192:195], v[76:79], v[136:139]
	ds_read_b64_tr_b16 a[242:243], v20 offset:24832
	v_add_f32 v3, v3, v5
	v_mfma_f32_16x16x32_bf16 v[132:135], a[196:199], v[72:75], v[132:135]
	ds_read_b64_tr_b16 a[244:245], v21 offset:16640
	v_mfma_f32_16x16x32_bf16 v[140:143], a[196:199], v[76:79], v[140:143]
	ds_read_b64_tr_b16 a[246:247], v21 offset:24832
	buffer_load_dwordx4 v43, s[28:31], s51 offen offset:3072 nt lds
	v_mfma_f32_16x16x32_bf16 v[144:147], a[200:203], v[72:75], v[144:147]
	ds_read_b64_tr_b16 a[248:249], v22 offset:16640
	v_mfma_f32_16x16x32_bf16 v[152:155], a[200:203], v[76:79], v[152:155]
	ds_read_b64_tr_b16 a[250:251], v22 offset:24832
	s_waitcnt lgkmcnt(13)
	v_mfma_f32_16x16x32_bf16 v[148:151], a[204:207], v[72:75], v[148:151]
	ds_read_b64_tr_b16 a[252:253], v23 offset:16640
	v_mfma_f32_16x16x32_bf16 v[156:159], a[204:207], v[76:79], v[156:159]
	ds_read_b64_tr_b16 a[254:255], v23 offset:24832
	v_mfma_f32_16x16x32_bf16 v[160:163], a[208:211], v[72:75], v[160:163]
	v_exp_f32 v48, v96
	v_mfma_f32_16x16x32_bf16 v[168:171], a[208:211], v[76:79], v[168:171]
	v_exp_f32 v49, v97
	v_mfma_f32_16x16x32_bf16 v[164:167], a[212:215], v[72:75], v[164:167]
	v_exp_f32 v50, v98
	v_mfma_f32_16x16x32_bf16 v[172:175], a[212:215], v[76:79], v[172:175]
	v_exp_f32 v51, v99
	v_mfma_f32_16x16x32_bf16 v[176:179], a[216:219], v[72:75], v[176:179]
	v_exp_f32 v52, v100
	v_mfma_f32_16x16x32_bf16 v[184:187], a[216:219], v[76:79], v[184:187]
	v_exp_f32 v53, v101
	v_mfma_f32_16x16x32_bf16 v[180:183], a[220:223], v[72:75], v[180:183]
	s_waitcnt vmcnt(16) lgkmcnt(0)
	s_barrier
	v_exp_f32 v54, v102
	v_mfma_f32_16x16x32_bf16 v[188:191], a[220:223], v[76:79], v[188:191]
	s_add_u32 m0, s45, 0x8000
	s_add_u32 s50, s50, 0x4000
	ds_read_b128 a[64:67], v12 offset:49152
	v_add_f32 v4, v48, v49
	v_mfma_f32_16x16x32_bf16 v[192:195], a[224:227], v[72:75], v[192:195]
	ds_read_b128 a[68:71], v12 offset:57344
	buffer_load_dwordx4 v36, s[24:27], s50 offen offset:0 nt lds
	v_mfma_f32_16x16x32_bf16 v[200:203], a[224:227], v[76:79], v[200:203]
	ds_read_b128 a[72:75], v13 offset:49152
	v_cvt_pk_bf16_f32 v64, v48, v49
	v_mfma_f32_16x16x32_bf16 v[196:199], a[228:231], v[72:75], v[196:199]
	ds_read_b128 a[76:79], v13 offset:57344
	v_add_f32 v4, v4, v50
	v_mfma_f32_16x16x32_bf16 v[204:207], a[228:231], v[76:79], v[204:207]
	ds_read_b128 a[80:83], v14 offset:49152
	v_add_f32 v4, v4, v51
	v_mfma_f32_16x16x32_bf16 v[208:211], a[232:235], v[72:75], v[208:211]
	ds_read_b128 a[84:87], v14 offset:57344
	v_cvt_pk_bf16_f32 v65, v50, v51
	v_mfma_f32_16x16x32_bf16 v[216:219], a[232:235], v[76:79], v[216:219]
	ds_read_b128 a[88:91], v15 offset:49152
	v_add_f32 v4, v4, v52
	v_mfma_f32_16x16x32_bf16 v[212:215], a[236:239], v[72:75], v[212:215]
	ds_read_b128 a[92:95], v15 offset:57344
	buffer_load_dwordx4 v37, s[24:27], s50 offen offset:1024 nt lds
	v_mfma_f32_16x16x32_bf16 v[220:223], a[236:239], v[76:79], v[220:223]
	ds_read_b128 a[96:99], v12 offset:49408
	v_add_f32 v4, v4, v53
	v_mfma_f32_16x16x32_bf16 v[224:227], a[240:243], v[72:75], v[224:227]
	ds_read_b128 a[100:103], v12 offset:57600
	v_cvt_pk_bf16_f32 v66, v52, v53
	v_mfma_f32_16x16x32_bf16 v[232:235], a[240:243], v[76:79], v[232:235]
	ds_read_b128 a[104:107], v13 offset:49408
	v_add_f32 v4, v4, v54
	v_mfma_f32_16x16x32_bf16 v[228:231], a[244:247], v[72:75], v[228:231]
	ds_read_b128 a[108:111], v13 offset:57600
	v_mfma_f32_16x16x32_bf16 v[236:239], a[244:247], v[76:79], v[236:239]
	ds_read_b128 a[112:115], v14 offset:49408
	v_mfma_f32_16x16x32_bf16 v[240:243], a[248:251], v[72:75], v[240:243]
	ds_read_b128 a[116:119], v14 offset:57600
	buffer_load_dwordx4 v38, s[24:27], s50 offen offset:2048 nt lds
	v_mfma_f32_16x16x32_bf16 v[248:251], a[248:251], v[76:79], v[248:251]
	ds_read_b128 a[120:123], v15 offset:49408
	v_mfma_f32_16x16x32_bf16 v[244:247], a[252:255], v[72:75], v[244:247]
	ds_read_b128 a[124:127], v15 offset:57600
	v_mfma_f32_16x16x32_bf16 v[252:255], a[252:255], v[76:79], v[252:255]
	v_exp_f32 v55, v103
	s_waitcnt lgkmcnt(12)
	v_mfma_f32_16x16x32_bf16 v[112:115], a[64:67], a[0:3], v[80:83]
	v_exp_f32 v56, v104
	v_mfma_f32_16x16x32_bf16 v[120:123], a[64:67], a[4:7], v[84:87]
	v_exp_f32 v57, v105
	v_mfma_f32_16x16x32_bf16 v[116:119], a[68:71], a[0:3], v[80:83]
	v_exp_f32 v58, v106
	v_mfma_f32_16x16x32_bf16 v[124:127], a[68:71], a[4:7], v[84:87]
	v_exp_f32 v59, v107
	v_mfma_f32_16x16x32_bf16 v[112:115], a[72:75], a[8:11], v[112:115]
	v_exp_f32 v60, v108
	v_mfma_f32_16x16x32_bf16 v[120:123], a[72:75], a[12:15], v[120:123]
	v_exp_f32 v61, v109
	v_mfma_f32_16x16x32_bf16 v[116:119], a[76:79], a[8:11], v[116:119]
	v_exp_f32 v62, v110
	v_mfma_f32_16x16x32_bf16 v[124:127], a[76:79], a[12:15], v[124:127]
	v_exp_f32 v63, v111
	s_waitcnt lgkmcnt(3)
	v_mfma_f32_16x16x32_bf16 v[112:115], a[80:83], a[16:19], v[112:115]
	ds_read_b64_tr_b16 a[192:193], v16 offset:32768
	v_add_f32 v4, v4, v55
	v_mfma_f32_16x16x32_bf16 v[120:123], a[80:83], a[20:23], v[120:123]
	ds_read_b64_tr_b16 a[194:195], v16 offset:40960
	buffer_load_dwordx4 v39, s[24:27], s50 offen offset:3072 nt lds
	v_mfma_f32_16x16x32_bf16 v[116:119], a[84:87], a[16:19], v[116:119]
	ds_read_b64_tr_b16 a[196:197], v17 offset:32768
	v_cvt_pk_bf16_f32 v67, v54, v55
	v_mfma_f32_16x16x32_bf16 v[124:127], a[84:87], a[20:23], v[124:127]
	ds_read_b64_tr_b16 a[198:199], v17 offset:40960
	v_add_f32 v5, v56, v57
	v_mfma_f32_16x16x32_bf16 v[112:115], a[88:91], a[24:27], v[112:115]
	ds_read_b64_tr_b16 a[200:201], v18 offset:32768
	v_cvt_pk_bf16_f32 v68, v56, v57
	v_mfma_f32_16x16x32_bf16 v[120:123], a[88:91], a[28:31], v[120:123]
	ds_read_b64_tr_b16 a[202:203], v18 offset:40960
	v_add_f32 v5, v5, v58
	v_mfma_f32_16x16x32_bf16 v[116:119], a[92:95], a[24:27], v[116:119]
	s_add_u32 m0, s45, 0x14000
	s_add_u32 s51, s51, 0x4000
	ds_read_b64_tr_b16 a[204:205], v19 offset:32768
	v_add_f32 v5, v5, v59
	v_mfma_f32_16x16x32_bf16 v[124:127], a[92:95], a[28:31], v[124:127]
	ds_read_b64_tr_b16 a[206:207], v19 offset:40960
	buffer_load_dwordx4 v40, s[28:31], s51 offen offset:0 nt lds
	v_mfma_f32_16x16x32_bf16 v[112:115], a[96:99], a[32:35], v[112:115]
	ds_read_b64_tr_b16 a[208:209], v20 offset:32768
	v_cvt_pk_bf16_f32 v69, v58, v59
	v_mfma_f32_16x16x32_bf16 v[120:123], a[96:99], a[36:39], v[120:123]
	ds_read_b64_tr_b16 a[210:211], v20 offset:40960
	v_add_f32 v5, v5, v60
	v_mfma_f32_16x16x32_bf16 v[116:119], a[100:103], a[32:35], v[116:119]
	ds_read_b64_tr_b16 a[212:213], v21 offset:32768
	v_add_f32 v5, v5, v61
	v_mfma_f32_16x16x32_bf16 v[124:127], a[100:103], a[36:39], v[124:127]
	ds_read_b64_tr_b16 a[214:215], v21 offset:40960
	v_cvt_pk_bf16_f32 v70, v60, v61
	v_mfma_f32_16x16x32_bf16 v[112:115], a[104:107], a[40:43], v[112:115]
	ds_read_b64_tr_b16 a[216:217], v22 offset:32768
	v_add_f32 v5, v5, v62
	v_mfma_f32_16x16x32_bf16 v[120:123], a[104:107], a[44:47], v[120:123]
	ds_read_b64_tr_b16 a[218:219], v22 offset:40960
	buffer_load_dwordx4 v41, s[28:31], s51 offen offset:1024 nt lds
	v_mfma_f32_16x16x32_bf16 v[116:119], a[108:111], a[40:43], v[116:119]
	ds_read_b64_tr_b16 a[220:221], v23 offset:32768
	v_add_f32 v5, v5, v63
	v_mfma_f32_16x16x32_bf16 v[124:127], a[108:111], a[44:47], v[124:127]
	ds_read_b64_tr_b16 a[222:223], v23 offset:40960
	v_cvt_pk_bf16_f32 v71, v62, v63
	v_mfma_f32_16x16x32_bf16 v[112:115], a[112:115], a[48:51], v[112:115]
	ds_read_b64_tr_b16 a[224:225], v16 offset:33024
	v_max_f32 v10, v4, v5
	v_mfma_f32_16x16x32_bf16 v[120:123], a[112:115], a[52:55], v[120:123]
	ds_read_b64_tr_b16 a[226:227], v16 offset:41216
	v_cmp_lt_f32 vcc, s47, v10
	s_waitcnt lgkmcnt(12)
	v_mfma_f32_16x16x32_bf16 v[116:119], a[116:119], a[48:51], v[116:119]
	ds_read_b64_tr_b16 a[228:229], v17 offset:33024
	v_mfma_f32_16x16x32_bf16 v[124:127], a[116:119], a[52:55], v[124:127]
	ds_read_b64_tr_b16 a[230:231], v17 offset:41216
	buffer_load_dwordx4 v42, s[28:31], s51 offen offset:2048 nt lds
	v_mfma_f32_16x16x32_bf16 v[112:115], a[120:123], a[56:59], v[112:115]
	ds_read_b64_tr_b16 a[232:233], v18 offset:33024
	v_mfma_f32_16x16x32_bf16 v[120:123], a[120:123], a[60:63], v[120:123]
	ds_read_b64_tr_b16 a[234:235], v18 offset:41216
	v_mfma_f32_16x16x32_bf16 v[116:119], a[124:127], a[56:59], v[116:119]
	ds_read_b64_tr_b16 a[236:237], v19 offset:33024
	v_mfma_f32_16x16x32_bf16 v[124:127], a[124:127], a[60:63], v[124:127]
	ds_read_b64_tr_b16 a[238:239], v19 offset:41216
	s_cbranch_vccnz L_tramp2
L_back2:
	v_mfma_f32_16x16x32_bf16 v[128:131], a[192:195], v[64:67], v[128:131]
	ds_read_b64_tr_b16 a[240:241], v20 offset:33024
	v_add_f32 v2, v2, v4
	v_mfma_f32_16x16x32_bf16 v[136:139], a[192:195], v[68:71], v[136:139]
	ds_read_b64_tr_b16 a[242:243], v20 offset:41216
	v_add_f32 v3, v3, v5
	v_mfma_f32_16x16x32_bf16 v[132:135], a[196:199], v[64:67], v[132:135]
	ds_read_b64_tr_b16 a[244:245], v21 offset:33024
	v_mfma_f32_16x16x32_bf16 v[140:143], a[196:199], v[68:71], v[140:143]
	ds_read_b64_tr_b16 a[246:247], v21 offset:41216
	buffer_load_dwordx4 v43, s[28:31], s51 offen offset:3072 nt lds
	v_mfma_f32_16x16x32_bf16 v[144:147], a[200:203], v[64:67], v[144:147]
	ds_read_b64_tr_b16 a[248:249], v22 offset:33024
	v_mfma_f32_16x16x32_bf16 v[152:155], a[200:203], v[68:71], v[152:155]
	ds_read_b64_tr_b16 a[250:251], v22 offset:41216
	s_waitcnt lgkmcnt(13)
	v_mfma_f32_16x16x32_bf16 v[148:151], a[204:207], v[64:67], v[148:151]
	ds_read_b64_tr_b16 a[252:253], v23 offset:33024
	v_mfma_f32_16x16x32_bf16 v[156:159], a[204:207], v[68:71], v[156:159]
	ds_read_b64_tr_b16 a[254:255], v23 offset:41216
	v_mfma_f32_16x16x32_bf16 v[160:163], a[208:211], v[64:67], v[160:163]
	v_exp_f32 v48, v112
	v_mfma_f32_16x16x32_bf16 v[168:171], a[208:211], v[68:71], v[168:171]
	v_exp_f32 v49, v113
	v_mfma_f32_16x16x32_bf16 v[164:167], a[212:215], v[64:67], v[164:167]
	v_exp_f32 v50, v114
	v_mfma_f32_16x16x32_bf16 v[172:175], a[212:215], v[68:71], v[172:175]
	v_exp_f32 v51, v115
	v_mfma_f32_16x16x32_bf16 v[176:179], a[216:219], v[64:67], v[176:179]
	v_exp_f32 v52, v116
	v_mfma_f32_16x16x32_bf16 v[184:187], a[216:219], v[68:71], v[184:187]
	v_exp_f32 v53, v117
	v_mfma_f32_16x16x32_bf16 v[180:183], a[220:223], v[64:67], v[180:183]
	s_waitcnt vmcnt(16) lgkmcnt(0)
	s_barrier
	v_exp_f32 v54, v118
	v_mfma_f32_16x16x32_bf16 v[188:191], a[220:223], v[68:71], v[188:191]
	s_add_u32 m0, s45, 0xc000
	s_add_u32 s50, s50, 0x4000
	ds_read_b128 a[64:67], v12 offset:0
	v_add_f32 v4, v48, v49
	v_mfma_f32_16x16x32_bf16 v[192:195], a[224:227], v[64:67], v[192:195]
	ds_read_b128 a[68:71], v12 offset:8192
	buffer_load_dwordx4 v36, s[24:27], s50 offen offset:0 nt lds
	v_mfma_f32_16x16x32_bf16 v[200:203], a[224:227], v[68:71], v[200:203]
	ds_read_b128 a[72:75], v13 offset:0
	v_cvt_pk_bf16_f32 v72, v48, v49
	v_mfma_f32_16x16x32_bf16 v[196:199], a[228:231], v[64:67], v[196:199]
	ds_read_b128 a[76:79], v13 offset:8192
	v_add_f32 v4, v4, v50
	v_mfma_f32_16x16x32_bf16 v[204:207], a[228:231], v[68:71], v[204:207]
	ds_read_b128 a[80:83], v14 offset:0
	v_add_f32 v4, v4, v51
	v_mfma_f32_16x16x32_bf16 v[208:211], a[232:235], v[64:67], v[208:211]
	ds_read_b128 a[84:87], v14 offset:8192
	v_cvt_pk_bf16_f32 v73, v50, v51
	v_mfma_f32_16x16x32_bf16 v[216:219], a[232:235], v[68:71], v[216:219]
	ds_read_b128 a[88:91], v15 offset:0
	v_add_f32 v4, v4, v52
	v_mfma_f32_16x16x32_bf16 v[212:215], a[236:239], v[64:67], v[212:215]
	ds_read_b128 a[92:95], v15 offset:8192
	buffer_load_dwordx4 v37, s[24:27], s50 offen offset:1024 nt lds
	v_mfma_f32_16x16x32_bf16 v[220:223], a[236:239], v[68:71], v[220:223]
	ds_read_b128 a[96:99], v12 offset:256
	v_add_f32 v4, v4, v53
	v_mfma_f32_16x16x32_bf16 v[224:227], a[240:243], v[64:67], v[224:227]
	ds_read_b128 a[100:103], v12 offset:8448
	v_cvt_pk_bf16_f32 v74, v52, v53
	v_mfma_f32_16x16x32_bf16 v[232:235], a[240:243], v[68:71], v[232:235]
	ds_read_b128 a[104:107], v13 offset:256
	v_add_f32 v4, v4, v54
	v_mfma_f32_16x16x32_bf16 v[228:231], a[244:247], v[64:67], v[228:231]
	ds_read_b128 a[108:111], v13 offset:8448
	v_mfma_f32_16x16x32_bf16 v[236:239], a[244:247], v[68:71], v[236:239]
	ds_read_b128 a[112:115], v14 offset:256
	v_mfma_f32_16x16x32_bf16 v[240:243], a[248:251], v[64:67], v[240:243]
	ds_read_b128 a[116:119], v14 offset:8448
	buffer_load_dwordx4 v38, s[24:27], s50 offen offset:2048 nt lds
	v_mfma_f32_16x16x32_bf16 v[248:251], a[248:251], v[68:71], v[248:251]
	ds_read_b128 a[120:123], v15 offset:256
	v_mfma_f32_16x16x32_bf16 v[244:247], a[252:255], v[64:67], v[244:247]
	ds_read_b128 a[124:127], v15 offset:8448
	v_mfma_f32_16x16x32_bf16 v[252:255], a[252:255], v[68:71], v[252:255]
	v_exp_f32 v55, v119
	s_waitcnt lgkmcnt(12)
	v_mfma_f32_16x16x32_bf16 v[96:99], a[64:67], a[0:3], v[80:83]
	v_exp_f32 v56, v120
	v_mfma_f32_16x16x32_bf16 v[104:107], a[64:67], a[4:7], v[84:87]
	v_exp_f32 v57, v121
	v_mfma_f32_16x16x32_bf16 v[100:103], a[68:71], a[0:3], v[80:83]
	v_exp_f32 v58, v122
	v_mfma_f32_16x16x32_bf16 v[108:111], a[68:71], a[4:7], v[84:87]
	v_exp_f32 v59, v123
	v_mfma_f32_16x16x32_bf16 v[96:99], a[72:75], a[8:11], v[96:99]
	v_exp_f32 v60, v124
	v_mfma_f32_16x16x32_bf16 v[104:107], a[72:75], a[12:15], v[104:107]
	v_exp_f32 v61, v125
	v_mfma_f32_16x16x32_bf16 v[100:103], a[76:79], a[8:11], v[100:103]
	v_exp_f32 v62, v126
	v_mfma_f32_16x16x32_bf16 v[108:111], a[76:79], a[12:15], v[108:111]
	v_exp_f32 v63, v127
	s_waitcnt lgkmcnt(3)
	v_mfma_f32_16x16x32_bf16 v[96:99], a[80:83], a[16:19], v[96:99]
	ds_read_b64_tr_b16 a[192:193], v16 offset:49152
	v_add_f32 v4, v4, v55
	v_mfma_f32_16x16x32_bf16 v[104:107], a[80:83], a[20:23], v[104:107]
	ds_read_b64_tr_b16 a[194:195], v16 offset:57344
	buffer_load_dwordx4 v39, s[24:27], s50 offen offset:3072 nt lds
	v_mfma_f32_16x16x32_bf16 v[100:103], a[84:87], a[16:19], v[100:103]
	ds_read_b64_tr_b16 a[196:197], v17 offset:49152
	v_cvt_pk_bf16_f32 v75, v54, v55
	v_mfma_f32_16x16x32_bf16 v[108:111], a[84:87], a[20:23], v[108:111]
	ds_read_b64_tr_b16 a[198:199], v17 offset:57344
	v_add_f32 v5, v56, v57
	v_mfma_f32_16x16x32_bf16 v[96:99], a[88:91], a[24:27], v[96:99]
	ds_read_b64_tr_b16 a[200:201], v18 offset:49152
	v_cvt_pk_bf16_f32 v76, v56, v57
	v_mfma_f32_16x16x32_bf16 v[104:107], a[88:91], a[28:31], v[104:107]
	ds_read_b64_tr_b16 a[202:203], v18 offset:57344
	v_add_f32 v5, v5, v58
	v_mfma_f32_16x16x32_bf16 v[100:103], a[92:95], a[24:27], v[100:103]
	s_add_u32 m0, s45, 0x18000
	s_add_u32 s51, s51, 0x4000
	ds_read_b64_tr_b16 a[204:205], v19 offset:49152
	v_add_f32 v5, v5, v59
	v_mfma_f32_16x16x32_bf16 v[108:111], a[92:95], a[28:31], v[108:111]
	ds_read_b64_tr_b16 a[206:207], v19 offset:57344
	buffer_load_dwordx4 v40, s[28:31], s51 offen offset:0 nt lds
	v_mfma_f32_16x16x32_bf16 v[96:99], a[96:99], a[32:35], v[96:99]
	ds_read_b64_tr_b16 a[208:209], v20 offset:49152
	v_cvt_pk_bf16_f32 v77, v58, v59
	v_mfma_f32_16x16x32_bf16 v[104:107], a[96:99], a[36:39], v[104:107]
	ds_read_b64_tr_b16 a[210:211], v20 offset:57344
	v_add_f32 v5, v5, v60
	v_mfma_f32_16x16x32_bf16 v[100:103], a[100:103], a[32:35], v[100:103]
	ds_read_b64_tr_b16 a[212:213], v21 offset:49152
	v_add_f32 v5, v5, v61
	v_mfma_f32_16x16x32_bf16 v[108:111], a[100:103], a[36:39], v[108:111]
	ds_read_b64_tr_b16 a[214:215], v21 offset:57344
	v_cvt_pk_bf16_f32 v78, v60, v61
	v_mfma_f32_16x16x32_bf16 v[96:99], a[104:107], a[40:43], v[96:99]
	ds_read_b64_tr_b16 a[216:217], v22 offset:49152
	v_add_f32 v5, v5, v62
	v_mfma_f32_16x16x32_bf16 v[104:107], a[104:107], a[44:47], v[104:107]
	ds_read_b64_tr_b16 a[218:219], v22 offset:57344
	buffer_load_dwordx4 v41, s[28:31], s51 offen offset:1024 nt lds
	v_mfma_f32_16x16x32_bf16 v[100:103], a[108:111], a[40:43], v[100:103]
	ds_read_b64_tr_b16 a[220:221], v23 offset:49152
	v_add_f32 v5, v5, v63
	v_mfma_f32_16x16x32_bf16 v[108:111], a[108:111], a[44:47], v[108:111]
	ds_read_b64_tr_b16 a[222:223], v23 offset:57344
	v_cvt_pk_bf16_f32 v79, v62, v63
	v_mfma_f32_16x16x32_bf16 v[96:99], a[112:115], a[48:51], v[96:99]
	ds_read_b64_tr_b16 a[224:225], v16 offset:49408
	v_max_f32 v10, v4, v5
	v_mfma_f32_16x16x32_bf16 v[104:107], a[112:115], a[52:55], v[104:107]
	ds_read_b64_tr_b16 a[226:227], v16 offset:57600
	v_cmp_lt_f32 vcc, s47, v10
	s_waitcnt lgkmcnt(12)
	v_mfma_f32_16x16x32_bf16 v[100:103], a[116:119], a[48:51], v[100:103]
	ds_read_b64_tr_b16 a[228:229], v17 offset:49408
	v_mfma_f32_16x16x32_bf16 v[108:111], a[116:119], a[52:55], v[108:111]
	ds_read_b64_tr_b16 a[230:231], v17 offset:57600
	buffer_load_dwordx4 v42, s[28:31], s51 offen offset:2048 nt lds
	v_mfma_f32_16x16x32_bf16 v[96:99], a[120:123], a[56:59], v[96:99]
	ds_read_b64_tr_b16 a[232:233], v18 offset:49408
	v_mfma_f32_16x16x32_bf16 v[104:107], a[120:123], a[60:63], v[104:107]
	ds_read_b64_tr_b16 a[234:235], v18 offset:57600
	v_mfma_f32_16x16x32_bf16 v[100:103], a[124:127], a[56:59], v[100:103]
	ds_read_b64_tr_b16 a[236:237], v19 offset:49408
	v_mfma_f32_16x16x32_bf16 v[108:111], a[124:127], a[60:63], v[108:111]
	ds_read_b64_tr_b16 a[238:239], v19 offset:57600
	s_cbranch_vccnz L_tramp3
L_back3:
	v_mfma_f32_16x16x32_bf16 v[128:131], a[192:195], v[72:75], v[128:131]
	ds_read_b64_tr_b16 a[240:241], v20 offset:49408
	v_add_f32 v2, v2, v4
	v_mfma_f32_16x16x32_bf16 v[136:139], a[192:195], v[76:79], v[136:139]
	ds_read_b64_tr_b16 a[242:243], v20 offset:57600
	v_add_f32 v3, v3, v5
	v_mfma_f32_16x16x32_bf16 v[132:135], a[196:199], v[72:75], v[132:135]
	ds_read_b64_tr_b16 a[244:245], v21 offset:49408
	v_mfma_f32_16x16x32_bf16 v[140:143], a[196:199], v[76:79], v[140:143]
	ds_read_b64_tr_b16 a[246:247], v21 offset:57600
	buffer_load_dwordx4 v43, s[28:31], s51 offen offset:3072 nt lds
	v_mfma_f32_16x16x32_bf16 v[144:147], a[200:203], v[72:75], v[144:147]
	ds_read_b64_tr_b16 a[248:249], v22 offset:49408
	v_mfma_f32_16x16x32_bf16 v[152:155], a[200:203], v[76:79], v[152:155]
	ds_read_b64_tr_b16 a[250:251], v22 offset:57600
	s_waitcnt lgkmcnt(13)
	v_mfma_f32_16x16x32_bf16 v[148:151], a[204:207], v[72:75], v[148:151]
	ds_read_b64_tr_b16 a[252:253], v23 offset:49408
	v_mfma_f32_16x16x32_bf16 v[156:159], a[204:207], v[76:79], v[156:159]
	ds_read_b64_tr_b16 a[254:255], v23 offset:57600
	v_mfma_f32_16x16x32_bf16 v[160:163], a[208:211], v[72:75], v[160:163]
	v_exp_f32 v48, v96
	v_mfma_f32_16x16x32_bf16 v[168:171], a[208:211], v[76:79], v[168:171]
	v_exp_f32 v49, v97
	v_mfma_f32_16x16x32_bf16 v[164:167], a[212:215], v[72:75], v[164:167]
	v_exp_f32 v50, v98
	v_mfma_f32_16x16x32_bf16 v[172:175], a[212:215], v[76:79], v[172:175]
	v_exp_f32 v51, v99
	v_mfma_f32_16x16x32_bf16 v[176:179], a[216:219], v[72:75], v[176:179]
	v_exp_f32 v52, v100
	v_mfma_f32_16x16x32_bf16 v[184:187], a[216:219], v[76:79], v[184:187]
	v_exp_f32 v53, v101
	v_mfma_f32_16x16x32_bf16 v[180:183], a[220:223], v[72:75], v[180:183]
	s_waitcnt vmcnt(16) lgkmcnt(0)
	s_barrier
	v_exp_f32 v54, v102
	v_mfma_f32_16x16x32_bf16 v[188:191], a[220:223], v[76:79], v[188:191]
	s_add_u32 m0, s45, 0
	s_add_u32 s50, s50, 0x4000
	ds_read_b128 a[64:67], v12 offset:16384
	v_add_f32 v4, v48, v49
	v_mfma_f32_16x16x32_bf16 v[192:195], a[224:227], v[72:75], v[192:195]
	ds_read_b128 a[68:71], v12 offset:24576
	buffer_load_dwordx4 v36, s[24:27], s50 offen offset:0 nt lds
	v_mfma_f32_16x16x32_bf16 v[200:203], a[224:227], v[76:79], v[200:203]
	ds_read_b128 a[72:75], v13 offset:16384
	v_cvt_pk_bf16_f32 v64, v48, v49
	v_mfma_f32_16x16x32_bf16 v[196:199], a[228:231], v[72:75], v[196:199]
	ds_read_b128 a[76:79], v13 offset:24576
	v_add_f32 v4, v4, v50
	v_mfma_f32_16x16x32_bf16 v[204:207], a[228:231], v[76:79], v[204:207]
	ds_read_b128 a[80:83], v14 offset:16384
	v_add_f32 v4, v4, v51
	v_mfma_f32_16x16x32_bf16 v[208:211], a[232:235], v[72:75], v[208:211]
	ds_read_b128 a[84:87], v14 offset:24576
	v_cvt_pk_bf16_f32 v65, v50, v51
	v_mfma_f32_16x16x32_bf16 v[216:219], a[232:235], v[76:79], v[216:219]
	ds_read_b128 a[88:91], v15 offset:16384
	v_add_f32 v4, v4, v52
	v_mfma_f32_16x16x32_bf16 v[212:215], a[236:239], v[72:75], v[212:215]
	ds_read_b128 a[92:95], v15 offset:24576
	buffer_load_dwordx4 v37, s[24:27], s50 offen offset:1024 nt lds
	v_mfma_f32_16x16x32_bf16 v[220:223], a[236:239], v[76:79], v[220:223]
	ds_read_b128 a[96:99], v12 offset:16640
	v_add_f32 v4, v4, v53
	v_mfma_f32_16x16x32_bf16 v[224:227], a[240:243], v[72:75], v[224:227]
	ds_read_b128 a[100:103], v12 offset:24832
	v_cvt_pk_bf16_f32 v66, v52, v53
	v_mfma_f32_16x16x32_bf16 v[232:235], a[240:243], v[76:79], v[232:235]
	ds_read_b128 a[104:107], v13 offset:16640
	v_add_f32 v4, v4, v54
	v_mfma_f32_16x16x32_bf16 v[228:231], a[244:247], v[72:75], v[228:231]
	ds_read_b128 a[108:111], v13 offset:24832
	v_mfma_f32_16x16x32_bf16 v[236:239], a[244:247], v[76:79], v[236:239]
	ds_read_b128 a[112:115], v14 offset:16640
	v_mfma_f32_16x16x32_bf16 v[240:243], a[248:251], v[72:75], v[240:243]
	ds_read_b128 a[116:119], v14 offset:24832
	buffer_load_dwordx4 v38, s[24:27], s50 offen offset:2048 nt lds
	v_mfma_f32_16x16x32_bf16 v[248:251], a[248:251], v[76:79], v[248:251]
	ds_read_b128 a[120:123], v15 offset:16640
	v_mfma_f32_16x16x32_bf16 v[244:247], a[252:255], v[72:75], v[244:247]
	ds_read_b128 a[124:127], v15 offset:24832
	v_mfma_f32_16x16x32_bf16 v[252:255], a[252:255], v[76:79], v[252:255]
	v_exp_f32 v55, v103
	s_waitcnt lgkmcnt(12)
	v_mfma_f32_16x16x32_bf16 v[112:115], a[64:67], a[0:3], v[80:83]
	v_exp_f32 v56, v104
	v_mfma_f32_16x16x32_bf16 v[120:123], a[64:67], a[4:7], v[84:87]
	v_exp_f32 v57, v105
	v_mfma_f32_16x16x32_bf16 v[116:119], a[68:71], a[0:3], v[80:83]
	v_exp_f32 v58, v106
	v_mfma_f32_16x16x32_bf16 v[124:127], a[68:71], a[4:7], v[84:87]
	v_exp_f32 v59, v107
	v_mfma_f32_16x16x32_bf16 v[112:115], a[72:75], a[8:11], v[112:115]
	v_exp_f32 v60, v108
	v_mfma_f32_16x16x32_bf16 v[120:123], a[72:75], a[12:15], v[120:123]
	v_exp_f32 v61, v109
	v_mfma_f32_16x16x32_bf16 v[116:119], a[76:79], a[8:11], v[116:119]
	v_exp_f32 v62, v110
	v_mfma_f32_16x16x32_bf16 v[124:127], a[76:79], a[12:15], v[124:127]
	v_exp_f32 v63, v111
	s_waitcnt lgkmcnt(3)
	v_mfma_f32_16x16x32_bf16 v[112:115], a[80:83], a[16:19], v[112:115]
	ds_read_b64_tr_b16 a[192:193], v16 offset:0
	v_add_f32 v4, v4, v55
	v_mfma_f32_16x16x32_bf16 v[120:123], a[80:83], a[20:23], v[120:123]
	ds_read_b64_tr_b16 a[194:195], v16 offset:8192
	buffer_load_dwordx4 v39, s[24:27], s50 offen offset:3072 nt lds
	v_mfma_f32_16x16x32_bf16 v[116:119], a[84:87], a[16:19], v[116:119]
	ds_read_b64_tr_b16 a[196:197], v17 offset:0
	v_cvt_pk_bf16_f32 v67, v54, v55
	v_mfma_f32_16x16x32_bf16 v[124:127], a[84:87], a[20:23], v[124:127]
	ds_read_b64_tr_b16 a[198:199], v17 offset:8192
	v_add_f32 v5, v56, v57
	v_mfma_f32_16x16x32_bf16 v[112:115], a[88:91], a[24:27], v[112:115]
	ds_read_b64_tr_b16 a[200:201], v18 offset:0
	v_cvt_pk_bf16_f32 v68, v56, v57
	v_mfma_f32_16x16x32_bf16 v[120:123], a[88:91], a[28:31], v[120:123]
	ds_read_b64_tr_b16 a[202:203], v18 offset:8192
	v_add_f32 v5, v5, v58
	v_mfma_f32_16x16x32_bf16 v[116:119], a[92:95], a[24:27], v[116:119]
	s_add_u32 m0, s45, 0x1c000
	s_add_u32 s51, s51, 0x4000
	ds_read_b64_tr_b16 a[204:205], v19 offset:0
	v_add_f32 v5, v5, v59
	v_mfma_f32_16x16x32_bf16 v[124:127], a[92:95], a[28:31], v[124:127]
	ds_read_b64_tr_b16 a[206:207], v19 offset:8192
	buffer_load_dwordx4 v40, s[28:31], s51 offen offset:0 nt lds
	v_mfma_f32_16x16x32_bf16 v[112:115], a[96:99], a[32:35], v[112:115]
	ds_read_b64_tr_b16 a[208:209], v20 offset:0
	v_cvt_pk_bf16_f32 v69, v58, v59
	v_mfma_f32_16x16x32_bf16 v[120:123], a[96:99], a[36:39], v[120:123]
	ds_read_b64_tr_b16 a[210:211], v20 offset:8192
	v_add_f32 v5, v5, v60
	v_mfma_f32_16x16x32_bf16 v[116:119], a[100:103], a[32:35], v[116:119]
	ds_read_b64_tr_b16 a[212:213], v21 offset:0
	v_add_f32 v5, v5, v61
	v_mfma_f32_16x16x32_bf16 v[124:127], a[100:103], a[36:39], v[124:127]
	ds_read_b64_tr_b16 a[214:215], v21 offset:8192
	v_cvt_pk_bf16_f32 v70, v60, v61
	v_mfma_f32_16x16x32_bf16 v[112:115], a[104:107], a[40:43], v[112:115]
	ds_read_b64_tr_b16 a[216:217], v22 offset:0
	v_add_f32 v5, v5, v62
	v_mfma_f32_16x16x32_bf16 v[120:123], a[104:107], a[44:47], v[120:123]
	ds_read_b64_tr_b16 a[218:219], v22 offset:8192
	buffer_load_dwordx4 v41, s[28:31], s51 offen offset:1024 nt lds
	v_mfma_f32_16x16x32_bf16 v[116:119], a[108:111], a[40:43], v[116:119]
	ds_read_b64_tr_b16 a[220:221], v23 offset:0
	v_add_f32 v5, v5, v63
	v_mfma_f32_16x16x32_bf16 v[124:127], a[108:111], a[44:47], v[124:127]
	ds_read_b64_tr_b16 a[222:223], v23 offset:8192
	v_cvt_pk_bf16_f32 v71, v62, v63
	v_mfma_f32_16x16x32_bf16 v[112:115], a[112:115], a[48:51], v[112:115]
	ds_read_b64_tr_b16 a[224:225], v16 offset:256
	v_max_f32 v10, v4, v5
	v_mfma_f32_16x16x32_bf16 v[120:123], a[112:115], a[52:55], v[120:123]
	ds_read_b64_tr_b16 a[226:227], v16 offset:8448
	v_cmp_lt_f32 vcc, s47, v10
	s_waitcnt lgkmcnt(12)
	v_mfma_f32_16x16x32_bf16 v[116:119], a[116:119], a[48:51], v[116:119]
	ds_read_b64_tr_b16 a[228:229], v17 offset:256
	v_mfma_f32_16x16x32_bf16 v[124:127], a[116:119], a[52:55], v[124:127]
	ds_read_b64_tr_b16 a[230:231], v17 offset:8448
	buffer_load_dwordx4 v42, s[28:31], s51 offen offset:2048 nt lds
	v_mfma_f32_16x16x32_bf16 v[112:115], a[120:123], a[56:59], v[112:115]
	ds_read_b64_tr_b16 a[232:233], v18 offset:256
	v_mfma_f32_16x16x32_bf16 v[120:123], a[120:123], a[60:63], v[120:123]
	ds_read_b64_tr_b16 a[234:235], v18 offset:8448
	v_mfma_f32_16x16x32_bf16 v[116:119], a[124:127], a[56:59], v[116:119]
	ds_read_b64_tr_b16 a[236:237], v19 offset:256
	v_mfma_f32_16x16x32_bf16 v[124:127], a[124:127], a[60:63], v[124:127]
	ds_read_b64_tr_b16 a[238:239], v19 offset:8448
	s_cbranch_vccnz L_tramp4
L_back4:
	v_mfma_f32_16x16x32_bf16 v[128:131], a[192:195], v[64:67], v[128:131]
	ds_read_b64_tr_b16 a[240:241], v20 offset:256
	v_add_f32 v2, v2, v4
	v_mfma_f32_16x16x32_bf16 v[136:139], a[192:195], v[68:71], v[136:139]
	ds_read_b64_tr_b16 a[242:243], v20 offset:8448
	v_add_f32 v3, v3, v5
	v_mfma_f32_16x16x32_bf16 v[132:135], a[196:199], v[64:67], v[132:135]
	ds_read_b64_tr_b16 a[244:245], v21 offset:256
	v_mfma_f32_16x16x32_bf16 v[140:143], a[196:199], v[68:71], v[140:143]
	ds_read_b64_tr_b16 a[246:247], v21 offset:8448
	buffer_load_dwordx4 v43, s[28:31], s51 offen offset:3072 nt lds
	v_mfma_f32_16x16x32_bf16 v[144:147], a[200:203], v[64:67], v[144:147]
	ds_read_b64_tr_b16 a[248:249], v22 offset:256
	v_mfma_f32_16x16x32_bf16 v[152:155], a[200:203], v[68:71], v[152:155]
	ds_read_b64_tr_b16 a[250:251], v22 offset:8448
	s_waitcnt lgkmcnt(13)
	v_mfma_f32_16x16x32_bf16 v[148:151], a[204:207], v[64:67], v[148:151]
	ds_read_b64_tr_b16 a[252:253], v23 offset:256
	v_mfma_f32_16x16x32_bf16 v[156:159], a[204:207], v[68:71], v[156:159]
	ds_read_b64_tr_b16 a[254:255], v23 offset:8448
	v_mfma_f32_16x16x32_bf16 v[160:163], a[208:211], v[64:67], v[160:163]
	v_exp_f32 v48, v112
	v_mfma_f32_16x16x32_bf16 v[168:171], a[208:211], v[68:71], v[168:171]
	v_exp_f32 v49, v113
	v_mfma_f32_16x16x32_bf16 v[164:167], a[212:215], v[64:67], v[164:167]
	v_exp_f32 v50, v114
	v_mfma_f32_16x16x32_bf16 v[172:175], a[212:215], v[68:71], v[172:175]
	v_exp_f32 v51, v115
	v_mfma_f32_16x16x32_bf16 v[176:179], a[216:219], v[64:67], v[176:179]
	v_exp_f32 v52, v116
	v_mfma_f32_16x16x32_bf16 v[184:187], a[216:219], v[68:71], v[184:187]
	v_exp_f32 v53, v117
	v_mfma_f32_16x16x32_bf16 v[180:183], a[220:223], v[64:67], v[180:183]
	s_waitcnt vmcnt(16) lgkmcnt(0)
	s_barrier
	v_exp_f32 v54, v118
	v_mfma_f32_16x16x32_bf16 v[188:191], a[220:223], v[68:71], v[188:191]
	s_add_u32 m0, s45, 0x4000
	s_add_u32 s50, s50, 0x4000
	ds_read_b128 a[64:67], v12 offset:32768
	v_add_f32 v4, v48, v49
	v_mfma_f32_16x16x32_bf16 v[192:195], a[224:227], v[64:67], v[192:195]
	ds_read_b128 a[68:71], v12 offset:40960
	buffer_load_dwordx4 v36, s[24:27], s50 offen offset:0 nt lds
	v_mfma_f32_16x16x32_bf16 v[200:203], a[224:227], v[68:71], v[200:203]
	ds_read_b128 a[72:75], v13 offset:32768
	v_cvt_pk_bf16_f32 v72, v48, v49
	v_mfma_f32_16x16x32_bf16 v[196:199], a[228:231], v[64:67], v[196:199]
	ds_read_b128 a[76:79], v13 offset:40960
	v_add_f32 v4, v4, v50
	v_mfma_f32_16x16x32_bf16 v[204:207], a[228:231], v[68:71], v[204:207]
	ds_read_b128 a[80:83], v14 offset:32768
	v_add_f32 v4, v4, v51
	v_mfma_f32_16x16x32_bf16 v[208:211], a[232:235], v[64:67], v[208:211]
	ds_read_b128 a[84:87], v14 offset:40960
	v_cvt_pk_bf16_f32 v73, v50, v51
	v_mfma_f32_16x16x32_bf16 v[216:219], a[232:235], v[68:71], v[216:219]
	ds_read_b128 a[88:91], v15 offset:32768
	v_add_f32 v4, v4, v52
	v_mfma_f32_16x16x32_bf16 v[212:215], a[236:239], v[64:67], v[212:215]
	ds_read_b128 a[92:95], v15 offset:40960
	buffer_load_dwordx4 v37, s[24:27], s50 offen offset:1024 nt lds
	v_mfma_f32_16x16x32_bf16 v[220:223], a[236:239], v[68:71], v[220:223]
	ds_read_b128 a[96:99], v12 offset:33024
	v_add_f32 v4, v4, v53
	v_mfma_f32_16x16x32_bf16 v[224:227], a[240:243], v[64:67], v[224:227]
	ds_read_b128 a[100:103], v12 offset:41216
	v_cvt_pk_bf16_f32 v74, v52, v53
	v_mfma_f32_16x16x32_bf16 v[232:235], a[240:243], v[68:71], v[232:235]
	ds_read_b128 a[104:107], v13 offset:33024
	v_add_f32 v4, v4, v54
	v_mfma_f32_16x16x32_bf16 v[228:231], a[244:247], v[64:67], v[228:231]
	ds_read_b128 a[108:111], v13 offset:41216
	v_mfma_f32_16x16x32_bf16 v[236:239], a[244:247], v[68:71], v[236:239]
	ds_read_b128 a[112:115], v14 offset:33024
	v_mfma_f32_16x16x32_bf16 v[240:243], a[248:251], v[64:67], v[240:243]
	ds_read_b128 a[116:119], v14 offset:41216
	buffer_load_dwordx4 v38, s[24:27], s50 offen offset:2048 nt lds
	v_mfma_f32_16x16x32_bf16 v[248:251], a[248:251], v[68:71], v[248:251]
	ds_read_b128 a[120:123], v15 offset:33024
	v_mfma_f32_16x16x32_bf16 v[244:247], a[252:255], v[64:67], v[244:247]
	ds_read_b128 a[124:127], v15 offset:41216
	v_mfma_f32_16x16x32_bf16 v[252:255], a[252:255], v[68:71], v[252:255]
	v_exp_f32 v55, v119
	s_waitcnt lgkmcnt(12)
	v_mfma_f32_16x16x32_bf16 v[96:99], a[64:67], a[0:3], v[80:83]
	v_exp_f32 v56, v120
	v_mfma_f32_16x16x32_bf16 v[104:107], a[64:67], a[4:7], v[84:87]
	v_exp_f32 v57, v121
	v_mfma_f32_16x16x32_bf16 v[100:103], a[68:71], a[0:3], v[80:83]
	v_exp_f32 v58, v122
	v_mfma_f32_16x16x32_bf16 v[108:111], a[68:71], a[4:7], v[84:87]
	v_exp_f32 v59, v123
	v_mfma_f32_16x16x32_bf16 v[96:99], a[72:75], a[8:11], v[96:99]
	v_exp_f32 v60, v124
	v_mfma_f32_16x16x32_bf16 v[104:107], a[72:75], a[12:15], v[104:107]
	v_exp_f32 v61, v125
	v_mfma_f32_16x16x32_bf16 v[100:103], a[76:79], a[8:11], v[100:103]
	v_exp_f32 v62, v126
	v_mfma_f32_16x16x32_bf16 v[108:111], a[76:79], a[12:15], v[108:111]
	v_exp_f32 v63, v127
	s_waitcnt lgkmcnt(3)
	v_mfma_f32_16x16x32_bf16 v[96:99], a[80:83], a[16:19], v[96:99]
	ds_read_b64_tr_b16 a[192:193], v16 offset:16384
	v_add_f32 v4, v4, v55
	v_mfma_f32_16x16x32_bf16 v[104:107], a[80:83], a[20:23], v[104:107]
	ds_read_b64_tr_b16 a[194:195], v16 offset:24576
	buffer_load_dwordx4 v39, s[24:27], s50 offen offset:3072 nt lds
	v_mfma_f32_16x16x32_bf16 v[100:103], a[84:87], a[16:19], v[100:103]
	ds_read_b64_tr_b16 a[196:197], v17 offset:16384
	v_cvt_pk_bf16_f32 v75, v54, v55
	v_mfma_f32_16x16x32_bf16 v[108:111], a[84:87], a[20:23], v[108:111]
	ds_read_b64_tr_b16 a[198:199], v17 offset:24576
	v_add_f32 v5, v56, v57
	v_mfma_f32_16x16x32_bf16 v[96:99], a[88:91], a[24:27], v[96:99]
	ds_read_b64_tr_b16 a[200:201], v18 offset:16384
	v_cvt_pk_bf16_f32 v76, v56, v57
	v_mfma_f32_16x16x32_bf16 v[104:107], a[88:91], a[28:31], v[104:107]
	ds_read_b64_tr_b16 a[202:203], v18 offset:24576
	v_add_f32 v5, v5, v58
	v_mfma_f32_16x16x32_bf16 v[100:103], a[92:95], a[24:27], v[100:103]
	s_add_u32 m0, s45, 0x10000
	s_add_u32 s51, s51, 0x4000
	ds_read_b64_tr_b16 a[204:205], v19 offset:16384
	v_add_f32 v5, v5, v59
	v_mfma_f32_16x16x32_bf16 v[108:111], a[92:95], a[28:31], v[108:111]
	ds_read_b64_tr_b16 a[206:207], v19 offset:24576
	buffer_load_dwordx4 v40, s[28:31], s51 offen offset:0 nt lds
	v_mfma_f32_16x16x32_bf16 v[96:99], a[96:99], a[32:35], v[96:99]
	ds_read_b64_tr_b16 a[208:209], v20 offset:16384
	v_cvt_pk_bf16_f32 v77, v58, v59
	v_mfma_f32_16x16x32_bf16 v[104:107], a[96:99], a[36:39], v[104:107]
	ds_read_b64_tr_b16 a[210:211], v20 offset:24576
	v_add_f32 v5, v5, v60
	v_mfma_f32_16x16x32_bf16 v[100:103], a[100:103], a[32:35], v[100:103]
	ds_read_b64_tr_b16 a[212:213], v21 offset:16384
	v_add_f32 v5, v5, v61
	v_mfma_f32_16x16x32_bf16 v[108:111], a[100:103], a[36:39], v[108:111]
	ds_read_b64_tr_b16 a[214:215], v21 offset:24576
	v_cvt_pk_bf16_f32 v78, v60, v61
	v_mfma_f32_16x16x32_bf16 v[96:99], a[104:107], a[40:43], v[96:99]
	ds_read_b64_tr_b16 a[216:217], v22 offset:16384
	v_add_f32 v5, v5, v62
	v_mfma_f32_16x16x32_bf16 v[104:107], a[104:107], a[44:47], v[104:107]
	ds_read_b64_tr_b16 a[218:219], v22 offset:24576
	buffer_load_dwordx4 v41, s[28:31], s51 offen offset:1024 nt lds
	v_mfma_f32_16x16x32_bf16 v[100:103], a[108:111], a[40:43], v[100:103]
	ds_read_b64_tr_b16 a[220:221], v23 offset:16384
	v_add_f32 v5, v5, v63
	v_mfma_f32_16x16x32_bf16 v[108:111], a[108:111], a[44:47], v[108:111]
	ds_read_b64_tr_b16 a[222:223], v23 offset:24576
	v_cvt_pk_bf16_f32 v79, v62, v63
	v_mfma_f32_16x16x32_bf16 v[96:99], a[112:115], a[48:51], v[96:99]
	ds_read_b64_tr_b16 a[224:225], v16 offset:16640
	v_max_f32 v10, v4, v5
	v_mfma_f32_16x16x32_bf16 v[104:107], a[112:115], a[52:55], v[104:107]
	ds_read_b64_tr_b16 a[226:227], v16 offset:24832
	v_cmp_lt_f32 vcc, s47, v10
	s_waitcnt lgkmcnt(12)
	v_mfma_f32_16x16x32_bf16 v[100:103], a[116:119], a[48:51], v[100:103]
	ds_read_b64_tr_b16 a[228:229], v17 offset:16640
	v_mfma_f32_16x16x32_bf16 v[108:111], a[116:119], a[52:55], v[108:111]
	ds_read_b64_tr_b16 a[230:231], v17 offset:24832
	buffer_load_dwordx4 v42, s[28:31], s51 offen offset:2048 nt lds
	v_mfma_f32_16x16x32_bf16 v[96:99], a[120:123], a[56:59], v[96:99]
	ds_read_b64_tr_b16 a[232:233], v18 offset:16640
	v_mfma_f32_16x16x32_bf16 v[104:107], a[120:123], a[60:63], v[104:107]
	ds_read_b64_tr_b16 a[234:235], v18 offset:24832
	v_mfma_f32_16x16x32_bf16 v[100:103], a[124:127], a[56:59], v[100:103]
	ds_read_b64_tr_b16 a[236:237], v19 offset:16640
	v_mfma_f32_16x16x32_bf16 v[108:111], a[124:127], a[60:63], v[108:111]
	ds_read_b64_tr_b16 a[238:239], v19 offset:24832
	s_cbranch_vccnz L_tramp5
L_back5:
	s_sub_u32 s56, s56, 1
	s_cmp_lg_u32 s56, 0
	s_cbranch_scc1 L_loop
	v_mfma_f32_16x16x32_bf16 v[128:131], a[192:195], v[72:75], v[128:131]
	ds_read_b64_tr_b16 a[240:241], v20 offset:16640
	v_add_f32 v2, v2, v4
	v_mfma_f32_16x16x32_bf16 v[136:139], a[192:195], v[76:79], v[136:139]
	ds_read_b64_tr_b16 a[242:243], v20 offset:24832
	v_add_f32 v3, v3, v5
	v_mfma_f32_16x16x32_bf16 v[132:135], a[196:199], v[72:75], v[132:135]
	ds_read_b64_tr_b16 a[244:245], v21 offset:16640
	v_mfma_f32_16x16x32_bf16 v[140:143], a[196:199], v[76:79], v[140:143]
	ds_read_b64_tr_b16 a[246:247], v21 offset:24832
	buffer_load_dwordx4 v43, s[28:31], s51 offen offset:3072 nt lds
	v_mfma_f32_16x16x32_bf16 v[144:147], a[200:203], v[72:75], v[144:147]
	ds_read_b64_tr_b16 a[248:249], v22 offset:16640
	v_mfma_f32_16x16x32_bf16 v[152:155], a[200:203], v[76:79], v[152:155]
	ds_read_b64_tr_b16 a[250:251], v22 offset:24832
	s_waitcnt lgkmcnt(13)
	v_mfma_f32_16x16x32_bf16 v[148:151], a[204:207], v[72:75], v[148:151]
	ds_read_b64_tr_b16 a[252:253], v23 offset:16640
	v_mfma_f32_16x16x32_bf16 v[156:159], a[204:207], v[76:79], v[156:159]
	ds_read_b64_tr_b16 a[254:255], v23 offset:24832
	v_mfma_f32_16x16x32_bf16 v[160:163], a[208:211], v[72:75], v[160:163]
	v_exp_f32 v48, v96
	v_mfma_f32_16x16x32_bf16 v[168:171], a[208:211], v[76:79], v[168:171]
	v_exp_f32 v49, v97
	v_mfma_f32_16x16x32_bf16 v[164:167], a[212:215], v[72:75], v[164:167]
	v_exp_f32 v50, v98
	v_mfma_f32_16x16x32_bf16 v[172:175], a[212:215], v[76:79], v[172:175]
	v_exp_f32 v51, v99
	v_mfma_f32_16x16x32_bf16 v[176:179], a[216:219], v[72:75], v[176:179]
	v_exp_f32 v52, v100
	v_mfma_f32_16x16x32_bf16 v[184:187], a[216:219], v[76:79], v[184:187]
	v_exp_f32 v53, v101
	v_mfma_f32_16x16x32_bf16 v[180:183], a[220:223], v[72:75], v[180:183]
	s_waitcnt vmcnt(16) lgkmcnt(0)
	s_barrier
	v_exp_f32 v54, v102
	v_mfma_f32_16x16x32_bf16 v[188:191], a[220:223], v[76:79], v[188:191]
	s_add_u32 m0, s45, 0x8000
	s_add_u32 s50, s50, 0x4000
	ds_read_b128 a[64:67], v12 offset:49152
	v_add_f32 v4, v48, v49
	v_mfma_f32_16x16x32_bf16 v[192:195], a[224:227], v[72:75], v[192:195]
	ds_read_b128 a[68:71], v12 offset:57344
	buffer_load_dwordx4 v36, s[24:27], s50 offen offset:0 nt lds
	v_mfma_f32_16x16x32_bf16 v[200:203], a[224:227], v[76:79], v[200:203]
	ds_read_b128 a[72:75], v13 offset:49152
	v_cvt_pk_bf16_f32 v64, v48, v49
	v_mfma_f32_16x16x32_bf16 v[196:199], a[228:231], v[72:75], v[196:199]
	ds_read_b128 a[76:79], v13 offset:57344
	v_add_f32 v4, v4, v50
	v_mfma_f32_16x16x32_bf16 v[204:207], a[228:231], v[76:79], v[204:207]
	ds_read_b128 a[80:83], v14 offset:49152
	v_add_f32 v4, v4, v51
	v_mfma_f32_16x16x32_bf16 v[208:211], a[232:235], v[72:75], v[208:211]
	ds_read_b128 a[84:87], v14 offset:57344
	v_cvt_pk_bf16_f32 v65, v50, v51
	v_mfma_f32_16x16x32_bf16 v[216:219], a[232:235], v[76:79], v[216:219]
	ds_read_b128 a[88:91], v15 offset:49152
	v_add_f32 v4, v4, v52
	v_mfma_f32_16x16x32_bf16 v[212:215], a[236:239], v[72:75], v[212:215]
	ds_read_b128 a[92:95], v15 offset:57344
	buffer_load_dwordx4 v37, s[24:27], s50 offen offset:1024 nt lds
	v_mfma_f32_16x16x32_bf16 v[220:223], a[236:239], v[76:79], v[220:223]
	ds_read_b128 a[96:99], v12 offset:49408
	v_add_f32 v4, v4, v53
	v_mfma_f32_16x16x32_bf16 v[224:227], a[240:243], v[72:75], v[224:227]
	ds_read_b128 a[100:103], v12 offset:57600
	v_cvt_pk_bf16_f32 v66, v52, v53
	v_mfma_f32_16x16x32_bf16 v[232:235], a[240:243], v[76:79], v[232:235]
	ds_read_b128 a[104:107], v13 offset:49408
	v_add_f32 v4, v4, v54
	v_mfma_f32_16x16x32_bf16 v[228:231], a[244:247], v[72:75], v[228:231]
	ds_read_b128 a[108:111], v13 offset:57600
	v_mfma_f32_16x16x32_bf16 v[236:239], a[244:247], v[76:79], v[236:239]
	ds_read_b128 a[112:115], v14 offset:49408
	v_mfma_f32_16x16x32_bf16 v[240:243], a[248:251], v[72:75], v[240:243]
	ds_read_b128 a[116:119], v14 offset:57600
	buffer_load_dwordx4 v38, s[24:27], s50 offen offset:2048 nt lds
	v_mfma_f32_16x16x32_bf16 v[248:251], a[248:251], v[76:79], v[248:251]
	ds_read_b128 a[120:123], v15 offset:49408
	v_mfma_f32_16x16x32_bf16 v[244:247], a[252:255], v[72:75], v[244:247]
	ds_read_b128 a[124:127], v15 offset:57600
	v_mfma_f32_16x16x32_bf16 v[252:255], a[252:255], v[76:79], v[252:255]
	v_exp_f32 v55, v103
	s_waitcnt lgkmcnt(12)
	v_mfma_f32_16x16x32_bf16 v[112:115], a[64:67], a[0:3], v[80:83]
	v_exp_f32 v56, v104
	v_mfma_f32_16x16x32_bf16 v[120:123], a[64:67], a[4:7], v[84:87]
	v_exp_f32 v57, v105
	v_mfma_f32_16x16x32_bf16 v[116:119], a[68:71], a[0:3], v[80:83]
	v_exp_f32 v58, v106
	v_mfma_f32_16x16x32_bf16 v[124:127], a[68:71], a[4:7], v[84:87]
	v_exp_f32 v59, v107
	v_mfma_f32_16x16x32_bf16 v[112:115], a[72:75], a[8:11], v[112:115]
	v_exp_f32 v60, v108
	v_mfma_f32_16x16x32_bf16 v[120:123], a[72:75], a[12:15], v[120:123]
	v_exp_f32 v61, v109
	v_mfma_f32_16x16x32_bf16 v[116:119], a[76:79], a[8:11], v[116:119]
	v_exp_f32 v62, v110
	v_mfma_f32_16x16x32_bf16 v[124:127], a[76:79], a[12:15], v[124:127]
	v_exp_f32 v63, v111
	s_waitcnt lgkmcnt(3)
	v_mfma_f32_16x16x32_bf16 v[112:115], a[80:83], a[16:19], v[112:115]
	ds_read_b64_tr_b16 a[192:193], v16 offset:32768
	v_add_f32 v4, v4, v55
	v_mfma_f32_16x16x32_bf16 v[120:123], a[80:83], a[20:23], v[120:123]
	ds_read_b64_tr_b16 a[194:195], v16 offset:40960
	buffer_load_dwordx4 v39, s[24:27], s50 offen offset:3072 nt lds
	v_mfma_f32_16x16x32_bf16 v[116:119], a[84:87], a[16:19], v[116:119]
	ds_read_b64_tr_b16 a[196:197], v17 offset:32768
	v_cvt_pk_bf16_f32 v67, v54, v55
	v_mfma_f32_16x16x32_bf16 v[124:127], a[84:87], a[20:23], v[124:127]
	ds_read_b64_tr_b16 a[198:199], v17 offset:40960
	v_add_f32 v5, v56, v57
	v_mfma_f32_16x16x32_bf16 v[112:115], a[88:91], a[24:27], v[112:115]
	ds_read_b64_tr_b16 a[200:201], v18 offset:32768
	v_cvt_pk_bf16_f32 v68, v56, v57
	v_mfma_f32_16x16x32_bf16 v[120:123], a[88:91], a[28:31], v[120:123]
	ds_read_b64_tr_b16 a[202:203], v18 offset:40960
	v_add_f32 v5, v5, v58
	v_mfma_f32_16x16x32_bf16 v[116:119], a[92:95], a[24:27], v[116:119]
	s_add_u32 m0, s45, 0x14000
	s_add_u32 s51, s51, 0x4000
	ds_read_b64_tr_b16 a[204:205], v19 offset:32768
	v_add_f32 v5, v5, v59
	v_mfma_f32_16x16x32_bf16 v[124:127], a[92:95], a[28:31], v[124:127]
	ds_read_b64_tr_b16 a[206:207], v19 offset:40960
	buffer_load_dwordx4 v40, s[28:31], s51 offen offset:0 nt lds
	v_mfma_f32_16x16x32_bf16 v[112:115], a[96:99], a[32:35], v[112:115]
	ds_read_b64_tr_b16 a[208:209], v20 offset:32768
	v_cvt_pk_bf16_f32 v69, v58, v59
	v_mfma_f32_16x16x32_bf16 v[120:123], a[96:99], a[36:39], v[120:123]
	ds_read_b64_tr_b16 a[210:211], v20 offset:40960
	v_add_f32 v5, v5, v60
	v_mfma_f32_16x16x32_bf16 v[116:119], a[100:103], a[32:35], v[116:119]
	ds_read_b64_tr_b16 a[212:213], v21 offset:32768
	v_add_f32 v5, v5, v61
	v_mfma_f32_16x16x32_bf16 v[124:127], a[100:103], a[36:39], v[124:127]
	ds_read_b64_tr_b16 a[214:215], v21 offset:40960
	v_cvt_pk_bf16_f32 v70, v60, v61
	v_mfma_f32_16x16x32_bf16 v[112:115], a[104:107], a[40:43], v[112:115]
	ds_read_b64_tr_b16 a[216:217], v22 offset:32768
	v_add_f32 v5, v5, v62
	v_mfma_f32_16x16x32_bf16 v[120:123], a[104:107], a[44:47], v[120:123]
	ds_read_b64_tr_b16 a[218:219], v22 offset:40960
	buffer_load_dwordx4 v41, s[28:31], s51 offen offset:1024 nt lds
	v_mfma_f32_16x16x32_bf16 v[116:119], a[108:111], a[40:43], v[116:119]
	ds_read_b64_tr_b16 a[220:221], v23 offset:32768
	v_add_f32 v5, v5, v63
	v_mfma_f32_16x16x32_bf16 v[124:127], a[108:111], a[44:47], v[124:127]
	ds_read_b64_tr_b16 a[222:223], v23 offset:40960
	v_cvt_pk_bf16_f32 v71, v62, v63
	v_mfma_f32_16x16x32_bf16 v[112:115], a[112:115], a[48:51], v[112:115]
	ds_read_b64_tr_b16 a[224:225], v16 offset:33024
	v_max_f32 v10, v4, v5
	v_mfma_f32_16x16x32_bf16 v[120:123], a[112:115], a[52:55], v[120:123]
	ds_read_b64_tr_b16 a[226:227], v16 offset:41216
	v_cmp_lt_f32 vcc, s47, v10
	s_waitcnt lgkmcnt(12)
	v_mfma_f32_16x16x32_bf16 v[116:119], a[116:119], a[48:51], v[116:119]
	ds_read_b64_tr_b16 a[228:229], v17 offset:33024
	v_mfma_f32_16x16x32_bf16 v[124:127], a[116:119], a[52:55], v[124:127]
	ds_read_b64_tr_b16 a[230:231], v17 offset:41216
	buffer_load_dwordx4 v42, s[28:31], s51 offen offset:2048 nt lds
	v_mfma_f32_16x16x32_bf16 v[112:115], a[120:123], a[56:59], v[112:115]
	ds_read_b64_tr_b16 a[232:233], v18 offset:33024
	v_mfma_f32_16x16x32_bf16 v[120:123], a[120:123], a[60:63], v[120:123]
	ds_read_b64_tr_b16 a[234:235], v18 offset:41216
	v_mfma_f32_16x16x32_bf16 v[116:119], a[124:127], a[56:59], v[116:119]
	ds_read_b64_tr_b16 a[236:237], v19 offset:33024
	v_mfma_f32_16x16x32_bf16 v[124:127], a[124:127], a[60:63], v[124:127]
	ds_read_b64_tr_b16 a[238:239], v19 offset:41216
	s_cbranch_vccnz L_tramp26
L_back26:
	v_mfma_f32_16x16x32_bf16 v[128:131], a[192:195], v[64:67], v[128:131]
	ds_read_b64_tr_b16 a[240:241], v20 offset:33024
	v_add_f32 v2, v2, v4
	v_mfma_f32_16x16x32_bf16 v[136:139], a[192:195], v[68:71], v[136:139]
	ds_read_b64_tr_b16 a[242:243], v20 offset:41216
	v_add_f32 v3, v3, v5
	v_mfma_f32_16x16x32_bf16 v[132:135], a[196:199], v[64:67], v[132:135]
	ds_read_b64_tr_b16 a[244:245], v21 offset:33024
	v_mfma_f32_16x16x32_bf16 v[140:143], a[196:199], v[68:71], v[140:143]
	ds_read_b64_tr_b16 a[246:247], v21 offset:41216
	buffer_load_dwordx4 v43, s[28:31], s51 offen offset:3072 nt lds
	v_mfma_f32_16x16x32_bf16 v[144:147], a[200:203], v[64:67], v[144:147]
	ds_read_b64_tr_b16 a[248:249], v22 offset:33024
	v_mfma_f32_16x16x32_bf16 v[152:155], a[200:203], v[68:71], v[152:155]
	ds_read_b64_tr_b16 a[250:251], v22 offset:41216
	s_waitcnt lgkmcnt(13)
	v_mfma_f32_16x16x32_bf16 v[148:151], a[204:207], v[64:67], v[148:151]
	ds_read_b64_tr_b16 a[252:253], v23 offset:33024
	v_mfma_f32_16x16x32_bf16 v[156:159], a[204:207], v[68:71], v[156:159]
	ds_read_b64_tr_b16 a[254:255], v23 offset:41216
	v_mfma_f32_16x16x32_bf16 v[160:163], a[208:211], v[64:67], v[160:163]
	v_exp_f32 v48, v112
	v_mfma_f32_16x16x32_bf16 v[168:171], a[208:211], v[68:71], v[168:171]
	v_exp_f32 v49, v113
	v_mfma_f32_16x16x32_bf16 v[164:167], a[212:215], v[64:67], v[164:167]
	v_exp_f32 v50, v114
	v_mfma_f32_16x16x32_bf16 v[172:175], a[212:215], v[68:71], v[172:175]
	v_exp_f32 v51, v115
	v_mfma_f32_16x16x32_bf16 v[176:179], a[216:219], v[64:67], v[176:179]
	v_exp_f32 v52, v116
	v_mfma_f32_16x16x32_bf16 v[184:187], a[216:219], v[68:71], v[184:187]
	v_exp_f32 v53, v117
	v_mfma_f32_16x16x32_bf16 v[180:183], a[220:223], v[64:67], v[180:183]
	s_waitcnt vmcnt(16) lgkmcnt(0)
	s_barrier
	v_exp_f32 v54, v118
	v_mfma_f32_16x16x32_bf16 v[188:191], a[220:223], v[68:71], v[188:191]
	s_add_u32 m0, s45, 0xc000
	s_add_u32 s50, s50, 0x4000
	ds_read_b128 a[64:67], v12 offset:0
	v_add_f32 v4, v48, v49
	v_mfma_f32_16x16x32_bf16 v[192:195], a[224:227], v[64:67], v[192:195]
	ds_read_b128 a[68:71], v12 offset:8192
	buffer_load_dwordx4 v36, s[24:27], s50 offen offset:0 nt lds
	v_mfma_f32_16x16x32_bf16 v[200:203], a[224:227], v[68:71], v[200:203]
	ds_read_b128 a[72:75], v13 offset:0
	v_cvt_pk_bf16_f32 v72, v48, v49
	v_mfma_f32_16x16x32_bf16 v[196:199], a[228:231], v[64:67], v[196:199]
	ds_read_b128 a[76:79], v13 offset:8192
	v_add_f32 v4, v4, v50
	v_mfma_f32_16x16x32_bf16 v[204:207], a[228:231], v[68:71], v[204:207]
	ds_read_b128 a[80:83], v14 offset:0
	v_add_f32 v4, v4, v51
	v_mfma_f32_16x16x32_bf16 v[208:211], a[232:235], v[64:67], v[208:211]
	ds_read_b128 a[84:87], v14 offset:8192
	v_cvt_pk_bf16_f32 v73, v50, v51
	v_mfma_f32_16x16x32_bf16 v[216:219], a[232:235], v[68:71], v[216:219]
	ds_read_b128 a[88:91], v15 offset:0
	v_add_f32 v4, v4, v52
	v_mfma_f32_16x16x32_bf16 v[212:215], a[236:239], v[64:67], v[212:215]
	ds_read_b128 a[92:95], v15 offset:8192
	buffer_load_dwordx4 v37, s[24:27], s50 offen offset:1024 nt lds
	v_mfma_f32_16x16x32_bf16 v[220:223], a[236:239], v[68:71], v[220:223]
	ds_read_b128 a[96:99], v12 offset:256
	v_add_f32 v4, v4, v53
	v_mfma_f32_16x16x32_bf16 v[224:227], a[240:243], v[64:67], v[224:227]
	ds_read_b128 a[100:103], v12 offset:8448
	v_cvt_pk_bf16_f32 v74, v52, v53
	v_mfma_f32_16x16x32_bf16 v[232:235], a[240:243], v[68:71], v[232:235]
	ds_read_b128 a[104:107], v13 offset:256
	v_add_f32 v4, v4, v54
	v_mfma_f32_16x16x32_bf16 v[228:231], a[244:247], v[64:67], v[228:231]
	ds_read_b128 a[108:111], v13 offset:8448
	v_mfma_f32_16x16x32_bf16 v[236:239], a[244:247], v[68:71], v[236:239]
	ds_read_b128 a[112:115], v14 offset:256
	v_mfma_f32_16x16x32_bf16 v[240:243], a[248:251], v[64:67], v[240:243]
	ds_read_b128 a[116:119], v14 offset:8448
	buffer_load_dwordx4 v38, s[24:27], s50 offen offset:2048 nt lds
	v_mfma_f32_16x16x32_bf16 v[248:251], a[248:251], v[68:71], v[248:251]
	ds_read_b128 a[120:123], v15 offset:256
	v_mfma_f32_16x16x32_bf16 v[244:247], a[252:255], v[64:67], v[244:247]
	ds_read_b128 a[124:127], v15 offset:8448
	v_mfma_f32_16x16x32_bf16 v[252:255], a[252:255], v[68:71], v[252:255]
	v_exp_f32 v55, v119
	s_waitcnt lgkmcnt(12)
	v_mfma_f32_16x16x32_bf16 v[96:99], a[64:67], a[0:3], v[80:83]
	v_exp_f32 v56, v120
	v_mfma_f32_16x16x32_bf16 v[104:107], a[64:67], a[4:7], v[84:87]
	v_exp_f32 v57, v121
	v_mfma_f32_16x16x32_bf16 v[100:103], a[68:71], a[0:3], v[80:83]
	v_exp_f32 v58, v122
	v_mfma_f32_16x16x32_bf16 v[108:111], a[68:71], a[4:7], v[84:87]
	v_exp_f32 v59, v123
	v_mfma_f32_16x16x32_bf16 v[96:99], a[72:75], a[8:11], v[96:99]
	v_exp_f32 v60, v124
	v_mfma_f32_16x16x32_bf16 v[104:107], a[72:75], a[12:15], v[104:107]
	v_exp_f32 v61, v125
	v_mfma_f32_16x16x32_bf16 v[100:103], a[76:79], a[8:11], v[100:103]
	v_exp_f32 v62, v126
	v_mfma_f32_16x16x32_bf16 v[108:111], a[76:79], a[12:15], v[108:111]
	v_exp_f32 v63, v127
	s_waitcnt lgkmcnt(3)
	v_mfma_f32_16x16x32_bf16 v[96:99], a[80:83], a[16:19], v[96:99]
	ds_read_b64_tr_b16 a[192:193], v16 offset:49152
	v_add_f32 v4, v4, v55
	v_mfma_f32_16x16x32_bf16 v[104:107], a[80:83], a[20:23], v[104:107]
	buffer_load_dword v91, v89, s[8:11], 0 offen sc1
	ds_read_b64_tr_b16 a[194:195], v16 offset:57344
	buffer_load_dwordx4 v39, s[24:27], s50 offen offset:3072 nt lds
	v_mfma_f32_16x16x32_bf16 v[100:103], a[84:87], a[16:19], v[100:103]
	ds_read_b64_tr_b16 a[196:197], v17 offset:49152
	v_cvt_pk_bf16_f32 v75, v54, v55
	v_mfma_f32_16x16x32_bf16 v[108:111], a[84:87], a[20:23], v[108:111]
	ds_read_b64_tr_b16 a[198:199], v17 offset:57344
	v_add_f32 v5, v56, v57
	v_mfma_f32_16x16x32_bf16 v[96:99], a[88:91], a[24:27], v[96:99]
	ds_read_b64_tr_b16 a[200:201], v18 offset:49152
	v_cvt_pk_bf16_f32 v76, v56, v57
	v_mfma_f32_16x16x32_bf16 v[104:107], a[88:91], a[28:31], v[104:107]
	ds_read_b64_tr_b16 a[202:203], v18 offset:57344
	v_add_f32 v5, v5, v58
	v_mfma_f32_16x16x32_bf16 v[100:103], a[92:95], a[24:27], v[100:103]
	s_add_u32 m0, s45, 0x18000
	s_add_u32 s51, s51, 0x4000
	ds_read_b64_tr_b16 a[204:205], v19 offset:49152
	v_add_f32 v5, v5, v59
	v_mfma_f32_16x16x32_bf16 v[108:111], a[92:95], a[28:31], v[108:111]
	ds_read_b64_tr_b16 a[206:207], v19 offset:57344
	buffer_load_dwordx4 v40, s[28:31], s51 offen offset:0 nt lds
	v_mfma_f32_16x16x32_bf16 v[96:99], a[96:99], a[32:35], v[96:99]
	ds_read_b64_tr_b16 a[208:209], v20 offset:49152
	v_cvt_pk_bf16_f32 v77, v58, v59
	v_mfma_f32_16x16x32_bf16 v[104:107], a[96:99], a[36:39], v[104:107]
	ds_read_b64_tr_b16 a[210:211], v20 offset:57344
	v_add_f32 v5, v5, v60
	v_mfma_f32_16x16x32_bf16 v[100:103], a[100:103], a[32:35], v[100:103]
	ds_read_b64_tr_b16 a[212:213], v21 offset:49152
	v_add_f32 v5, v5, v61
	v_mfma_f32_16x16x32_bf16 v[108:111], a[100:103], a[36:39], v[108:111]
	ds_read_b64_tr_b16 a[214:215], v21 offset:57344
	v_cvt_pk_bf16_f32 v78, v60, v61
	v_mfma_f32_16x16x32_bf16 v[96:99], a[104:107], a[40:43], v[96:99]
	ds_read_b64_tr_b16 a[216:217], v22 offset:49152
	v_add_f32 v5, v5, v62
	v_mfma_f32_16x16x32_bf16 v[104:107], a[104:107], a[44:47], v[104:107]
	ds_read_b64_tr_b16 a[218:219], v22 offset:57344
	buffer_load_dwordx4 v41, s[28:31], s51 offen offset:1024 nt lds
	v_mfma_f32_16x16x32_bf16 v[100:103], a[108:111], a[40:43], v[100:103]
	ds_read_b64_tr_b16 a[220:221], v23 offset:49152
	v_add_f32 v5, v5, v63
	v_mfma_f32_16x16x32_bf16 v[108:111], a[108:111], a[44:47], v[108:111]
	ds_read_b64_tr_b16 a[222:223], v23 offset:57344
	v_cvt_pk_bf16_f32 v79, v62, v63
	v_mfma_f32_16x16x32_bf16 v[96:99], a[112:115], a[48:51], v[96:99]
	ds_read_b64_tr_b16 a[224:225], v16 offset:49408
	v_max_f32 v10, v4, v5
	v_mfma_f32_16x16x32_bf16 v[104:107], a[112:115], a[52:55], v[104:107]
	ds_read_b64_tr_b16 a[226:227], v16 offset:57600
	v_cmp_lt_f32 vcc, s47, v10
	s_waitcnt lgkmcnt(12)
	v_mfma_f32_16x16x32_bf16 v[100:103], a[116:119], a[48:51], v[100:103]
	ds_read_b64_tr_b16 a[228:229], v17 offset:49408
	v_mfma_f32_16x16x32_bf16 v[108:111], a[116:119], a[52:55], v[108:111]
	ds_read_b64_tr_b16 a[230:231], v17 offset:57600
	buffer_load_dwordx4 v42, s[28:31], s51 offen offset:2048 nt lds
	v_mfma_f32_16x16x32_bf16 v[96:99], a[120:123], a[56:59], v[96:99]
	ds_read_b64_tr_b16 a[232:233], v18 offset:49408
	v_mfma_f32_16x16x32_bf16 v[104:107], a[120:123], a[60:63], v[104:107]
	ds_read_b64_tr_b16 a[234:235], v18 offset:57600
	v_mfma_f32_16x16x32_bf16 v[100:103], a[124:127], a[56:59], v[100:103]
	ds_read_b64_tr_b16 a[236:237], v19 offset:49408
	v_mfma_f32_16x16x32_bf16 v[108:111], a[124:127], a[60:63], v[108:111]
	ds_read_b64_tr_b16 a[238:239], v19 offset:57600
	s_cbranch_vccnz L_tramp27
L_back27:
	v_mfma_f32_16x16x32_bf16 v[128:131], a[192:195], v[72:75], v[128:131]
	ds_read_b64_tr_b16 a[240:241], v20 offset:49408
	v_add_f32 v2, v2, v4
	v_mfma_f32_16x16x32_bf16 v[136:139], a[192:195], v[76:79], v[136:139]
	ds_read_b64_tr_b16 a[242:243], v20 offset:57600
	v_add_f32 v3, v3, v5
	v_mfma_f32_16x16x32_bf16 v[132:135], a[196:199], v[72:75], v[132:135]
	ds_read_b64_tr_b16 a[244:245], v21 offset:49408
	v_mfma_f32_16x16x32_bf16 v[140:143], a[196:199], v[76:79], v[140:143]
	ds_read_b64_tr_b16 a[246:247], v21 offset:57600
	buffer_load_dwordx4 v43, s[28:31], s51 offen offset:3072 nt lds
	v_mfma_f32_16x16x32_bf16 v[144:147], a[200:203], v[72:75], v[144:147]
	ds_read_b64_tr_b16 a[248:249], v22 offset:49408
	v_mfma_f32_16x16x32_bf16 v[152:155], a[200:203], v[76:79], v[152:155]
	ds_read_b64_tr_b16 a[250:251], v22 offset:57600
	s_waitcnt lgkmcnt(13)
	v_mfma_f32_16x16x32_bf16 v[148:151], a[204:207], v[72:75], v[148:151]
	ds_read_b64_tr_b16 a[252:253], v23 offset:49408
	v_mfma_f32_16x16x32_bf16 v[156:159], a[204:207], v[76:79], v[156:159]
	ds_read_b64_tr_b16 a[254:255], v23 offset:57600
	v_mfma_f32_16x16x32_bf16 v[160:163], a[208:211], v[72:75], v[160:163]
	v_exp_f32 v48, v96
	v_mfma_f32_16x16x32_bf16 v[168:171], a[208:211], v[76:79], v[168:171]
	v_exp_f32 v49, v97
	v_mfma_f32_16x16x32_bf16 v[164:167], a[212:215], v[72:75], v[164:167]
	v_exp_f32 v50, v98
	v_mfma_f32_16x16x32_bf16 v[172:175], a[212:215], v[76:79], v[172:175]
	v_exp_f32 v51, v99
	v_mfma_f32_16x16x32_bf16 v[176:179], a[216:219], v[72:75], v[176:179]
	v_exp_f32 v52, v100
	v_mfma_f32_16x16x32_bf16 v[184:187], a[216:219], v[76:79], v[184:187]
	v_exp_f32 v53, v101
	v_mfma_f32_16x16x32_bf16 v[180:183], a[220:223], v[72:75], v[180:183]
	s_waitcnt vmcnt(17) lgkmcnt(0)
	s_barrier
	v_exp_f32 v54, v102
	v_mfma_f32_16x16x32_bf16 v[188:191], a[220:223], v[76:79], v[188:191]
	s_add_u32 m0, s45, 0x1c000
	s_add_u32 s51, s51, 0x4000
	ds_read_b128 a[64:67], v12 offset:16384
	v_add_f32 v4, v48, v49
	v_mfma_f32_16x16x32_bf16 v[192:195], a[224:227], v[72:75], v[192:195]
	ds_read_b128 a[68:71], v12 offset:24576
	buffer_load_dwordx4 v40, s[28:31], s51 offen offset:0 nt lds
	v_mfma_f32_16x16x32_bf16 v[200:203], a[224:227], v[76:79], v[200:203]
	ds_read_b128 a[72:75], v13 offset:16384
	v_cvt_pk_bf16_f32 v64, v48, v49
	v_mfma_f32_16x16x32_bf16 v[196:199], a[228:231], v[72:75], v[196:199]
	ds_read_b128 a[76:79], v13 offset:24576
	v_add_f32 v4, v4, v50
	v_mfma_f32_16x16x32_bf16 v[204:207], a[228:231], v[76:79], v[204:207]
	ds_read_b128 a[80:83], v14 offset:16384
	v_add_f32 v4, v4, v51
	v_mfma_f32_16x16x32_bf16 v[208:211], a[232:235], v[72:75], v[208:211]
	ds_read_b128 a[84:87], v14 offset:24576
	buffer_load_dwordx4 v41, s[28:31], s51 offen offset:1024 nt lds
	v_mfma_f32_16x16x32_bf16 v[216:219], a[232:235], v[76:79], v[216:219]
	ds_read_b128 a[88:91], v15 offset:16384
	v_cvt_pk_bf16_f32 v65, v50, v51
	v_mfma_f32_16x16x32_bf16 v[212:215], a[236:239], v[72:75], v[212:215]
	ds_read_b128 a[92:95], v15 offset:24576
	v_add_f32 v4, v4, v52
	v_mfma_f32_16x16x32_bf16 v[220:223], a[236:239], v[76:79], v[220:223]
	ds_read_b128 a[96:99], v12 offset:16640
	v_add_f32 v4, v4, v53
	v_mfma_f32_16x16x32_bf16 v[224:227], a[240:243], v[72:75], v[224:227]
	ds_read_b128 a[100:103], v12 offset:24832
	buffer_load_dwordx4 v42, s[28:31], s51 offen offset:2048 nt lds
	v_mfma_f32_16x16x32_bf16 v[232:235], a[240:243], v[76:79], v[232:235]
	ds_read_b128 a[104:107], v13 offset:16640
	v_cvt_pk_bf16_f32 v66, v52, v53
	v_mfma_f32_16x16x32_bf16 v[228:231], a[244:247], v[72:75], v[228:231]
	ds_read_b128 a[108:111], v13 offset:24832
	v_add_f32 v4, v4, v54
	v_mfma_f32_16x16x32_bf16 v[236:239], a[244:247], v[76:79], v[236:239]
	ds_read_b128 a[112:115], v14 offset:16640
	v_mfma_f32_16x16x32_bf16 v[240:243], a[248:251], v[72:75], v[240:243]
	ds_read_b128 a[116:119], v14 offset:24832
	buffer_load_dwordx4 v43, s[28:31], s51 offen offset:3072 nt lds
	v_mfma_f32_16x16x32_bf16 v[248:251], a[248:251], v[76:79], v[248:251]
	ds_read_b128 a[120:123], v15 offset:16640
	v_mfma_f32_16x16x32_bf16 v[244:247], a[252:255], v[72:75], v[244:247]
	ds_read_b128 a[124:127], v15 offset:24832
	v_mfma_f32_16x16x32_bf16 v[252:255], a[252:255], v[76:79], v[252:255]
	v_exp_f32 v55, v103
	s_waitcnt lgkmcnt(12)
	v_mfma_f32_16x16x32_bf16 v[112:115], a[64:67], a[0:3], v[80:83]
	v_exp_f32 v56, v104
	v_mfma_f32_16x16x32_bf16 v[120:123], a[64:67], a[4:7], v[84:87]
	v_exp_f32 v57, v105
	v_mfma_f32_16x16x32_bf16 v[116:119], a[68:71], a[0:3], v[80:83]
	v_exp_f32 v58, v106
	v_mfma_f32_16x16x32_bf16 v[124:127], a[68:71], a[4:7], v[84:87]
	v_exp_f32 v59, v107
	v_mfma_f32_16x16x32_bf16 v[112:115], a[72:75], a[8:11], v[112:115]
	v_exp_f32 v60, v108
	v_mfma_f32_16x16x32_bf16 v[120:123], a[72:75], a[12:15], v[120:123]
	v_exp_f32 v61, v109
	v_mfma_f32_16x16x32_bf16 v[116:119], a[76:79], a[8:11], v[116:119]
	v_exp_f32 v62, v110
	v_mfma_f32_16x16x32_bf16 v[124:127], a[76:79], a[12:15], v[124:127]
	v_exp_f32 v63, v111
	s_waitcnt lgkmcnt(3)
	v_mfma_f32_16x16x32_bf16 v[112:115], a[80:83], a[16:19], v[112:115]
	s_add_u32 m0, s46, 0x20000
	s_mov_b32 s52, 0
	ds_read_b64_tr_b16 a[192:193], v16 offset:0
	v_add_f32 v4, v4, v55
	v_mfma_f32_16x16x32_bf16 v[120:123], a[80:83], a[20:23], v[120:123]
	ds_read_b64_tr_b16 a[194:195], v16 offset:8192
	buffer_load_dwordx4 v44, s[36:39], s52 offen offset:0 lds
	v_mfma_f32_16x16x32_bf16 v[116:119], a[84:87], a[16:19], v[116:119]
	ds_read_b64_tr_b16 a[196:197], v17 offset:0
	v_cvt_pk_bf16_f32 v67, v54, v55
	v_mfma_f32_16x16x32_bf16 v[124:127], a[84:87], a[20:23], v[124:127]
	ds_read_b64_tr_b16 a[198:199], v17 offset:8192
	v_add_f32 v5, v56, v57
	v_mfma_f32_16x16x32_bf16 v[112:115], a[88:91], a[24:27], v[112:115]
	ds_read_b64_tr_b16 a[200:201], v18 offset:0
	v_cvt_pk_bf16_f32 v68, v56, v57
	v_mfma_f32_16x16x32_bf16 v[120:123], a[88:91], a[28:31], v[120:123]
	ds_read_b64_tr_b16 a[202:203], v18 offset:8192
	buffer_load_dwordx4 v45, s[36:39], s52 offen offset:1024 lds
	v_mfma_f32_16x16x32_bf16 v[116:119], a[92:95], a[24:27], v[116:119]
	ds_read_b64_tr_b16 a[204:205], v19 offset:0
	v_add_f32 v5, v5, v58
	v_mfma_f32_16x16x32_bf16 v[124:127], a[92:95], a[28:31], v[124:127]
	ds_read_b64_tr_b16 a[206:207], v19 offset:8192
	v_add_f32 v5, v5, v59
	v_mfma_f32_16x16x32_bf16 v[112:115], a[96:99], a[32:35], v[112:115]
	ds_read_b64_tr_b16 a[208:209], v20 offset:0
	v_cvt_pk_bf16_f32 v69, v58, v59
	v_mfma_f32_16x16x32_bf16 v[120:123], a[96:99], a[36:39], v[120:123]
	ds_read_b64_tr_b16 a[210:211], v20 offset:8192
	buffer_load_dwordx4 v46, s[36:39], s52 offen offset:2048 lds
	v_mfma_f32_16x16x32_bf16 v[116:119], a[100:103], a[32:35], v[116:119]
	ds_read_b64_tr_b16 a[212:213], v21 offset:0
	v_add_f32 v5, v5, v60
	v_mfma_f32_16x16x32_bf16 v[124:127], a[100:103], a[36:39], v[124:127]
	ds_read_b64_tr_b16 a[214:215], v21 offset:8192
	v_add_f32 v5, v5, v61
	v_mfma_f32_16x16x32_bf16 v[112:115], a[104:107], a[40:43], v[112:115]
	ds_read_b64_tr_b16 a[216:217], v22 offset:0
	v_cvt_pk_bf16_f32 v70, v60, v61
	v_mfma_f32_16x16x32_bf16 v[120:123], a[104:107], a[44:47], v[120:123]
	ds_read_b64_tr_b16 a[218:219], v22 offset:8192
	buffer_load_dwordx4 v47, s[36:39], s52 offen offset:3072 lds
	v_mfma_f32_16x16x32_bf16 v[116:119], a[108:111], a[40:43], v[116:119]
	ds_read_b64_tr_b16 a[220:221], v23 offset:0
	v_add_f32 v5, v5, v62
	v_mfma_f32_16x16x32_bf16 v[124:127], a[108:111], a[44:47], v[124:127]
	ds_read_b64_tr_b16 a[222:223], v23 offset:8192
	v_add_f32 v5, v5, v63
	v_mfma_f32_16x16x32_bf16 v[112:115], a[112:115], a[48:51], v[112:115]
	s_add_u32 m0, s46, 0x21000
	s_mov_b32 s52, 0x7000
	ds_read_b64_tr_b16 a[224:225], v16 offset:256
	v_cvt_pk_bf16_f32 v71, v62, v63
	v_mfma_f32_16x16x32_bf16 v[120:123], a[112:115], a[52:55], v[120:123]
	ds_read_b64_tr_b16 a[226:227], v16 offset:8448
	buffer_load_dwordx4 v44, s[36:39], s52 offen offset:0 lds
	s_waitcnt lgkmcnt(12)
	v_mfma_f32_16x16x32_bf16 v[116:119], a[116:119], a[48:51], v[116:119]
	ds_read_b64_tr_b16 a[228:229], v17 offset:256
	v_max_f32 v10, v4, v5
	v_mfma_f32_16x16x32_bf16 v[124:127], a[116:119], a[52:55], v[124:127]
	ds_read_b64_tr_b16 a[230:231], v17 offset:8448
	v_cmp_lt_f32 vcc, s47, v10
	v_mfma_f32_16x16x32_bf16 v[112:115], a[120:123], a[56:59], v[112:115]
	ds_read_b64_tr_b16 a[232:233], v18 offset:256
	v_mfma_f32_16x16x32_bf16 v[120:123], a[120:123], a[60:63], v[120:123]
	ds_read_b64_tr_b16 a[234:235], v18 offset:8448
	buffer_load_dwordx4 v45, s[36:39], s52 offen offset:1024 lds
	v_mfma_f32_16x16x32_bf16 v[116:119], a[124:127], a[56:59], v[116:119]
	ds_read_b64_tr_b16 a[236:237], v19 offset:256
	v_mfma_f32_16x16x32_bf16 v[124:127], a[124:127], a[60:63], v[124:127]
	ds_read_b64_tr_b16 a[238:239], v19 offset:8448
	s_cbranch_vccnz L_tramp28
L_back28:
	v_mfma_f32_16x16x32_bf16 v[128:131], a[192:195], v[64:67], v[128:131]
	ds_read_b64_tr_b16 a[240:241], v20 offset:256
	v_add_f32 v2, v2, v4
	v_mfma_f32_16x16x32_bf16 v[136:139], a[192:195], v[68:71], v[136:139]
	ds_read_b64_tr_b16 a[242:243], v20 offset:8448
	buffer_load_dwordx4 v46, s[36:39], s52 offen offset:2048 lds
	v_add_f32 v3, v3, v5
	v_mfma_f32_16x16x32_bf16 v[132:135], a[196:199], v[64:67], v[132:135]
	ds_read_b64_tr_b16 a[244:245], v21 offset:256
	v_mfma_f32_16x16x32_bf16 v[140:143], a[196:199], v[68:71], v[140:143]
	ds_read_b64_tr_b16 a[246:247], v21 offset:8448
	v_mfma_f32_16x16x32_bf16 v[144:147], a[200:203], v[64:67], v[144:147]
	ds_read_b64_tr_b16 a[248:249], v22 offset:256
	v_mfma_f32_16x16x32_bf16 v[152:155], a[200:203], v[68:71], v[152:155]
	ds_read_b64_tr_b16 a[250:251], v22 offset:8448
	buffer_load_dwordx4 v47, s[36:39], s52 offen offset:3072 lds
	s_waitcnt lgkmcnt(12)
	v_mfma_f32_16x16x32_bf16 v[148:151], a[204:207], v[64:67], v[148:151]
	ds_read_b64_tr_b16 a[252:253], v23 offset:256
	v_mfma_f32_16x16x32_bf16 v[156:159], a[204:207], v[68:71], v[156:159]
	ds_read_b64_tr_b16 a[254:255], v23 offset:8448
	v_mfma_f32_16x16x32_bf16 v[160:163], a[208:211], v[64:67], v[160:163]
	v_exp_f32 v48, v112
	v_mfma_f32_16x16x32_bf16 v[168:171], a[208:211], v[68:71], v[168:171]
	v_exp_f32 v49, v113
	v_mfma_f32_16x16x32_bf16 v[164:167], a[212:215], v[64:67], v[164:167]
	v_exp_f32 v50, v114
	v_mfma_f32_16x16x32_bf16 v[172:175], a[212:215], v[68:71], v[172:175]
	v_exp_f32 v51, v115
	v_mfma_f32_16x16x32_bf16 v[176:179], a[216:219], v[64:67], v[176:179]
	v_exp_f32 v52, v116
	v_mfma_f32_16x16x32_bf16 v[184:187], a[216:219], v[68:71], v[184:187]
	v_exp_f32 v53, v117
	v_mfma_f32_16x16x32_bf16 v[180:183], a[220:223], v[64:67], v[180:183]
	s_waitcnt vmcnt(21) lgkmcnt(0)
	s_barrier
	v_exp_f32 v54, v118
	v_mfma_f32_16x16x32_bf16 v[188:191], a[220:223], v[68:71], v[188:191]
	s_add_u32 m0, s46, 0
	s_mov_b32 s52, 0x80
	ds_read_b128 a[64:67], v12 offset:32768
	v_add_f32 v4, v48, v49
	v_mfma_f32_16x16x32_bf16 v[192:195], a[224:227], v[64:67], v[192:195]
	ds_read_b128 a[68:71], v12 offset:40960
	buffer_load_dwordx4 v44, s[36:39], s52 offen offset:0 lds
	v_mfma_f32_16x16x32_bf16 v[200:203], a[224:227], v[68:71], v[200:203]
	ds_read_b128 a[72:75], v13 offset:32768
	v_cvt_pk_bf16_f32 v72, v48, v49
	v_mfma_f32_16x16x32_bf16 v[196:199], a[228:231], v[64:67], v[196:199]
	ds_read_b128 a[76:79], v13 offset:40960
	v_add_f32 v4, v4, v50
	v_mfma_f32_16x16x32_bf16 v[204:207], a[228:231], v[68:71], v[204:207]
	ds_read_b128 a[80:83], v14 offset:32768
	v_add_f32 v4, v4, v51
	v_mfma_f32_16x16x32_bf16 v[208:211], a[232:235], v[64:67], v[208:211]
	ds_read_b128 a[84:87], v14 offset:40960
	v_cvt_pk_bf16_f32 v73, v50, v51
	v_mfma_f32_16x16x32_bf16 v[216:219], a[232:235], v[68:71], v[216:219]
	ds_read_b128 a[88:91], v15 offset:32768
	v_add_f32 v4, v4, v52
	v_mfma_f32_16x16x32_bf16 v[212:215], a[236:239], v[64:67], v[212:215]
	ds_read_b128 a[92:95], v15 offset:40960
	buffer_load_dwordx4 v45, s[36:39], s52 offen offset:1024 lds
	v_mfma_f32_16x16x32_bf16 v[220:223], a[236:239], v[68:71], v[220:223]
	ds_read_b128 a[96:99], v12 offset:33024
	v_add_f32 v4, v4, v53
	v_mfma_f32_16x16x32_bf16 v[224:227], a[240:243], v[64:67], v[224:227]
	ds_read_b128 a[100:103], v12 offset:41216
	v_cvt_pk_bf16_f32 v74, v52, v53
	v_mfma_f32_16x16x32_bf16 v[232:235], a[240:243], v[68:71], v[232:235]
	ds_read_b128 a[104:107], v13 offset:33024
	v_add_f32 v4, v4, v54
	v_mfma_f32_16x16x32_bf16 v[228:231], a[244:247], v[64:67], v[228:231]
	ds_read_b128 a[108:111], v13 offset:41216
	v_mfma_f32_16x16x32_bf16 v[236:239], a[244:247], v[68:71], v[236:239]
	ds_read_b128 a[112:115], v14 offset:33024
	v_mfma_f32_16x16x32_bf16 v[240:243], a[248:251], v[64:67], v[240:243]
	ds_read_b128 a[116:119], v14 offset:41216
	buffer_load_dwordx4 v46, s[36:39], s52 offen offset:2048 lds
	v_mfma_f32_16x16x32_bf16 v[248:251], a[248:251], v[68:71], v[248:251]
	ds_read_b128 a[120:123], v15 offset:33024
	v_mfma_f32_16x16x32_bf16 v[244:247], a[252:255], v[64:67], v[244:247]
	ds_read_b128 a[124:127], v15 offset:41216
	v_mfma_f32_16x16x32_bf16 v[252:255], a[252:255], v[68:71], v[252:255]
	v_exp_f32 v55, v119
	s_waitcnt lgkmcnt(12)
	v_mfma_f32_16x16x32_bf16 v[96:99], a[64:67], a[0:3], v[80:83]
	v_exp_f32 v56, v120
	v_mfma_f32_16x16x32_bf16 v[104:107], a[64:67], a[4:7], v[84:87]
	v_exp_f32 v57, v121
	v_mfma_f32_16x16x32_bf16 v[100:103], a[68:71], a[0:3], v[80:83]
	v_exp_f32 v58, v122
	v_mfma_f32_16x16x32_bf16 v[108:111], a[68:71], a[4:7], v[84:87]
	v_exp_f32 v59, v123
	v_mfma_f32_16x16x32_bf16 v[96:99], a[72:75], a[8:11], v[96:99]
	v_exp_f32 v60, v124
	v_mfma_f32_16x16x32_bf16 v[104:107], a[72:75], a[12:15], v[104:107]
	v_exp_f32 v61, v125
	v_mfma_f32_16x16x32_bf16 v[100:103], a[76:79], a[8:11], v[100:103]
	v_exp_f32 v62, v126
	v_mfma_f32_16x16x32_bf16 v[108:111], a[76:79], a[12:15], v[108:111]
	v_exp_f32 v63, v127
	s_waitcnt lgkmcnt(3)
	v_mfma_f32_16x16x32_bf16 v[96:99], a[80:83], a[16:19], v[96:99]
	ds_read_b64_tr_b16 a[192:193], v16 offset:16384
	v_add_f32 v4, v4, v55
	v_mfma_f32_16x16x32_bf16 v[104:107], a[80:83], a[20:23], v[104:107]
	ds_read_b64_tr_b16 a[194:195], v16 offset:24576
	buffer_load_dwordx4 v47, s[36:39], s52 offen offset:3072 lds
	v_mfma_f32_16x16x32_bf16 v[100:103], a[84:87], a[16:19], v[100:103]
	ds_read_b64_tr_b16 a[196:197], v17 offset:16384
	v_cvt_pk_bf16_f32 v75, v54, v55
	v_mfma_f32_16x16x32_bf16 v[108:111], a[84:87], a[20:23], v[108:111]
	ds_read_b64_tr_b16 a[198:199], v17 offset:24576
	v_add_f32 v5, v56, v57
	v_mfma_f32_16x16x32_bf16 v[96:99], a[88:91], a[24:27], v[96:99]
	ds_read_b64_tr_b16 a[200:201], v18 offset:16384
	v_cvt_pk_bf16_f32 v76, v56, v57
	v_mfma_f32_16x16x32_bf16 v[104:107], a[88:91], a[28:31], v[104:107]
	ds_read_b64_tr_b16 a[202:203], v18 offset:24576
	v_add_f32 v5, v5, v58
	v_mfma_f32_16x16x32_bf16 v[100:103], a[92:95], a[24:27], v[100:103]
	s_add_u32 m0, s46, 0x1000
	s_mov_b32 s52, 0x7080
	ds_read_b64_tr_b16 a[204:205], v19 offset:16384
	v_add_f32 v5, v5, v59
	v_mfma_f32_16x16x32_bf16 v[108:111], a[92:95], a[28:31], v[108:111]
	ds_read_b64_tr_b16 a[206:207], v19 offset:24576
	buffer_load_dwordx4 v44, s[36:39], s52 offen offset:0 lds
	v_mfma_f32_16x16x32_bf16 v[96:99], a[96:99], a[32:35], v[96:99]
	ds_read_b64_tr_b16 a[208:209], v20 offset:16384
	v_cvt_pk_bf16_f32 v77, v58, v59
	v_mfma_f32_16x16x32_bf16 v[104:107], a[96:99], a[36:39], v[104:107]
	ds_read_b64_tr_b16 a[210:211], v20 offset:24576
	v_add_f32 v5, v5, v60
	v_mfma_f32_16x16x32_bf16 v[100:103], a[100:103], a[32:35], v[100:103]
	ds_read_b64_tr_b16 a[212:213], v21 offset:16384
	v_add_f32 v5, v5, v61
	v_mfma_f32_16x16x32_bf16 v[108:111], a[100:103], a[36:39], v[108:111]
	ds_read_b64_tr_b16 a[214:215], v21 offset:24576
	v_cvt_pk_bf16_f32 v78, v60, v61
	v_mfma_f32_16x16x32_bf16 v[96:99], a[104:107], a[40:43], v[96:99]
	ds_read_b64_tr_b16 a[216:217], v22 offset:16384
	v_add_f32 v5, v5, v62
	v_mfma_f32_16x16x32_bf16 v[104:107], a[104:107], a[44:47], v[104:107]
	ds_read_b64_tr_b16 a[218:219], v22 offset:24576
	buffer_load_dwordx4 v45, s[36:39], s52 offen offset:1024 lds
	v_mfma_f32_16x16x32_bf16 v[100:103], a[108:111], a[40:43], v[100:103]
	ds_read_b64_tr_b16 a[220:221], v23 offset:16384
	v_add_f32 v5, v5, v63
	v_mfma_f32_16x16x32_bf16 v[108:111], a[108:111], a[44:47], v[108:111]
	ds_read_b64_tr_b16 a[222:223], v23 offset:24576
	v_cvt_pk_bf16_f32 v79, v62, v63
	v_mfma_f32_16x16x32_bf16 v[96:99], a[112:115], a[48:51], v[96:99]
	ds_read_b64_tr_b16 a[224:225], v16 offset:16640
	v_max_f32 v10, v4, v5
	v_mfma_f32_16x16x32_bf16 v[104:107], a[112:115], a[52:55], v[104:107]
	ds_read_b64_tr_b16 a[226:227], v16 offset:24832
	v_cmp_lt_f32 vcc, s47, v10
	s_waitcnt lgkmcnt(12)
	v_mfma_f32_16x16x32_bf16 v[100:103], a[116:119], a[48:51], v[100:103]
	ds_read_b64_tr_b16 a[228:229], v17 offset:16640
	v_mfma_f32_16x16x32_bf16 v[108:111], a[116:119], a[52:55], v[108:111]
	ds_read_b64_tr_b16 a[230:231], v17 offset:24832
	buffer_load_dwordx4 v46, s[36:39], s52 offen offset:2048 lds
	v_mfma_f32_16x16x32_bf16 v[96:99], a[120:123], a[56:59], v[96:99]
	ds_read_b64_tr_b16 a[232:233], v18 offset:16640
	v_mfma_f32_16x16x32_bf16 v[104:107], a[120:123], a[60:63], v[104:107]
	ds_read_b64_tr_b16 a[234:235], v18 offset:24832
	v_mfma_f32_16x16x32_bf16 v[100:103], a[124:127], a[56:59], v[100:103]
	ds_read_b64_tr_b16 a[236:237], v19 offset:16640
	v_mfma_f32_16x16x32_bf16 v[108:111], a[124:127], a[60:63], v[108:111]
	ds_read_b64_tr_b16 a[238:239], v19 offset:24832
	s_cbranch_vccnz L_tramp29
L_back29:
	v_mfma_f32_16x16x32_bf16 v[128:131], a[192:195], v[72:75], v[128:131]
	ds_read_b64_tr_b16 a[240:241], v20 offset:16640
	v_add_f32 v2, v2, v4
	v_mfma_f32_16x16x32_bf16 v[136:139], a[192:195], v[76:79], v[136:139]
	ds_read_b64_tr_b16 a[242:243], v20 offset:24832
	v_add_f32 v3, v3, v5
	v_mfma_f32_16x16x32_bf16 v[132:135], a[196:199], v[72:75], v[132:135]
	ds_read_b64_tr_b16 a[244:245], v21 offset:16640
	v_mfma_f32_16x16x32_bf16 v[140:143], a[196:199], v[76:79], v[140:143]
	ds_read_b64_tr_b16 a[246:247], v21 offset:24832
	buffer_load_dwordx4 v47, s[36:39], s52 offen offset:3072 lds
	v_mfma_f32_16x16x32_bf16 v[144:147], a[200:203], v[72:75], v[144:147]
	ds_read_b64_tr_b16 a[248:249], v22 offset:16640
	v_mfma_f32_16x16x32_bf16 v[152:155], a[200:203], v[76:79], v[152:155]
	ds_read_b64_tr_b16 a[250:251], v22 offset:24832
	s_waitcnt lgkmcnt(13)
	v_mfma_f32_16x16x32_bf16 v[148:151], a[204:207], v[72:75], v[148:151]
	ds_read_b64_tr_b16 a[252:253], v23 offset:16640
	v_mfma_f32_16x16x32_bf16 v[156:159], a[204:207], v[76:79], v[156:159]
	ds_read_b64_tr_b16 a[254:255], v23 offset:24832
	v_mfma_f32_16x16x32_bf16 v[160:163], a[208:211], v[72:75], v[160:163]
	v_exp_f32 v48, v96
	v_mfma_f32_16x16x32_bf16 v[168:171], a[208:211], v[76:79], v[168:171]
	v_exp_f32 v49, v97
	v_mfma_f32_16x16x32_bf16 v[164:167], a[212:215], v[72:75], v[164:167]
	v_exp_f32 v50, v98
	v_mfma_f32_16x16x32_bf16 v[172:175], a[212:215], v[76:79], v[172:175]
	v_exp_f32 v51, v99
	v_mfma_f32_16x16x32_bf16 v[176:179], a[216:219], v[72:75], v[176:179]
	v_exp_f32 v52, v100
	v_mfma_f32_16x16x32_bf16 v[184:187], a[216:219], v[76:79], v[184:187]
	v_exp_f32 v53, v101
	v_mfma_f32_16x16x32_bf16 v[180:183], a[220:223], v[72:75], v[180:183]
	s_waitcnt vmcnt(16) lgkmcnt(0)
	s_barrier
	v_exp_f32 v54, v102
	v_mfma_f32_16x16x32_bf16 v[188:191], a[220:223], v[76:79], v[188:191]
	s_add_u32 m0, s46, 0x10000
	s_mov_b32 s52, 0x100
	ds_read_b128 a[64:67], v12 offset:49152
	v_add_f32 v4, v48, v49
	v_mfma_f32_16x16x32_bf16 v[192:195], a[224:227], v[72:75], v[192:195]
	ds_read_b128 a[68:71], v12 offset:57344
	buffer_load_dwordx4 v44, s[36:39], s52 offen offset:0 lds
	v_mfma_f32_16x16x32_bf16 v[200:203], a[224:227], v[76:79], v[200:203]
	ds_read_b128 a[72:75], v13 offset:49152
	v_cvt_pk_bf16_f32 v64, v48, v49
	v_mfma_f32_16x16x32_bf16 v[196:199], a[228:231], v[72:75], v[196:199]
	ds_read_b128 a[76:79], v13 offset:57344
	v_add_f32 v4, v4, v50
	v_mfma_f32_16x16x32_bf16 v[204:207], a[228:231], v[76:79], v[204:207]
	ds_read_b128 a[80:83], v14 offset:49152
	v_add_f32 v4, v4, v51
	v_mfma_f32_16x16x32_bf16 v[208:211], a[232:235], v[72:75], v[208:211]
	ds_read_b128 a[84:87], v14 offset:57344
	v_cvt_pk_bf16_f32 v65, v50, v51
	v_mfma_f32_16x16x32_bf16 v[216:219], a[232:235], v[76:79], v[216:219]
	ds_read_b128 a[88:91], v15 offset:49152
	v_add_f32 v4, v4, v52
	v_mfma_f32_16x16x32_bf16 v[212:215], a[236:239], v[72:75], v[212:215]
	ds_read_b128 a[92:95], v15 offset:57344
	buffer_load_dwordx4 v45, s[36:39], s52 offen offset:1024 lds
	v_mfma_f32_16x16x32_bf16 v[220:223], a[236:239], v[76:79], v[220:223]
	ds_read_b128 a[96:99], v12 offset:49408
	v_add_f32 v4, v4, v53
	v_mfma_f32_16x16x32_bf16 v[224:227], a[240:243], v[72:75], v[224:227]
	ds_read_b128 a[100:103], v12 offset:57600
	v_cvt_pk_bf16_f32 v66, v52, v53
	v_mfma_f32_16x16x32_bf16 v[232:235], a[240:243], v[76:79], v[232:235]
	ds_read_b128 a[104:107], v13 offset:49408
	v_add_f32 v4, v4, v54
	v_mfma_f32_16x16x32_bf16 v[228:231], a[244:247], v[72:75], v[228:231]
	ds_read_b128 a[108:111], v13 offset:57600
	v_mfma_f32_16x16x32_bf16 v[236:239], a[244:247], v[76:79], v[236:239]
	ds_read_b128 a[112:115], v14 offset:49408
	v_mfma_f32_16x16x32_bf16 v[240:243], a[248:251], v[72:75], v[240:243]
	ds_read_b128 a[116:119], v14 offset:57600
	buffer_load_dwordx4 v46, s[36:39], s52 offen offset:2048 lds
	v_mfma_f32_16x16x32_bf16 v[248:251], a[248:251], v[76:79], v[248:251]
	ds_read_b128 a[120:123], v15 offset:49408
	v_mfma_f32_16x16x32_bf16 v[244:247], a[252:255], v[72:75], v[244:247]
	ds_read_b128 a[124:127], v15 offset:57600
	v_mfma_f32_16x16x32_bf16 v[252:255], a[252:255], v[76:79], v[252:255]
	v_exp_f32 v55, v103
	s_waitcnt lgkmcnt(12)
	v_mfma_f32_16x16x32_bf16 v[112:115], a[64:67], a[0:3], v[80:83]
	v_exp_f32 v56, v104
	v_mfma_f32_16x16x32_bf16 v[120:123], a[64:67], a[4:7], v[84:87]
	v_exp_f32 v57, v105
	v_mfma_f32_16x16x32_bf16 v[116:119], a[68:71], a[0:3], v[80:83]
	v_exp_f32 v58, v106
	v_mfma_f32_16x16x32_bf16 v[124:127], a[68:71], a[4:7], v[84:87]
	v_exp_f32 v59, v107
	v_mfma_f32_16x16x32_bf16 v[112:115], a[72:75], a[8:11], v[112:115]
	v_exp_f32 v60, v108
	v_mfma_f32_16x16x32_bf16 v[120:123], a[72:75], a[12:15], v[120:123]
	v_exp_f32 v61, v109
	v_mfma_f32_16x16x32_bf16 v[116:119], a[76:79], a[8:11], v[116:119]
	v_exp_f32 v62, v110
	v_mfma_f32_16x16x32_bf16 v[124:127], a[76:79], a[12:15], v[124:127]
	v_exp_f32 v63, v111
	s_waitcnt lgkmcnt(3)
	v_mfma_f32_16x16x32_bf16 v[112:115], a[80:83], a[16:19], v[112:115]
	ds_read_b64_tr_b16 a[192:193], v16 offset:32768
	v_add_f32 v4, v4, v55
	v_mfma_f32_16x16x32_bf16 v[120:123], a[80:83], a[20:23], v[120:123]
	ds_read_b64_tr_b16 a[194:195], v16 offset:40960
	buffer_load_dwordx4 v47, s[36:39], s52 offen offset:3072 lds
	v_mfma_f32_16x16x32_bf16 v[116:119], a[84:87], a[16:19], v[116:119]
	ds_read_b64_tr_b16 a[196:197], v17 offset:32768
	v_cvt_pk_bf16_f32 v67, v54, v55
	v_mfma_f32_16x16x32_bf16 v[124:127], a[84:87], a[20:23], v[124:127]
	ds_read_b64_tr_b16 a[198:199], v17 offset:40960
	v_add_f32 v5, v56, v57
	v_mfma_f32_16x16x32_bf16 v[112:115], a[88:91], a[24:27], v[112:115]
	ds_read_b64_tr_b16 a[200:201], v18 offset:32768
	v_cvt_pk_bf16_f32 v68, v56, v57
	v_mfma_f32_16x16x32_bf16 v[120:123], a[88:91], a[28:31], v[120:123]
	ds_read_b64_tr_b16 a[202:203], v18 offset:40960
	v_add_f32 v5, v5, v58
	v_mfma_f32_16x16x32_bf16 v[116:119], a[92:95], a[24:27], v[116:119]
	s_add_u32 m0, s46, 0x11000
	s_mov_b32 s52, 0x7100
	ds_read_b64_tr_b16 a[204:205], v19 offset:32768
	v_add_f32 v5, v5, v59
	v_mfma_f32_16x16x32_bf16 v[124:127], a[92:95], a[28:31], v[124:127]
	ds_read_b64_tr_b16 a[206:207], v19 offset:40960
	buffer_load_dwordx4 v44, s[36:39], s52 offen offset:0 lds
	v_mfma_f32_16x16x32_bf16 v[112:115], a[96:99], a[32:35], v[112:115]
	ds_read_b64_tr_b16 a[208:209], v20 offset:32768
	v_cvt_pk_bf16_f32 v69, v58, v59
	v_mfma_f32_16x16x32_bf16 v[120:123], a[96:99], a[36:39], v[120:123]
	ds_read_b64_tr_b16 a[210:211], v20 offset:40960
	v_add_f32 v5, v5, v60
	v_mfma_f32_16x16x32_bf16 v[116:119], a[100:103], a[32:35], v[116:119]
	ds_read_b64_tr_b16 a[212:213], v21 offset:32768
	v_add_f32 v5, v5, v61
	v_mfma_f32_16x16x32_bf16 v[124:127], a[100:103], a[36:39], v[124:127]
	ds_read_b64_tr_b16 a[214:215], v21 offset:40960
	v_cvt_pk_bf16_f32 v70, v60, v61
	v_mfma_f32_16x16x32_bf16 v[112:115], a[104:107], a[40:43], v[112:115]
	ds_read_b64_tr_b16 a[216:217], v22 offset:32768
	v_add_f32 v5, v5, v62
	v_mfma_f32_16x16x32_bf16 v[120:123], a[104:107], a[44:47], v[120:123]
	ds_read_b64_tr_b16 a[218:219], v22 offset:40960
	buffer_load_dwordx4 v45, s[36:39], s52 offen offset:1024 lds
	v_mfma_f32_16x16x32_bf16 v[116:119], a[108:111], a[40:43], v[116:119]
	ds_read_b64_tr_b16 a[220:221], v23 offset:32768
	v_add_f32 v5, v5, v63
	v_mfma_f32_16x16x32_bf16 v[124:127], a[108:111], a[44:47], v[124:127]
	ds_read_b64_tr_b16 a[222:223], v23 offset:40960
	v_cvt_pk_bf16_f32 v71, v62, v63
	v_mfma_f32_16x16x32_bf16 v[112:115], a[112:115], a[48:51], v[112:115]
	ds_read_b64_tr_b16 a[224:225], v16 offset:33024
	v_max_f32 v10, v4, v5
	v_mfma_f32_16x16x32_bf16 v[120:123], a[112:115], a[52:55], v[120:123]
	ds_read_b64_tr_b16 a[226:227], v16 offset:41216
	v_cmp_lt_f32 vcc, s47, v10
	s_waitcnt lgkmcnt(12)
	v_mfma_f32_16x16x32_bf16 v[116:119], a[116:119], a[48:51], v[116:119]
	ds_read_b64_tr_b16 a[228:229], v17 offset:33024
	v_mfma_f32_16x16x32_bf16 v[124:127], a[116:119], a[52:55], v[124:127]
	ds_read_b64_tr_b16 a[230:231], v17 offset:41216
	buffer_load_dwordx4 v46, s[36:39], s52 offen offset:2048 lds
	v_mfma_f32_16x16x32_bf16 v[112:115], a[120:123], a[56:59], v[112:115]
	ds_read_b64_tr_b16 a[232:233], v18 offset:33024
	v_mfma_f32_16x16x32_bf16 v[120:123], a[120:123], a[60:63], v[120:123]
	ds_read_b64_tr_b16 a[234:235], v18 offset:41216
	v_mfma_f32_16x16x32_bf16 v[116:119], a[124:127], a[56:59], v[116:119]
	ds_read_b64_tr_b16 a[236:237], v19 offset:33024
	v_mfma_f32_16x16x32_bf16 v[124:127], a[124:127], a[60:63], v[124:127]
	ds_read_b64_tr_b16 a[238:239], v19 offset:41216
	s_cbranch_vccnz L_tramp30
L_back30:
	v_mfma_f32_16x16x32_bf16 v[128:131], a[192:195], v[64:67], v[128:131]
	ds_read_b64_tr_b16 a[240:241], v20 offset:33024
	v_add_f32 v2, v2, v4
	v_mfma_f32_16x16x32_bf16 v[136:139], a[192:195], v[68:71], v[136:139]
	ds_read_b64_tr_b16 a[242:243], v20 offset:41216
	v_add_f32 v3, v3, v5
	v_mfma_f32_16x16x32_bf16 v[132:135], a[196:199], v[64:67], v[132:135]
	ds_read_b64_tr_b16 a[244:245], v21 offset:33024
	v_exp_f32 v48, v112
	v_mfma_f32_16x16x32_bf16 v[140:143], a[196:199], v[68:71], v[140:143]
	ds_read_b64_tr_b16 a[246:247], v21 offset:41216
	buffer_load_dwordx4 v47, s[36:39], s52 offen offset:3072 lds
	v_exp_f32 v49, v113
	v_mfma_f32_16x16x32_bf16 v[144:147], a[200:203], v[64:67], v[144:147]
	ds_read_b64_tr_b16 a[248:249], v22 offset:33024
	v_exp_f32 v50, v114
	v_mfma_f32_16x16x32_bf16 v[152:155], a[200:203], v[68:71], v[152:155]
	ds_read_b64_tr_b16 a[250:251], v22 offset:41216
	v_exp_f32 v51, v115
	s_waitcnt lgkmcnt(11)
	v_mfma_f32_16x16x32_bf16 v[148:151], a[204:207], v[64:67], v[148:151]
	ds_read_b64_tr_b16 a[252:253], v23 offset:33024
	v_exp_f32 v52, v116
	v_mfma_f32_16x16x32_bf16 v[156:159], a[204:207], v[68:71], v[156:159]
	ds_read_b64_tr_b16 a[254:255], v23 offset:41216
	v_exp_f32 v53, v117
	v_mfma_f32_16x16x32_bf16 v[160:163], a[208:211], v[64:67], v[160:163]
	v_exp_f32 v54, v118
	v_exp_f32 v55, v119
	v_mfma_f32_16x16x32_bf16 v[168:171], a[208:211], v[68:71], v[168:171]
	v_exp_f32 v56, v120
	v_exp_f32 v57, v121
	v_mfma_f32_16x16x32_bf16 v[164:167], a[212:215], v[64:67], v[164:167]
	v_exp_f32 v58, v122
	v_exp_f32 v59, v123
	v_mfma_f32_16x16x32_bf16 v[172:175], a[212:215], v[68:71], v[172:175]
	v_exp_f32 v60, v124
	v_exp_f32 v61, v125
	v_mfma_f32_16x16x32_bf16 v[176:179], a[216:219], v[64:67], v[176:179]
	v_exp_f32 v62, v126
	v_exp_f32 v63, v127
	v_mfma_f32_16x16x32_bf16 v[184:187], a[216:219], v[68:71], v[184:187]
	v_add_f32 v4, v48, v49
	v_cvt_pk_bf16_f32 v72, v48, v49
	v_add_f32 v4, v4, v50
	v_mfma_f32_16x16x32_bf16 v[180:183], a[220:223], v[64:67], v[180:183]
	s_waitcnt vmcnt(16) lgkmcnt(0)
	s_barrier
	v_add_f32 v4, v4, v51
	v_cvt_pk_bf16_f32 v73, v50, v51
	v_add_f32 v4, v4, v52
	v_mfma_f32_16x16x32_bf16 v[188:191], a[220:223], v[68:71], v[188:191]
	s_add_u32 m0, s46, 0x8000
	s_mov_b32 s52, 0x180
	v_add_f32 v4, v4, v53
	v_cvt_pk_bf16_f32 v74, v52, v53
	v_add_f32 v4, v4, v54
	v_mfma_f32_16x16x32_bf16 v[192:195], a[224:227], v[64:67], v[192:195]
	buffer_load_dwordx4 v44, s[36:39], s52 offen offset:0 lds
	v_add_f32 v4, v4, v55
	v_mfma_f32_16x16x32_bf16 v[200:203], a[224:227], v[68:71], v[200:203]
	v_cvt_pk_bf16_f32 v75, v54, v55
	v_add_f32 v5, v56, v57
	v_mfma_f32_16x16x32_bf16 v[196:199], a[228:231], v[64:67], v[196:199]
	v_cvt_pk_bf16_f32 v76, v56, v57
	v_add_f32 v5, v5, v58
	v_mfma_f32_16x16x32_bf16 v[204:207], a[228:231], v[68:71], v[204:207]
	v_add_f32 v5, v5, v59
	v_cvt_pk_bf16_f32 v77, v58, v59
	v_mfma_f32_16x16x32_bf16 v[208:211], a[232:235], v[64:67], v[208:211]
	ds_read_b64_tr_b16 a[192:193], v16 offset:49152
	buffer_load_dwordx4 v45, s[36:39], s52 offen offset:1024 lds
	v_mfma_f32_16x16x32_bf16 v[216:219], a[232:235], v[68:71], v[216:219]
	ds_read_b64_tr_b16 a[194:195], v16 offset:57344
	v_add_f32 v5, v5, v60
	v_mfma_f32_16x16x32_bf16 v[212:215], a[236:239], v[64:67], v[212:215]
	ds_read_b64_tr_b16 a[196:197], v17 offset:49152
	v_add_f32 v5, v5, v61
	v_mfma_f32_16x16x32_bf16 v[220:223], a[236:239], v[68:71], v[220:223]
	ds_read_b64_tr_b16 a[198:199], v17 offset:57344
	v_cvt_pk_bf16_f32 v78, v60, v61
	v_mfma_f32_16x16x32_bf16 v[224:227], a[240:243], v[64:67], v[224:227]
	ds_read_b64_tr_b16 a[200:201], v18 offset:49152
	buffer_load_dwordx4 v46, s[36:39], s52 offen offset:2048 lds
	v_mfma_f32_16x16x32_bf16 v[232:235], a[240:243], v[68:71], v[232:235]
	ds_read_b64_tr_b16 a[202:203], v18 offset:57344
	v_add_f32 v5, v5, v62
	v_mfma_f32_16x16x32_bf16 v[228:231], a[244:247], v[64:67], v[228:231]
	ds_read_b64_tr_b16 a[204:205], v19 offset:49152
	v_add_f32 v5, v5, v63
	v_mfma_f32_16x16x32_bf16 v[236:239], a[244:247], v[68:71], v[236:239]
	ds_read_b64_tr_b16 a[206:207], v19 offset:57344
	v_cvt_pk_bf16_f32 v79, v62, v63
	v_mfma_f32_16x16x32_bf16 v[240:243], a[248:251], v[64:67], v[240:243]
	ds_read_b64_tr_b16 a[208:209], v20 offset:49152
	buffer_load_dwordx4 v47, s[36:39], s52 offen offset:3072 lds
	v_mfma_f32_16x16x32_bf16 v[248:251], a[248:251], v[68:71], v[248:251]
	ds_read_b64_tr_b16 a[210:211], v20 offset:57344
	v_max_f32 v10, v4, v5
	v_mfma_f32_16x16x32_bf16 v[244:247], a[252:255], v[64:67], v[244:247]
	ds_read_b64_tr_b16 a[212:213], v21 offset:49152
	v_cmp_lt_f32 vcc, s47, v10
	v_mfma_f32_16x16x32_bf16 v[252:255], a[252:255], v[68:71], v[252:255]
	s_add_u32 m0, s46, 0x9000
	s_mov_b32 s52, 0x7180
	ds_read_b64_tr_b16 a[214:215], v21 offset:57344
	s_cbranch_vccnz L_tramp31
L_back31:
	s_waitcnt lgkmcnt(10)
	v_mfma_f32_16x16x32_bf16 v[128:131], a[192:195], v[72:75], v[128:131]
	ds_read_b64_tr_b16 a[216:217], v22 offset:49152
	buffer_load_dwordx4 v44, s[36:39], s52 offen offset:0 lds
	v_add_f32 v2, v2, v4
	v_mfma_f32_16x16x32_bf16 v[136:139], a[192:195], v[76:79], v[136:139]
	ds_read_b64_tr_b16 a[218:219], v22 offset:57344
	v_add_f32 v3, v3, v5
	v_readfirstlane_b32 s98, v91
	s_nop 1
	s_cmp_ge_u32 s98, 1
	s_cbranch_scc0 L_tr_dec
L_bk_dec:
	s_waitcnt lgkmcnt(10)
	v_mfma_f32_16x16x32_bf16 v[132:135], a[196:199], v[72:75], v[132:135]
	ds_read_b64_tr_b16 a[220:221], v23 offset:49152
	v_mov_b32 v10, v2
	v_mov_b32 v11, v3
	s_nop 0
	v_permlane16_swap_b32 v2, v10
	v_mfma_f32_16x16x32_bf16 v[140:143], a[196:199], v[76:79], v[140:143]
	ds_read_b64_tr_b16 a[222:223], v23 offset:57344
	v_permlane16_swap_b32 v3, v11
	v_add_f32 v2, v2, v10
	v_add_f32 v3, v3, v11
	s_lshl_b32 s51, s59, 4
	s_add_u32 s51, s51, s57
	s_mul_i32 s51, s51, 0x1c000
	s_add_u32 s20, s18, s51
	s_addc_u32 s21, s19, 0
	s_mov_b32 s22, 0x1c000
	s_lshl_b32 s51, s59, 3
	s_lshr_b32 s50, s57, 1
	s_add_u32 s51, s51, s50
	s_mul_i32 s51, s51, 0x3800
	s_add_u32 s24, s14, s51
	s_addc_u32 s25, s15, 0
	s_mov_b32 s26, 0x3800
	s_and_b32 s51, s57, 1
	s_lshl_b32 s51, s51, 6
	s_lshl_b32 s50, s44, 3
	s_add_u32 s50, s50, s51
	s_waitcnt lgkmcnt(6)
	v_mfma_f32_16x16x32_bf16 v[144:147], a[200:203], v[72:75], v[144:147]
	ds_read_b64_tr_b16 a[224:225], v16 offset:49408
	buffer_load_dwordx4 v45, s[36:39], s52 offen offset:1024 lds
	v_mov_b32 v10, v2
	v_mov_b32 v11, v3
	v_mfma_f32_16x16x32_bf16 v[152:155], a[200:203], v[76:79], v[152:155]
	ds_read_b64_tr_b16 a[226:227], v16 offset:57600
	v_permlane32_swap_b32 v2, v10
	v_permlane32_swap_b32 v3, v11
	v_mfma_f32_16x16x32_bf16 v[148:151], a[204:207], v[72:75], v[148:151]
	ds_read_b64_tr_b16 a[228:229], v17 offset:49408
	v_add_f32 v2, v2, v10
	v_add_f32 v3, v3, v11
	v_mfma_f32_16x16x32_bf16 v[156:159], a[204:207], v[76:79], v[156:159]
	ds_read_b64_tr_b16 a[230:231], v17 offset:57600
	v_rcp_f32 v8, v2
	v_mfma_f32_16x16x32_bf16 v[160:163], a[208:211], v[72:75], v[160:163]
	ds_read_b64_tr_b16 a[232:233], v18 offset:49408
	buffer_load_dwordx4 v46, s[36:39], s52 offen offset:2048 lds
	ds_read_b64_tr_b16 a[192:193], v32 offset:0
	v_rcp_f32 v9, v3
	v_mfma_f32_16x16x32_bf16 v[168:171], a[208:211], v[76:79], v[168:171]
	ds_read_b64_tr_b16 a[234:235], v18 offset:57600
	ds_read_b64_tr_b16 a[194:195], v32 offset:2048
	v_mul_f32 v128, v8, v128
	s_waitcnt lgkmcnt(8)
	v_mfma_f32_16x16x32_bf16 v[164:167], a[212:215], v[72:75], v[164:167]
	ds_read_b64_tr_b16 a[236:237], v19 offset:49408
	ds_read_b64_tr_b16 a[196:197], v33 offset:0
	v_mul_f32 v129, v8, v129
	v_mfma_f32_16x16x32_bf16 v[172:175], a[212:215], v[76:79], v[172:175]
	ds_read_b64_tr_b16 a[238:239], v19 offset:57600
	ds_read_b64_tr_b16 a[198:199], v33 offset:2048
	v_mul_f32 v130, v8, v130
	v_mfma_f32_16x16x32_bf16 v[176:179], a[216:219], v[72:75], v[176:179]
	ds_read_b64_tr_b16 a[240:241], v20 offset:49408
	buffer_load_dwordx4 v47, s[36:39], s52 offen offset:3072 lds
	ds_read_b64_tr_b16 a[200:201], v34 offset:0
	v_mfma_f32_16x16x32_bf16 v[184:187], a[216:219], v[76:79], v[184:187]
	ds_read_b64_tr_b16 a[242:243], v20 offset:57600
	ds_read_b64_tr_b16 a[202:203], v34 offset:2048
	v_mul_f32 v131, v8, v131
	v_mfma_f32_16x16x32_bf16 v[180:183], a[220:223], v[72:75], v[180:183]
	ds_read_b64_tr_b16 a[244:245], v21 offset:49408
	ds_read_b64_tr_b16 a[204:205], v35 offset:0
	v_mul_f32 v132, v8, v132
	v_mfma_f32_16x16x32_bf16 v[188:191], a[220:223], v[76:79], v[188:191]
	ds_read_b64_tr_b16 a[246:247], v21 offset:57600
	ds_read_b64_tr_b16 a[206:207], v35 offset:2048
	v_mul_f32 v133, v8, v133
	s_waitcnt lgkmcnt(15)
	v_mfma_f32_16x16x32_bf16 v[192:195], a[224:227], v[72:75], v[192:195]
	ds_read_b64_tr_b16 a[248:249], v22 offset:49408
	ds_read_b64_tr_b16 a[208:209], v32 offset:4096
	v_mul_f32 v134, v8, v134
	v_mfma_f32_16x16x32_bf16 v[200:203], a[224:227], v[76:79], v[200:203]
	ds_read_b64_tr_b16 a[250:251], v22 offset:57600
	ds_read_b64_tr_b16 a[210:211], v32 offset:6144
	v_mul_f32 v135, v8, v135
	v_mfma_f32_16x16x32_bf16 v[196:199], a[228:231], v[72:75], v[196:199]
	ds_read_b64_tr_b16 a[252:253], v23 offset:49408
	ds_read_b64_tr_b16 a[212:213], v33 offset:4096
	v_cvt_pk_bf16_f32 v128, v128, v129
	v_mfma_f32_16x16x32_bf16 v[204:207], a[228:231], v[76:79], v[204:207]
	ds_read_b64_tr_b16 a[254:255], v23 offset:57600
	ds_read_b64_tr_b16 a[214:215], v33 offset:6144
	v_cvt_pk_bf16_f32 v129, v130, v131
	s_waitcnt lgkmcnt(15)
	v_mfma_f32_16x16x32_bf16 v[208:211], a[232:235], v[72:75], v[208:211]
	ds_read_b64_tr_b16 a[216:217], v34 offset:4096
	v_cvt_pk_bf16_f32 v130, v132, v133
	v_cvt_pk_bf16_f32 v131, v134, v135
	v_mfma_f32_16x16x32_bf16 v[216:219], a[232:235], v[76:79], v[216:219]
	ds_read_b64_tr_b16 a[218:219], v34 offset:6144
	v_mul_f32 v136, v9, v136
	v_mul_f32 v137, v9, v137
	v_mfma_f32_16x16x32_bf16 v[212:215], a[236:239], v[72:75], v[212:215]
	ds_read_b64_tr_b16 a[220:221], v35 offset:4096
	v_mul_f32 v138, v9, v138
	v_mfma_f32_16x16x32_bf16 v[220:223], a[236:239], v[76:79], v[220:223]
	ds_read_b64_tr_b16 a[222:223], v35 offset:6144
	v_mul_f32 v139, v9, v139
	s_waitcnt lgkmcnt(15)
	v_mfma_f32_16x16x32_bf16 v[224:227], a[240:243], v[72:75], v[224:227]
	ds_read_b64_tr_b16 a[224:225], v32 offset:8192
	v_mul_f32 v140, v9, v140
	v_mfma_f32_16x16x32_bf16 v[232:235], a[240:243], v[76:79], v[232:235]
	ds_read_b64_tr_b16 a[226:227], v32 offset:10240
	v_mul_f32 v141, v9, v141
	s_waitcnt lgkmcnt(14)
	v_mfma_f32_16x16x32_bf16 v[228:231], a[244:247], v[72:75], v[228:231]
	ds_read_b64_tr_b16 a[228:229], v33 offset:8192
	v_mul_f32 v142, v9, v142
	v_mfma_f32_16x16x32_bf16 v[236:239], a[244:247], v[76:79], v[236:239]
	ds_read_b64_tr_b16 a[230:231], v33 offset:10240
	v_mul_f32 v143, v9, v143
	s_waitcnt lgkmcnt(13)
	v_mfma_f32_16x16x32_bf16 v[240:243], a[248:251], v[72:75], v[240:243]
	ds_read_b64_tr_b16 a[232:233], v34 offset:8192
	v_cvt_pk_bf16_f32 v136, v136, v137
	v_mfma_f32_16x16x32_bf16 v[248:251], a[248:251], v[76:79], v[248:251]
	ds_read_b64_tr_b16 a[234:235], v34 offset:10240
	v_cvt_pk_bf16_f32 v137, v138, v139
	s_waitcnt lgkmcnt(11)
	v_mfma_f32_16x16x32_bf16 v[244:247], a[252:255], v[72:75], v[244:247]
	ds_read_b64_tr_b16 a[236:237], v35 offset:8192
	v_cvt_pk_bf16_f32 v138, v140, v141
	v_mfma_f32_16x16x32_bf16 v[252:255], a[252:255], v[76:79], v[252:255]
	ds_read_b64_tr_b16 a[238:239], v35 offset:10240
	v_cvt_pk_bf16_f32 v139, v142, v143
	v_mul_f32 v144, v8, v144
	v_mul_f32 v145, v8, v145
	v_mfma_f32_16x16x32_bf16 v[48:51], a[192:195], v[128:131], 0
	ds_read_b64_tr_b16 a[240:241], v32 offset:12288
	v_mul_f32 v146, v8, v146
	v_mul_f32 v147, v8, v147
	v_mul_f32 v148, v8, v148
	v_mfma_f32_16x16x32_bf16 v[64:67], a[192:195], v[136:139], 0
	ds_read_b64_tr_b16 a[242:243], v32 offset:14336
	v_mul_f32 v149, v8, v149
	v_mul_f32 v150, v8, v150
	v_mul_f32 v151, v8, v151
	v_mfma_f32_16x16x32_bf16 v[52:55], a[196:199], v[128:131], 0
	ds_read_b64_tr_b16 a[244:245], v33 offset:12288
	v_cvt_pk_bf16_f32 v144, v144, v145
	v_cvt_pk_bf16_f32 v145, v146, v147
	v_cvt_pk_bf16_f32 v146, v148, v149
	v_mfma_f32_16x16x32_bf16 v[68:71], a[196:199], v[136:139], 0
	ds_read_b64_tr_b16 a[246:247], v33 offset:14336
	v_cvt_pk_bf16_f32 v147, v150, v151
	v_mul_f32 v152, v9, v152
	v_mul_f32 v153, v9, v153
	v_mfma_f32_16x16x32_bf16 v[56:59], a[200:203], v[128:131], 0
	ds_read_b64_tr_b16 a[248:249], v34 offset:12288
	v_mul_f32 v154, v9, v154
	v_mul_f32 v155, v9, v155
	v_mul_f32 v156, v9, v156
	v_mfma_f32_16x16x32_bf16 v[72:75], a[200:203], v[136:139], 0
	ds_read_b64_tr_b16 a[250:251], v34 offset:14336
	v_mul_f32 v157, v9, v157
	v_mul_f32 v158, v9, v158
	v_mfma_f32_16x16x32_bf16 v[60:63], a[204:207], v[128:131], 0
	ds_read_b64_tr_b16 a[252:253], v35 offset:12288
	v_mul_f32 v159, v9, v159
	v_cvt_pk_bf16_f32 v152, v152, v153
	v_mfma_f32_16x16x32_bf16 v[76:79], a[204:207], v[136:139], 0
	ds_read_b64_tr_b16 a[254:255], v35 offset:14336
	v_cvt_pk_bf16_f32 v153, v154, v155
	v_cvt_pk_bf16_f32 v154, v156, v157
	v_cvt_pk_bf16_f32 v155, v158, v159
	v_mfma_f32_16x16x32_bf16 v[48:51], a[208:211], v[144:147], v[48:51]
	ds_read_b64_tr_b16 a[192:193], v32 offset:16384
	v_mul_f32 v160, v8, v160
	v_mul_f32 v161, v8, v161
	v_mul_f32 v162, v8, v162
	v_mfma_f32_16x16x32_bf16 v[64:67], a[208:211], v[152:155], v[64:67]
	ds_read_b64_tr_b16 a[194:195], v32 offset:18432
	v_mul_f32 v163, v8, v163
	v_mul_f32 v164, v8, v164
	v_mul_f32 v165, v8, v165
	s_waitcnt lgkmcnt(9)
	v_mfma_f32_16x16x32_bf16 v[52:55], a[212:215], v[144:147], v[52:55]
	ds_read_b64_tr_b16 a[196:197], v33 offset:16384
	v_mul_f32 v166, v8, v166
	v_mul_f32 v167, v8, v167
	v_cvt_pk_bf16_f32 v160, v160, v161
	v_mfma_f32_16x16x32_bf16 v[68:71], a[212:215], v[152:155], v[68:71]
	ds_read_b64_tr_b16 a[198:199], v33 offset:18432
	v_cvt_pk_bf16_f32 v161, v162, v163
	v_cvt_pk_bf16_f32 v162, v164, v165
	v_cvt_pk_bf16_f32 v163, v166, v167
	v_mfma_f32_16x16x32_bf16 v[56:59], a[216:219], v[144:147], v[56:59]
	ds_read_b64_tr_b16 a[200:201], v34 offset:16384
	v_mul_f32 v168, v9, v168
	v_mul_f32 v169, v9, v169
	v_mul_f32 v170, v9, v170
	v_mfma_f32_16x16x32_bf16 v[72:75], a[216:219], v[152:155], v[72:75]
	ds_read_b64_tr_b16 a[202:203], v34 offset:18432
	v_mul_f32 v171, v9, v171
	v_mul_f32 v172, v9, v172
	v_mul_f32 v173, v9, v173
	v_mfma_f32_16x16x32_bf16 v[60:63], a[220:223], v[144:147], v[60:63]
	ds_read_b64_tr_b16 a[204:205], v35 offset:16384
	v_mul_f32 v174, v9, v174
	v_mul_f32 v175, v9, v175
	v_cvt_pk_bf16_f32 v168, v168, v169
	v_mfma_f32_16x16x32_bf16 v[76:79], a[220:223], v[152:155], v[76:79]
	ds_read_b64_tr_b16 a[206:207], v35 offset:18432
	v_cvt_pk_bf16_f32 v169, v170, v171
	v_cvt_pk_bf16_f32 v170, v172, v173
	v_cvt_pk_bf16_f32 v171, v174, v175
	v_mfma_f32_16x16x32_bf16 v[48:51], a[224:227], v[160:163], v[48:51]
	ds_read_b64_tr_b16 a[208:209], v32 offset:20480
	v_mul_f32 v176, v8, v176
	v_mul_f32 v177, v8, v177
	v_mul_f32 v178, v8, v178
	v_mfma_f32_16x16x32_bf16 v[64:67], a[224:227], v[168:171], v[64:67]
	ds_read_b64_tr_b16 a[210:211], v32 offset:22528
	v_mul_f32 v179, v8, v179
	v_mul_f32 v180, v8, v180
	v_mul_f32 v181, v8, v181
	v_mfma_f32_16x16x32_bf16 v[52:55], a[228:231], v[160:163], v[52:55]
	ds_read_b64_tr_b16 a[212:213], v33 offset:20480
	v_mul_f32 v182, v8, v182
	v_mul_f32 v183, v8, v183
	v_cvt_pk_bf16_f32 v176, v176, v177
	v_mfma_f32_16x16x32_bf16 v[68:71], a[228:231], v[168:171], v[68:71]
	ds_read_b64_tr_b16 a[214:215], v33 offset:22528
	v_cvt_pk_bf16_f32 v177, v178, v179
	v_cvt_pk_bf16_f32 v178, v180, v181
	v_cvt_pk_bf16_f32 v179, v182, v183
	v_mfma_f32_16x16x32_bf16 v[56:59], a[232:235], v[160:163], v[56:59]
	ds_read_b64_tr_b16 a[216:217], v34 offset:20480
	v_mul_f32 v184, v9, v184
	v_mul_f32 v185, v9, v185
	v_mul_f32 v186, v9, v186
	v_mfma_f32_16x16x32_bf16 v[72:75], a[232:235], v[168:171], v[72:75]
	ds_read_b64_tr_b16 a[218:219], v34 offset:22528
	v_mul_f32 v187, v9, v187
	v_mul_f32 v188, v9, v188
	v_mul_f32 v189, v9, v189
	v_mfma_f32_16x16x32_bf16 v[60:63], a[236:239], v[160:163], v[60:63]
	ds_read_b64_tr_b16 a[220:221], v35 offset:20480
	v_mul_f32 v190, v9, v190
	v_mul_f32 v191, v9, v191
	v_cvt_pk_bf16_f32 v184, v184, v185
	v_mfma_f32_16x16x32_bf16 v[76:79], a[236:239], v[168:171], v[76:79]
	ds_read_b64_tr_b16 a[222:223], v35 offset:22528
	v_cvt_pk_bf16_f32 v185, v186, v187
	v_cvt_pk_bf16_f32 v186, v188, v189
	v_cvt_pk_bf16_f32 v187, v190, v191
	s_waitcnt lgkmcnt(8)
	v_mfma_f32_16x16x32_bf16 v[48:51], a[240:243], v[176:179], v[48:51]
	ds_read_b64_tr_b16 a[224:225], v32 offset:24576
	v_mul_f32 v192, v8, v192
	v_mul_f32 v193, v8, v193
	v_mul_f32 v194, v8, v194
	v_mfma_f32_16x16x32_bf16 v[64:67], a[240:243], v[184:187], v[64:67]
	ds_read_b64_tr_b16 a[226:227], v32 offset:26624
	v_mul_f32 v195, v8, v195
	v_mul_f32 v196, v8, v196
	v_mul_f32 v197, v8, v197
	v_mfma_f32_16x16x32_bf16 v[52:55], a[244:247], v[176:179], v[52:55]
	ds_read_b64_tr_b16 a[228:229], v33 offset:24576
	v_mul_f32 v198, v8, v198
	v_mul_f32 v199, v8, v199
	v_cvt_pk_bf16_f32 v192, v192, v193
	v_mfma_f32_16x16x32_bf16 v[68:71], a[244:247], v[184:187], v[68:71]
	ds_read_b64_tr_b16 a[230:231], v33 offset:26624
	v_cvt_pk_bf16_f32 v193, v194, v195
	v_cvt_pk_bf16_f32 v194, v196, v197
	v_cvt_pk_bf16_f32 v195, v198, v199
	v_mfma_f32_16x16x32_bf16 v[56:59], a[248:251], v[176:179], v[56:59]
	ds_read_b64_tr_b16 a[232:233], v34 offset:24576
	v_mul_f32 v200, v9, v200
	v_mul_f32 v201, v9, v201
	v_mul_f32 v202, v9, v202
	v_mfma_f32_16x16x32_bf16 v[72:75], a[248:251], v[184:187], v[72:75]
	ds_read_b64_tr_b16 a[234:235], v34 offset:26624
	v_mul_f32 v203, v9, v203
	v_mul_f32 v204, v9, v204
	v_mul_f32 v205, v9, v205
	v_mfma_f32_16x16x32_bf16 v[60:63], a[252:255], v[176:179], v[60:63]
	ds_read_b64_tr_b16 a[236:237], v35 offset:24576
	v_mul_f32 v206, v9, v206
	v_mul_f32 v207, v9, v207
	v_cvt_pk_bf16_f32 v200, v200, v201
	v_mfma_f32_16x16x32_bf16 v[76:79], a[252:255], v[184:187], v[76:79]
	ds_read_b64_tr_b16 a[238:239], v35 offset:26624
	v_cvt_pk_bf16_f32 v201, v202, v203
	v_cvt_pk_bf16_f32 v202, v204, v205
	v_cvt_pk_bf16_f32 v203, v206, v207
	v_mfma_f32_16x16x32_bf16 v[48:51], a[192:195], v[192:195], v[48:51]
	ds_read_b64_tr_b16 a[240:241], v32 offset:28672
	v_mul_f32 v208, v8, v208
	v_mul_f32 v209, v8, v209
	v_mul_f32 v210, v8, v210
	v_mfma_f32_16x16x32_bf16 v[64:67], a[192:195], v[200:203], v[64:67]
	ds_read_b64_tr_b16 a[242:243], v32 offset:30720
	v_mul_f32 v211, v8, v211
	v_mul_f32 v212, v8, v212
	v_mul_f32 v213, v8, v213
	v_mfma_f32_16x16x32_bf16 v[52:55], a[196:199], v[192:195], v[52:55]
	ds_read_b64_tr_b16 a[244:245], v33 offset:28672
	v_mul_f32 v214, v8, v214
	v_mul_f32 v215, v8, v215
	v_cvt_pk_bf16_f32 v208, v208, v209
	v_mfma_f32_16x16x32_bf16 v[68:71], a[196:199], v[200:203], v[68:71]
	ds_read_b64_tr_b16 a[246:247], v33 offset:30720
	v_cvt_pk_bf16_f32 v209, v210, v211
	v_cvt_pk_bf16_f32 v210, v212, v213
	v_cvt_pk_bf16_f32 v211, v214, v215
	v_mfma_f32_16x16x32_bf16 v[56:59], a[200:203], v[192:195], v[56:59]
	ds_read_b64_tr_b16 a[248:249], v34 offset:28672
	v_mul_f32 v216, v9, v216
	v_mul_f32 v217, v9, v217
	v_mul_f32 v218, v9, v218
	v_mfma_f32_16x16x32_bf16 v[72:75], a[200:203], v[200:203], v[72:75]
	ds_read_b64_tr_b16 a[250:251], v34 offset:30720
	v_mul_f32 v219, v9, v219
	v_mul_f32 v220, v9, v220
	v_mul_f32 v221, v9, v221
	v_mfma_f32_16x16x32_bf16 v[60:63], a[204:207], v[192:195], v[60:63]
	s_waitcnt vmcnt(16)
	s_barrier
	ds_read_b64_tr_b16 a[252:253], v35 offset:28672
	v_mul_f32 v222, v9, v222
	v_mul_f32 v223, v9, v223
	v_cvt_pk_bf16_f32 v216, v216, v217
	v_mfma_f32_16x16x32_bf16 v[76:79], a[204:207], v[200:203], v[76:79]
	s_add_u32 m0, s46, 0x18000
	s_mov_b32 s52, 0x200
	ds_read_b64_tr_b16 a[254:255], v35 offset:30720
	v_cvt_pk_bf16_f32 v217, v218, v219
	v_cvt_pk_bf16_f32 v218, v220, v221
	v_cvt_pk_bf16_f32 v219, v222, v223
	s_waitcnt lgkmcnt(8)
	v_mfma_f32_16x16x32_bf16 v[48:51], a[208:211], v[208:211], v[48:51]
	ds_read_b64_tr_b16 a[192:193], v24 offset:0
	buffer_load_dwordx4 v44, s[36:39], s52 offen offset:0 lds
	v_mul_f32 v224, v8, v224
	v_mul_f32 v225, v8, v225
	v_mfma_f32_16x16x32_bf16 v[64:67], a[208:211], v[216:219], v[64:67]
	ds_read_b64_tr_b16 a[194:195], v24 offset:2048
	v_mul_f32 v226, v8, v226
	v_mul_f32 v227, v8, v227
	v_mul_f32 v228, v8, v228
	v_mfma_f32_16x16x32_bf16 v[52:55], a[212:215], v[208:211], v[52:55]
	ds_read_b64_tr_b16 a[196:197], v25 offset:0
	v_mul_f32 v229, v8, v229
	v_mul_f32 v230, v8, v230
	v_mul_f32 v231, v8, v231
	v_mfma_f32_16x16x32_bf16 v[68:71], a[212:215], v[216:219], v[68:71]
	ds_read_b64_tr_b16 a[198:199], v25 offset:2048
	v_cvt_pk_bf16_f32 v224, v224, v225
	v_cvt_pk_bf16_f32 v225, v226, v227
	v_cvt_pk_bf16_f32 v226, v228, v229
	v_mfma_f32_16x16x32_bf16 v[56:59], a[216:219], v[208:211], v[56:59]
	ds_read_b64_tr_b16 a[200:201], v26 offset:0
	buffer_load_dwordx4 v45, s[36:39], s52 offen offset:1024 lds
	v_cvt_pk_bf16_f32 v227, v230, v231
	v_mul_f32 v232, v9, v232
	v_mfma_f32_16x16x32_bf16 v[72:75], a[216:219], v[216:219], v[72:75]
	ds_read_b64_tr_b16 a[202:203], v26 offset:2048
	v_mul_f32 v233, v9, v233
	v_mul_f32 v234, v9, v234
	v_mul_f32 v235, v9, v235
	v_mfma_f32_16x16x32_bf16 v[60:63], a[220:223], v[208:211], v[60:63]
	ds_read_b64_tr_b16 a[204:205], v27 offset:0
	v_mul_f32 v236, v9, v236
	v_mul_f32 v237, v9, v237
	v_mul_f32 v238, v9, v238
	v_mfma_f32_16x16x32_bf16 v[76:79], a[220:223], v[216:219], v[76:79]
	ds_read_b64_tr_b16 a[206:207], v27 offset:2048
	v_mul_f32 v239, v9, v239
	v_cvt_pk_bf16_f32 v232, v232, v233
	v_cvt_pk_bf16_f32 v233, v234, v235
	v_cvt_pk_bf16_f32 v234, v236, v237
	v_cvt_pk_bf16_f32 v235, v238, v239
	v_mfma_f32_16x16x32_bf16 v[48:51], a[224:227], v[224:227], v[48:51]
	ds_read_b64_tr_b16 a[208:209], v24 offset:4096
	buffer_load_dwordx4 v46, s[36:39], s52 offen offset:2048 lds
	v_mul_f32 v240, v8, v240
	v_mul_f32 v241, v8, v241
	v_mfma_f32_16x16x32_bf16 v[64:67], a[224:227], v[232:235], v[64:67]
	ds_read_b64_tr_b16 a[210:211], v24 offset:6144
	v_mul_f32 v242, v8, v242
	v_mul_f32 v243, v8, v243
	v_mul_f32 v244, v8, v244
	v_mfma_f32_16x16x32_bf16 v[52:55], a[228:231], v[224:227], v[52:55]
	ds_read_b64_tr_b16 a[212:213], v25 offset:4096
	v_mul_f32 v245, v8, v245
	v_mul_f32 v246, v8, v246
	v_mul_f32 v247, v8, v247
	v_mfma_f32_16x16x32_bf16 v[68:71], a[228:231], v[232:235], v[68:71]
	ds_read_b64_tr_b16 a[214:215], v25 offset:6144
	v_cvt_pk_bf16_f32 v240, v240, v241
	v_cvt_pk_bf16_f32 v241, v242, v243
	v_cvt_pk_bf16_f32 v242, v244, v245
	v_mfma_f32_16x16x32_bf16 v[56:59], a[232:235], v[224:227], v[56:59]
	ds_read_b64_tr_b16 a[216:217], v26 offset:4096
	buffer_load_dwordx4 v47, s[36:39], s52 offen offset:3072 lds
	v_cvt_pk_bf16_f32 v243, v246, v247
	v_mul_f32 v248, v9, v248
	v_mfma_f32_16x16x32_bf16 v[72:75], a[232:235], v[232:235], v[72:75]
	ds_read_b64_tr_b16 a[218:219], v26 offset:6144
	v_mul_f32 v249, v9, v249
	v_mul_f32 v250, v9, v250
	v_mul_f32 v251, v9, v251
	v_mfma_f32_16x16x32_bf16 v[60:63], a[236:239], v[224:227], v[60:63]
	ds_read_b64_tr_b16 a[220:221], v27 offset:4096
	v_mul_f32 v252, v9, v252
	v_mul_f32 v253, v9, v253
	v_mul_f32 v254, v9, v254
	v_mfma_f32_16x16x32_bf16 v[76:79], a[236:239], v[232:235], v[76:79]
	s_add_u32 m0, s46, 0x19000
	s_mov_b32 s52, 0x7200
	ds_read_b64_tr_b16 a[222:223], v27 offset:6144
	v_mul_f32 v255, v9, v255
	v_cvt_pk_bf16_f32 v248, v248, v249
	v_cvt_pk_bf16_f32 v249, v250, v251
	v_cvt_pk_bf16_f32 v250, v252, v253
	v_cvt_pk_bf16_f32 v251, v254, v255
	s_waitcnt lgkmcnt(8)
	v_mfma_f32_16x16x32_bf16 v[48:51], a[240:243], v[240:243], v[48:51]
	ds_read_b64_tr_b16 a[224:225], v24 offset:8192
	buffer_load_dwordx4 v44, s[36:39], s52 offen offset:0 lds
	v_mfma_f32_16x16x32_bf16 v[64:67], a[240:243], v[248:251], v[64:67]
	ds_read_b64_tr_b16 a[226:227], v24 offset:10240
	v_and_b32 v93, 15, v1
	v_mfma_f32_16x16x32_bf16 v[52:55], a[244:247], v[240:243], v[52:55]
	ds_read_b64_tr_b16 a[228:229], v25 offset:8192
	v_lshrrev_b32 v94, 4, v1
	v_mfma_f32_16x16x32_bf16 v[68:71], a[244:247], v[248:251], v[68:71]
	ds_read_b64_tr_b16 a[230:231], v25 offset:10240
	v_and_b32 v40, 1, v1
	v_mfma_f32_16x16x32_bf16 v[56:59], a[248:251], v[240:243], v[56:59]
	ds_read_b64_tr_b16 a[232:233], v26 offset:8192
	buffer_load_dwordx4 v45, s[36:39], s52 offen offset:1024 lds
	v_mfma_f32_16x16x32_bf16 v[72:75], a[248:251], v[248:251], v[72:75]
	ds_read_b64_tr_b16 a[234:235], v26 offset:10240
	v_lshlrev_b32 v40, 4, v40
	v_mfma_f32_16x16x32_bf16 v[60:63], a[252:255], v[240:243], v[60:63]
	ds_read_b64_tr_b16 a[236:237], v27 offset:8192
	v_mov_b32 v41, 0x3f80
	v_mfma_f32_16x16x32_bf16 v[76:79], a[252:255], v[248:251], v[76:79]
	ds_read_b64_tr_b16 a[238:239], v27 offset:10240
	v_lshlrev_b32 v40, v40, v41
	v_mfma_f32_16x16x32_bf16 v[96:99], a[192:195], v[128:131], 0
	ds_read_b64_tr_b16 a[240:241], v24 offset:12288
	buffer_load_dwordx4 v46, s[36:39], s52 offen offset:2048 lds
	v_mfma_f32_16x16x32_bf16 v[112:115], a[192:195], v[136:139], 0
	ds_read_b64_tr_b16 a[242:243], v24 offset:14336
	v_lshrrev_b32 v41, 1, v93
	v_mfma_f32_16x16x32_bf16 v[100:103], a[196:199], v[128:131], 0
	ds_read_b64_tr_b16 a[244:245], v25 offset:12288
	v_cvt_pk_bf16_f32 v48, v48, v49
	v_mfma_f32_16x16x32_bf16 v[116:119], a[196:199], v[136:139], 0
	ds_read_b64_tr_b16 a[246:247], v25 offset:14336
	v_cvt_pk_bf16_f32 v49, v50, v51
	v_mfma_f32_16x16x32_bf16 v[104:107], a[200:203], v[128:131], 0
	ds_read_b64_tr_b16 a[248:249], v26 offset:12288
	buffer_load_dwordx4 v47, s[36:39], s52 offen offset:3072 lds
	v_mfma_f32_16x16x32_bf16 v[120:123], a[200:203], v[136:139], 0
	ds_read_b64_tr_b16 a[250:251], v26 offset:14336
	v_cvt_pk_bf16_f32 v50, v52, v53
	v_mfma_f32_16x16x32_bf16 v[108:111], a[204:207], v[128:131], 0
	ds_read_b64_tr_b16 a[252:253], v27 offset:12288
	v_cvt_pk_bf16_f32 v51, v54, v55
	s_mov_b32 s53, 0
	v_mfma_f32_16x16x32_bf16 v[124:127], a[204:207], v[136:139], 0
	ds_read_b64_tr_b16 a[254:255], v27 offset:14336
	buffer_store_dwordx4 v[48:51], v88, s[40:43], s53 offen offset:0 sc1
	s_waitcnt lgkmcnt(12)
	v_mfma_f32_16x16x32_bf16 v[96:99], a[208:211], v[144:147], v[96:99]
	ds_read_b64_tr_b16 a[192:193], v24 offset:16384
	v_cvt_pk_bf16_f32 v56, v56, v57
	v_mfma_f32_16x16x32_bf16 v[112:115], a[208:211], v[152:155], v[112:115]
	ds_read_b64_tr_b16 a[194:195], v24 offset:18432
	v_cvt_pk_bf16_f32 v57, v58, v59
	v_mfma_f32_16x16x32_bf16 v[100:103], a[212:215], v[144:147], v[100:103]
	ds_read_b64_tr_b16 a[196:197], v25 offset:16384
	v_cvt_pk_bf16_f32 v58, v60, v61
	v_mfma_f32_16x16x32_bf16 v[116:119], a[212:215], v[152:155], v[116:119]
	ds_read_b64_tr_b16 a[198:199], v25 offset:18432
	v_cvt_pk_bf16_f32 v59, v62, v63
	s_mov_b32 s53, 0x1c000
	v_mfma_f32_16x16x32_bf16 v[104:107], a[216:219], v[144:147], v[104:107]
	ds_read_b64_tr_b16 a[200:201], v26 offset:16384
	buffer_store_dwordx4 v[56:59], v88, s[40:43], s53 offen offset:0 sc1
	v_mfma_f32_16x16x32_bf16 v[120:123], a[216:219], v[152:155], v[120:123]
	ds_read_b64_tr_b16 a[202:203], v26 offset:18432
	v_cvt_pk_bf16_f32 v64, v64, v65
	v_mfma_f32_16x16x32_bf16 v[108:111], a[220:223], v[144:147], v[108:111]
	ds_read_b64_tr_b16 a[204:205], v27 offset:16384
	v_cvt_pk_bf16_f32 v65, v66, v67
	v_mfma_f32_16x16x32_bf16 v[124:127], a[220:223], v[152:155], v[124:127]
	ds_read_b64_tr_b16 a[206:207], v27 offset:18432
	v_cvt_pk_bf16_f32 v66, v68, v69
	v_mfma_f32_16x16x32_bf16 v[96:99], a[224:227], v[160:163], v[96:99]
	ds_read_b64_tr_b16 a[208:209], v24 offset:20480
	v_cvt_pk_bf16_f32 v67, v70, v71
	s_mov_b32 s53, 0x38000
	v_mfma_f32_16x16x32_bf16 v[112:115], a[224:227], v[168:171], v[112:115]
	ds_read_b64_tr_b16 a[210:211], v24 offset:22528
	buffer_store_dwordx4 v[64:67], v88, s[40:43], s53 offen offset:0 sc1
	v_mfma_f32_16x16x32_bf16 v[100:103], a[228:231], v[160:163], v[100:103]
	ds_read_b64_tr_b16 a[212:213], v25 offset:20480
	v_cvt_pk_bf16_f32 v72, v72, v73
	v_mfma_f32_16x16x32_bf16 v[116:119], a[228:231], v[168:171], v[116:119]
	ds_read_b64_tr_b16 a[214:215], v25 offset:22528
	v_cvt_pk_bf16_f32 v73, v74, v75
	s_waitcnt lgkmcnt(12)
	v_mfma_f32_16x16x32_bf16 v[104:107], a[232:235], v[160:163], v[104:107]
	ds_read_b64_tr_b16 a[216:217], v26 offset:20480
	v_cvt_pk_bf16_f32 v74, v76, v77
	v_mfma_f32_16x16x32_bf16 v[120:123], a[232:235], v[168:171], v[120:123]
	ds_read_b64_tr_b16 a[218:219], v26 offset:22528
	v_cvt_pk_bf16_f32 v75, v78, v79
	s_mov_b32 s53, 0x54000
	v_mfma_f32_16x16x32_bf16 v[108:111], a[236:239], v[160:163], v[108:111]
	ds_read_b64_tr_b16 a[220:221], v27 offset:20480
	buffer_store_dwordx4 v[72:75], v88, s[40:43], s53 offen offset:0 sc1
	v_mfma_f32_16x16x32_bf16 v[124:127], a[236:239], v[168:171], v[124:127]
	ds_read_b64_tr_b16 a[222:223], v27 offset:22528
	v_cmp_eq_u32 vcc, 0, v41
	v_mfma_f32_16x16x32_bf16 v[96:99], a[240:243], v[176:179], v[96:99]
	ds_read_b64_tr_b16 a[224:225], v24 offset:24576
	v_cndmask_b32 v80, v89, v40, vcc
	v_mfma_f32_16x16x32_bf16 v[112:115], a[240:243], v[184:187], v[112:115]
	ds_read_b64_tr_b16 a[226:227], v24 offset:26624
	v_cmp_eq_u32 vcc, 1, v41
	v_mfma_f32_16x16x32_bf16 v[100:103], a[244:247], v[176:179], v[100:103]
	ds_read_b64_tr_b16 a[228:229], v25 offset:24576
	v_cndmask_b32 v81, v89, v40, vcc
	v_mfma_f32_16x16x32_bf16 v[116:119], a[244:247], v[184:187], v[116:119]
	ds_read_b64_tr_b16 a[230:231], v25 offset:26624
	v_cmp_eq_u32 vcc, 2, v41
	v_mfma_f32_16x16x32_bf16 v[104:107], a[248:251], v[176:179], v[104:107]
	ds_read_b64_tr_b16 a[232:233], v26 offset:24576
	v_cndmask_b32 v82, v89, v40, vcc
	v_mfma_f32_16x16x32_bf16 v[120:123], a[248:251], v[184:187], v[120:123]
	ds_read_b64_tr_b16 a[234:235], v26 offset:26624
	v_cmp_eq_u32 vcc, 3, v41
	v_mfma_f32_16x16x32_bf16 v[108:111], a[252:255], v[176:179], v[108:111]
	ds_read_b64_tr_b16 a[236:237], v27 offset:24576
	v_cndmask_b32 v83, v89, v40, vcc
	v_mfma_f32_16x16x32_bf16 v[124:127], a[252:255], v[184:187], v[124:127]
	ds_read_b64_tr_b16 a[238:239], v27 offset:26624
	v_cmp_eq_u32 vcc, 4, v41
	s_waitcnt lgkmcnt(12)
	v_mfma_f32_16x16x32_bf16 v[96:99], a[192:195], v[192:195], v[96:99]
	ds_read_b64_tr_b16 a[240:241], v24 offset:28672
	v_cndmask_b32 v84, v89, v40, vcc
	v_mfma_f32_16x16x32_bf16 v[112:115], a[192:195], v[200:203], v[112:115]
	ds_read_b64_tr_b16 a[242:243], v24 offset:30720
	v_cmp_eq_u32 vcc, 5, v41
	v_mfma_f32_16x16x32_bf16 v[100:103], a[196:199], v[192:195], v[100:103]
	ds_read_b64_tr_b16 a[244:245], v25 offset:28672
	v_cndmask_b32 v85, v89, v40, vcc
	v_mfma_f32_16x16x32_bf16 v[116:119], a[196:199], v[200:203], v[116:119]
	ds_read_b64_tr_b16 a[246:247], v25 offset:30720
	v_cmp_eq_u32 vcc, 6, v41
	v_mfma_f32_16x16x32_bf16 v[104:107], a[200:203], v[192:195], v[104:107]
	ds_read_b64_tr_b16 a[248:249], v26 offset:28672
	v_cndmask_b32 v86, v89, v40, vcc
	v_mfma_f32_16x16x32_bf16 v[120:123], a[200:203], v[200:203], v[120:123]
	ds_read_b64_tr_b16 a[250:251], v26 offset:30720
	v_cmp_eq_u32 vcc, 7, v41
	v_mfma_f32_16x16x32_bf16 v[108:111], a[204:207], v[192:195], v[108:111]
	s_waitcnt vmcnt(20)
	s_barrier
	ds_read_b64_tr_b16 a[252:253], v27 offset:28672
	v_cndmask_b32 v87, v89, v40, vcc
	v_mfma_f32_16x16x32_bf16 v[124:127], a[204:207], v[200:203], v[124:127]
	s_add_u32 m0, s46, 0x20000
	s_mov_b32 s52, 0x280
	ds_read_b64_tr_b16 a[254:255], v27 offset:30720
	v_lshrrev_b32 v40, 6, v0
	v_mfma_f32_16x16x32_bf16 v[96:99], a[208:211], v[208:211], v[96:99]
	ds_read_b64_tr_b16 a[192:193], v28 offset:0
	buffer_load_dwordx4 v44, s[36:39], s52 offen offset:0 lds
	v_mfma_f32_16x16x32_bf16 v[112:115], a[208:211], v[216:219], v[112:115]
	ds_read_b64_tr_b16 a[194:195], v28 offset:2048
	v_lshl_add_u32 v40, v40, 4, v93
	v_mfma_f32_16x16x32_bf16 v[100:103], a[212:215], v[208:211], v[100:103]
	ds_read_b64_tr_b16 a[196:197], v29 offset:0
	v_lshlrev_b32 v40, 4, v40
	v_mfma_f32_16x16x32_bf16 v[116:119], a[212:215], v[216:219], v[116:119]
	ds_read_b64_tr_b16 a[198:199], v29 offset:2048
	v_lshl_add_u32 v40, v94, 10, v40
	s_waitcnt lgkmcnt(12)
	v_mfma_f32_16x16x32_bf16 v[104:107], a[216:219], v[208:211], v[104:107]
	ds_read_b64_tr_b16 a[200:201], v30 offset:0
	buffer_load_dwordx4 v45, s[36:39], s52 offen offset:1024 lds
	v_mfma_f32_16x16x32_bf16 v[120:123], a[216:219], v[216:219], v[120:123]
	ds_read_b64_tr_b16 a[202:203], v30 offset:2048
	v_mul_u32_u24 v41, 0x380, v93
	v_mfma_f32_16x16x32_bf16 v[108:111], a[220:223], v[208:211], v[108:111]
	ds_read_b64_tr_b16 a[204:205], v31 offset:0
	v_lshrrev_b32 v93, 1, v94
	v_mfma_f32_16x16x32_bf16 v[124:127], a[220:223], v[216:219], v[124:127]
	ds_read_b64_tr_b16 a[206:207], v31 offset:2048
	v_lshl_add_u32 v41, v93, 7, v41
	v_mfma_f32_16x16x32_bf16 v[96:99], a[224:227], v[224:227], v[96:99]
	ds_read_b64_tr_b16 a[208:209], v28 offset:4096
	buffer_load_dwordx4 v46, s[36:39], s52 offen offset:2048 lds
	v_mfma_f32_16x16x32_bf16 v[112:115], a[224:227], v[232:235], v[112:115]
	ds_read_b64_tr_b16 a[210:211], v28 offset:6144
	v_and_b32 v94, 1, v94
	v_mfma_f32_16x16x32_bf16 v[100:103], a[228:231], v[224:227], v[100:103]
	ds_read_b64_tr_b16 a[212:213], v29 offset:4096
	v_lshl_add_u32 v41, v94, 5, v41
	v_mfma_f32_16x16x32_bf16 v[116:119], a[228:231], v[232:235], v[116:119]
	ds_read_b64_tr_b16 a[214:215], v29 offset:6144
	v_lshl_add_u32 v42, v93, 30, v41
	v_mfma_f32_16x16x32_bf16 v[104:107], a[232:235], v[224:227], v[104:107]
	ds_read_b64_tr_b16 a[216:217], v30 offset:4096
	buffer_load_dwordx4 v47, s[36:39], s52 offen offset:3072 lds
	v_mfma_f32_16x16x32_bf16 v[120:123], a[232:235], v[232:235], v[120:123]
	ds_read_b64_tr_b16 a[218:219], v30 offset:6144
	v_mfma_f32_16x16x32_bf16 v[108:111], a[236:239], v[224:227], v[108:111]
	ds_read_b64_tr_b16 a[220:221], v31 offset:4096
	v_mfma_f32_16x16x32_bf16 v[124:127], a[236:239], v[232:235], v[124:127]
	s_add_u32 m0, s46, 0x21000
	s_mov_b32 s52, 0x7280
	ds_read_b64_tr_b16 a[222:223], v31 offset:6144
	s_waitcnt lgkmcnt(12)
	v_mfma_f32_16x16x32_bf16 v[96:99], a[240:243], v[240:243], v[96:99]
	ds_read_b64_tr_b16 a[224:225], v28 offset:8192
	buffer_load_dwordx4 v44, s[36:39], s52 offen offset:0 lds
	v_mfma_f32_16x16x32_bf16 v[112:115], a[240:243], v[248:251], v[112:115]
	ds_read_b64_tr_b16 a[226:227], v28 offset:10240
	v_mfma_f32_16x16x32_bf16 v[100:103], a[244:247], v[240:243], v[100:103]
	ds_read_b64_tr_b16 a[228:229], v29 offset:8192
	v_mfma_f32_16x16x32_bf16 v[116:119], a[244:247], v[248:251], v[116:119]
	ds_read_b64_tr_b16 a[230:231], v29 offset:10240
	v_mfma_f32_16x16x32_bf16 v[104:107], a[248:251], v[240:243], v[104:107]
	ds_read_b64_tr_b16 a[232:233], v30 offset:8192
	buffer_load_dwordx4 v45, s[36:39], s52 offen offset:1024 lds
	v_mfma_f32_16x16x32_bf16 v[120:123], a[248:251], v[248:251], v[120:123]
	ds_read_b64_tr_b16 a[234:235], v30 offset:10240
	v_mfma_f32_16x16x32_bf16 v[108:111], a[252:255], v[240:243], v[108:111]
	ds_read_b64_tr_b16 a[236:237], v31 offset:8192
	v_mfma_f32_16x16x32_bf16 v[124:127], a[252:255], v[248:251], v[124:127]
	ds_read_b64_tr_b16 a[238:239], v31 offset:10240
	v_mfma_f32_16x16x32_bf16 v[48:51], a[192:195], v[128:131], 0
	ds_read_b64_tr_b16 a[240:241], v28 offset:12288
	buffer_load_dwordx4 v46, s[36:39], s52 offen offset:2048 lds
	v_mfma_f32_16x16x32_bf16 v[64:67], a[192:195], v[136:139], 0
	ds_read_b64_tr_b16 a[242:243], v28 offset:14336
	v_mfma_f32_16x16x32_bf16 v[52:55], a[196:199], v[128:131], 0
	ds_read_b64_tr_b16 a[244:245], v29 offset:12288
	v_cvt_pk_bf16_f32 v96, v96, v97
	v_mfma_f32_16x16x32_bf16 v[68:71], a[196:199], v[136:139], 0
	ds_read_b64_tr_b16 a[246:247], v29 offset:14336
	v_cvt_pk_bf16_f32 v97, v98, v99
	s_waitcnt lgkmcnt(13)
	v_mfma_f32_16x16x32_bf16 v[56:59], a[200:203], v[128:131], 0
	ds_read_b64_tr_b16 a[248:249], v30 offset:12288
	buffer_load_dwordx4 v47, s[36:39], s52 offen offset:3072 lds
	v_mfma_f32_16x16x32_bf16 v[72:75], a[200:203], v[136:139], 0
	ds_read_b64_tr_b16 a[250:251], v30 offset:14336
	v_cvt_pk_bf16_f32 v98, v100, v101
	v_mfma_f32_16x16x32_bf16 v[60:63], a[204:207], v[128:131], 0
	ds_read_b64_tr_b16 a[252:253], v31 offset:12288
	v_cvt_pk_bf16_f32 v99, v102, v103
	s_mov_b32 s53, 0x4000
	v_mfma_f32_16x16x32_bf16 v[76:79], a[204:207], v[136:139], 0
	ds_read_b64_tr_b16 a[254:255], v31 offset:14336
	buffer_store_dwordx4 v[96:99], v88, s[40:43], s53 offen offset:0 sc1
	v_mfma_f32_16x16x32_bf16 v[48:51], a[208:211], v[144:147], v[48:51]
	ds_read_b64_tr_b16 a[192:193], v28 offset:16384
	v_cvt_pk_bf16_f32 v104, v104, v105
	v_mfma_f32_16x16x32_bf16 v[64:67], a[208:211], v[152:155], v[64:67]
	ds_read_b64_tr_b16 a[194:195], v28 offset:18432
	v_cvt_pk_bf16_f32 v105, v106, v107
	v_mfma_f32_16x16x32_bf16 v[52:55], a[212:215], v[144:147], v[52:55]
	ds_read_b64_tr_b16 a[196:197], v29 offset:16384
	v_cvt_pk_bf16_f32 v106, v108, v109
	v_mfma_f32_16x16x32_bf16 v[68:71], a[212:215], v[152:155], v[68:71]
	ds_read_b64_tr_b16 a[198:199], v29 offset:18432
	v_cvt_pk_bf16_f32 v107, v110, v111
	s_mov_b32 s53, 0x20000
	v_mfma_f32_16x16x32_bf16 v[56:59], a[216:219], v[144:147], v[56:59]
	ds_read_b64_tr_b16 a[200:201], v30 offset:16384
	buffer_store_dwordx4 v[104:107], v88, s[40:43], s53 offen offset:0 sc1
	v_mfma_f32_16x16x32_bf16 v[72:75], a[216:219], v[152:155], v[72:75]
	ds_read_b64_tr_b16 a[202:203], v30 offset:18432
	v_cvt_pk_bf16_f32 v112, v112, v113
	s_waitcnt lgkmcnt(12)
	v_mfma_f32_16x16x32_bf16 v[60:63], a[220:223], v[144:147], v[60:63]
	ds_read_b64_tr_b16 a[204:205], v31 offset:16384
	v_cvt_pk_bf16_f32 v113, v114, v115
	v_mfma_f32_16x16x32_bf16 v[76:79], a[220:223], v[152:155], v[76:79]
	ds_read_b64_tr_b16 a[206:207], v31 offset:18432
	v_cvt_pk_bf16_f32 v114, v116, v117
	v_mfma_f32_16x16x32_bf16 v[48:51], a[224:227], v[160:163], v[48:51]
	ds_read_b64_tr_b16 a[208:209], v28 offset:20480
	v_cvt_pk_bf16_f32 v115, v118, v119
	s_mov_b32 s53, 0x3c000
	v_mfma_f32_16x16x32_bf16 v[64:67], a[224:227], v[168:171], v[64:67]
	ds_read_b64_tr_b16 a[210:211], v28 offset:22528
	buffer_store_dwordx4 v[112:115], v88, s[40:43], s53 offen offset:0 sc1
	v_mfma_f32_16x16x32_bf16 v[52:55], a[228:231], v[160:163], v[52:55]
	ds_read_b64_tr_b16 a[212:213], v29 offset:20480
	v_cvt_pk_bf16_f32 v120, v120, v121
	v_mfma_f32_16x16x32_bf16 v[68:71], a[228:231], v[168:171], v[68:71]
	ds_read_b64_tr_b16 a[214:215], v29 offset:22528
	v_cvt_pk_bf16_f32 v121, v122, v123
	v_mfma_f32_16x16x32_bf16 v[56:59], a[232:235], v[160:163], v[56:59]
	ds_read_b64_tr_b16 a[216:217], v30 offset:20480
	v_cvt_pk_bf16_f32 v122, v124, v125
	v_mfma_f32_16x16x32_bf16 v[72:75], a[232:235], v[168:171], v[72:75]
	ds_read_b64_tr_b16 a[218:219], v30 offset:22528
	v_cvt_pk_bf16_f32 v123, v126, v127
	s_mov_b32 s53, 0x58000
	v_mfma_f32_16x16x32_bf16 v[60:63], a[236:239], v[160:163], v[60:63]
	ds_read_b64_tr_b16 a[220:221], v31 offset:20480
	buffer_store_dwordx4 v[120:123], v88, s[40:43], s53 offen offset:0 sc1
	v_mfma_f32_16x16x32_bf16 v[76:79], a[236:239], v[168:171], v[76:79]
	ds_read_b64_tr_b16 a[222:223], v31 offset:22528
	v_mfma_f32_16x16x32_bf16 v[48:51], a[240:243], v[176:179], v[48:51]
	ds_read_b64_tr_b16 a[224:225], v28 offset:24576
	v_mfma_f32_16x16x32_bf16 v[64:67], a[240:243], v[184:187], v[64:67]
	ds_read_b64_tr_b16 a[226:227], v28 offset:26624
	s_waitcnt lgkmcnt(12)
	v_mfma_f32_16x16x32_bf16 v[52:55], a[244:247], v[176:179], v[52:55]
	ds_read_b64_tr_b16 a[228:229], v29 offset:24576
	v_mfma_f32_16x16x32_bf16 v[68:71], a[244:247], v[184:187], v[68:71]
	ds_read_b64_tr_b16 a[230:231], v29 offset:26624
	v_mfma_f32_16x16x32_bf16 v[56:59], a[248:251], v[176:179], v[56:59]
	ds_read_b64_tr_b16 a[232:233], v30 offset:24576
	v_mfma_f32_16x16x32_bf16 v[72:75], a[248:251], v[184:187], v[72:75]
	ds_read_b64_tr_b16 a[234:235], v30 offset:26624
	v_mfma_f32_16x16x32_bf16 v[60:63], a[252:255], v[176:179], v[60:63]
	ds_read_b64_tr_b16 a[236:237], v31 offset:24576
	v_mfma_f32_16x16x32_bf16 v[76:79], a[252:255], v[184:187], v[76:79]
	ds_read_b64_tr_b16 a[238:239], v31 offset:26624
	v_mfma_f32_16x16x32_bf16 v[48:51], a[192:195], v[192:195], v[48:51]
	ds_read_b64_tr_b16 a[240:241], v28 offset:28672
	v_mfma_f32_16x16x32_bf16 v[64:67], a[192:195], v[200:203], v[64:67]
	ds_read_b64_tr_b16 a[242:243], v28 offset:30720
	v_mfma_f32_16x16x32_bf16 v[52:55], a[196:199], v[192:195], v[52:55]
	ds_read_b64_tr_b16 a[244:245], v29 offset:28672
	v_mfma_f32_16x16x32_bf16 v[68:71], a[196:199], v[200:203], v[68:71]
	ds_read_b64_tr_b16 a[246:247], v29 offset:30720
	v_mfma_f32_16x16x32_bf16 v[56:59], a[200:203], v[192:195], v[56:59]
	ds_read_b64_tr_b16 a[248:249], v30 offset:28672
	v_mfma_f32_16x16x32_bf16 v[72:75], a[200:203], v[200:203], v[72:75]
	ds_read_b64_tr_b16 a[250:251], v30 offset:30720
	s_waitcnt lgkmcnt(13)
	v_mfma_f32_16x16x32_bf16 v[60:63], a[204:207], v[192:195], v[60:63]
	s_waitcnt vmcnt(24)
	s_barrier
	ds_read_b64_tr_b16 a[252:253], v31 offset:28672
	v_mfma_f32_16x16x32_bf16 v[76:79], a[204:207], v[200:203], v[76:79]
	s_add_u32 m0, s46, 0
	s_mov_b32 s52, 0x300
	ds_read_b64_tr_b16 a[254:255], v31 offset:30720
	v_mfma_f32_16x16x32_bf16 v[48:51], a[208:211], v[208:211], v[48:51]
	ds_read_b64_tr_b16 a[192:193], v24 offset:32768
	buffer_load_dwordx4 v44, s[36:39], s52 offen offset:0 lds
	v_mfma_f32_16x16x32_bf16 v[64:67], a[208:211], v[216:219], v[64:67]
	ds_read_b64_tr_b16 a[194:195], v24 offset:34816
	v_mfma_f32_16x16x32_bf16 v[52:55], a[212:215], v[208:211], v[52:55]
	ds_read_b64_tr_b16 a[196:197], v25 offset:32768
	v_mfma_f32_16x16x32_bf16 v[68:71], a[212:215], v[216:219], v[68:71]
	ds_read_b64_tr_b16 a[198:199], v25 offset:34816
	v_mfma_f32_16x16x32_bf16 v[56:59], a[216:219], v[208:211], v[56:59]
	ds_read_b64_tr_b16 a[200:201], v26 offset:32768
	buffer_load_dwordx4 v45, s[36:39], s52 offen offset:1024 lds
	v_mfma_f32_16x16x32_bf16 v[72:75], a[216:219], v[216:219], v[72:75]
	ds_read_b64_tr_b16 a[202:203], v26 offset:34816
	v_mfma_f32_16x16x32_bf16 v[60:63], a[220:223], v[208:211], v[60:63]
	ds_read_b64_tr_b16 a[204:205], v27 offset:32768
	v_mfma_f32_16x16x32_bf16 v[76:79], a[220:223], v[216:219], v[76:79]
	ds_read_b64_tr_b16 a[206:207], v27 offset:34816
	s_waitcnt lgkmcnt(13)
	v_mfma_f32_16x16x32_bf16 v[48:51], a[224:227], v[224:227], v[48:51]
	ds_read_b64_tr_b16 a[208:209], v24 offset:36864
	buffer_load_dwordx4 v46, s[36:39], s52 offen offset:2048 lds
	v_mfma_f32_16x16x32_bf16 v[64:67], a[224:227], v[232:235], v[64:67]
	ds_read_b64_tr_b16 a[210:211], v24 offset:38912
	v_mfma_f32_16x16x32_bf16 v[52:55], a[228:231], v[224:227], v[52:55]
	ds_read_b64_tr_b16 a[212:213], v25 offset:36864
	v_mfma_f32_16x16x32_bf16 v[68:71], a[228:231], v[232:235], v[68:71]
	ds_read_b64_tr_b16 a[214:215], v25 offset:38912
	v_mfma_f32_16x16x32_bf16 v[56:59], a[232:235], v[224:227], v[56:59]
	ds_read_b64_tr_b16 a[216:217], v26 offset:36864
	buffer_load_dwordx4 v47, s[36:39], s52 offen offset:3072 lds
	v_mfma_f32_16x16x32_bf16 v[72:75], a[232:235], v[232:235], v[72:75]
	ds_read_b64_tr_b16 a[218:219], v26 offset:38912
	v_mfma_f32_16x16x32_bf16 v[60:63], a[236:239], v[224:227], v[60:63]
	ds_read_b64_tr_b16 a[220:221], v27 offset:36864
	v_mfma_f32_16x16x32_bf16 v[76:79], a[236:239], v[232:235], v[76:79]
	s_add_u32 m0, s46, 0x1000
	s_mov_b32 s52, 0x7300
	ds_read_b64_tr_b16 a[222:223], v27 offset:38912
	v_mfma_f32_16x16x32_bf16 v[48:51], a[240:243], v[240:243], v[48:51]
	ds_read_b64_tr_b16 a[224:225], v24 offset:40960
	buffer_load_dwordx4 v44, s[36:39], s52 offen offset:0 lds
	v_mfma_f32_16x16x32_bf16 v[64:67], a[240:243], v[248:251], v[64:67]
	ds_read_b64_tr_b16 a[226:227], v24 offset:43008
	s_waitcnt lgkmcnt(13)
	v_mfma_f32_16x16x32_bf16 v[52:55], a[244:247], v[240:243], v[52:55]
	ds_read_b64_tr_b16 a[228:229], v25 offset:40960
	v_mfma_f32_16x16x32_bf16 v[68:71], a[244:247], v[248:251], v[68:71]
	ds_read_b64_tr_b16 a[230:231], v25 offset:43008
	v_mfma_f32_16x16x32_bf16 v[56:59], a[248:251], v[240:243], v[56:59]
	ds_read_b64_tr_b16 a[232:233], v26 offset:40960
	buffer_load_dwordx4 v45, s[36:39], s52 offen offset:1024 lds
	v_mfma_f32_16x16x32_bf16 v[72:75], a[248:251], v[248:251], v[72:75]
	ds_read_b64_tr_b16 a[234:235], v26 offset:43008
	v_mfma_f32_16x16x32_bf16 v[60:63], a[252:255], v[240:243], v[60:63]
	ds_read_b64_tr_b16 a[236:237], v27 offset:40960
	v_mfma_f32_16x16x32_bf16 v[76:79], a[252:255], v[248:251], v[76:79]
	ds_read_b64_tr_b16 a[238:239], v27 offset:43008
	v_mfma_f32_16x16x32_bf16 v[96:99], a[192:195], v[128:131], 0
	ds_read_b64_tr_b16 a[240:241], v24 offset:45056
	buffer_load_dwordx4 v46, s[36:39], s52 offen offset:2048 lds
	v_mfma_f32_16x16x32_bf16 v[112:115], a[192:195], v[136:139], 0
	ds_read_b64_tr_b16 a[242:243], v24 offset:47104
	v_mfma_f32_16x16x32_bf16 v[100:103], a[196:199], v[128:131], 0
	ds_read_b64_tr_b16 a[244:245], v25 offset:45056
	v_cvt_pk_bf16_f32 v48, v48, v49
	v_mfma_f32_16x16x32_bf16 v[116:119], a[196:199], v[136:139], 0
	ds_read_b64_tr_b16 a[246:247], v25 offset:47104
	v_cvt_pk_bf16_f32 v49, v50, v51
	s_waitcnt lgkmcnt(13)
	v_mfma_f32_16x16x32_bf16 v[104:107], a[200:203], v[128:131], 0
	ds_read_b64_tr_b16 a[248:249], v26 offset:45056
	buffer_load_dwordx4 v47, s[36:39], s52 offen offset:3072 lds
	v_mfma_f32_16x16x32_bf16 v[120:123], a[200:203], v[136:139], 0
	ds_read_b64_tr_b16 a[250:251], v26 offset:47104
	v_cvt_pk_bf16_f32 v50, v52, v53
	v_mfma_f32_16x16x32_bf16 v[108:111], a[204:207], v[128:131], 0
	ds_read_b64_tr_b16 a[252:253], v27 offset:45056
	v_cvt_pk_bf16_f32 v51, v54, v55
	s_mov_b32 s53, 0x8000
	v_mfma_f32_16x16x32_bf16 v[124:127], a[204:207], v[136:139], 0
	ds_read_b64_tr_b16 a[254:255], v27 offset:47104
	buffer_store_dwordx4 v[48:51], v88, s[40:43], s53 offen offset:0 sc1
	v_mfma_f32_16x16x32_bf16 v[96:99], a[208:211], v[144:147], v[96:99]
	ds_read_b64_tr_b16 a[192:193], v24 offset:49152
	v_cvt_pk_bf16_f32 v56, v56, v57
	v_mfma_f32_16x16x32_bf16 v[112:115], a[208:211], v[152:155], v[112:115]
	ds_read_b64_tr_b16 a[194:195], v24 offset:51200
	v_cvt_pk_bf16_f32 v57, v58, v59
	v_mfma_f32_16x16x32_bf16 v[100:103], a[212:215], v[144:147], v[100:103]
	ds_read_b64_tr_b16 a[196:197], v25 offset:49152
	v_cvt_pk_bf16_f32 v58, v60, v61
	v_mfma_f32_16x16x32_bf16 v[116:119], a[212:215], v[152:155], v[116:119]
	ds_read_b64_tr_b16 a[198:199], v25 offset:51200
	v_cvt_pk_bf16_f32 v59, v62, v63
	s_mov_b32 s53, 0x24000
	v_mfma_f32_16x16x32_bf16 v[104:107], a[216:219], v[144:147], v[104:107]
	ds_read_b64_tr_b16 a[200:201], v26 offset:49152
	buffer_store_dwordx4 v[56:59], v88, s[40:43], s53 offen offset:0 sc1
	v_mfma_f32_16x16x32_bf16 v[120:123], a[216:219], v[152:155], v[120:123]
	ds_read_b64_tr_b16 a[202:203], v26 offset:51200
	v_cvt_pk_bf16_f32 v64, v64, v65
	s_waitcnt lgkmcnt(12)
	v_mfma_f32_16x16x32_bf16 v[108:111], a[220:223], v[144:147], v[108:111]
	ds_read_b64_tr_b16 a[204:205], v27 offset:49152
	v_cvt_pk_bf16_f32 v65, v66, v67
	v_mfma_f32_16x16x32_bf16 v[124:127], a[220:223], v[152:155], v[124:127]
	ds_read_b64_tr_b16 a[206:207], v27 offset:51200
	v_cvt_pk_bf16_f32 v66, v68, v69
	v_mfma_f32_16x16x32_bf16 v[96:99], a[224:227], v[160:163], v[96:99]
	ds_read_b64_tr_b16 a[208:209], v24 offset:53248
	v_cvt_pk_bf16_f32 v67, v70, v71
	s_mov_b32 s53, 0x40000
	v_mfma_f32_16x16x32_bf16 v[112:115], a[224:227], v[168:171], v[112:115]
	ds_read_b64_tr_b16 a[210:211], v24 offset:55296
	buffer_store_dwordx4 v[64:67], v88, s[40:43], s53 offen offset:0 sc1
	v_mfma_f32_16x16x32_bf16 v[100:103], a[228:231], v[160:163], v[100:103]
	ds_read_b64_tr_b16 a[212:213], v25 offset:53248
	v_cvt_pk_bf16_f32 v72, v72, v73
	v_mfma_f32_16x16x32_bf16 v[116:119], a[228:231], v[168:171], v[116:119]
	ds_read_b64_tr_b16 a[214:215], v25 offset:55296
	v_cvt_pk_bf16_f32 v73, v74, v75
	v_mfma_f32_16x16x32_bf16 v[104:107], a[232:235], v[160:163], v[104:107]
	ds_read_b64_tr_b16 a[216:217], v26 offset:53248
	v_cvt_pk_bf16_f32 v74, v76, v77
	v_mfma_f32_16x16x32_bf16 v[120:123], a[232:235], v[168:171], v[120:123]
	ds_read_b64_tr_b16 a[218:219], v26 offset:55296
	v_cvt_pk_bf16_f32 v75, v78, v79
	s_mov_b32 s53, 0x5c000
	v_mfma_f32_16x16x32_bf16 v[108:111], a[236:239], v[160:163], v[108:111]
	ds_read_b64_tr_b16 a[220:221], v27 offset:53248
	buffer_store_dwordx4 v[72:75], v88, s[40:43], s53 offen offset:0 sc1
	v_mfma_f32_16x16x32_bf16 v[124:127], a[236:239], v[168:171], v[124:127]
	ds_read_b64_tr_b16 a[222:223], v27 offset:55296
	v_mfma_f32_16x16x32_bf16 v[96:99], a[240:243], v[176:179], v[96:99]
	ds_read_b64_tr_b16 a[224:225], v24 offset:57344
	v_mfma_f32_16x16x32_bf16 v[112:115], a[240:243], v[184:187], v[112:115]
	ds_read_b64_tr_b16 a[226:227], v24 offset:59392
	s_waitcnt lgkmcnt(12)
	v_mfma_f32_16x16x32_bf16 v[100:103], a[244:247], v[176:179], v[100:103]
	ds_read_b64_tr_b16 a[228:229], v25 offset:57344
	v_mfma_f32_16x16x32_bf16 v[116:119], a[244:247], v[184:187], v[116:119]
	ds_read_b64_tr_b16 a[230:231], v25 offset:59392
	v_mfma_f32_16x16x32_bf16 v[104:107], a[248:251], v[176:179], v[104:107]
	ds_read_b64_tr_b16 a[232:233], v26 offset:57344
	v_mfma_f32_16x16x32_bf16 v[120:123], a[248:251], v[184:187], v[120:123]
	ds_read_b64_tr_b16 a[234:235], v26 offset:59392
	v_mfma_f32_16x16x32_bf16 v[108:111], a[252:255], v[176:179], v[108:111]
	ds_read_b64_tr_b16 a[236:237], v27 offset:57344
	v_mfma_f32_16x16x32_bf16 v[124:127], a[252:255], v[184:187], v[124:127]
	ds_read_b64_tr_b16 a[238:239], v27 offset:59392
	v_mfma_f32_16x16x32_bf16 v[96:99], a[192:195], v[192:195], v[96:99]
	ds_read_b64_tr_b16 a[240:241], v24 offset:61440
	v_mfma_f32_16x16x32_bf16 v[112:115], a[192:195], v[200:203], v[112:115]
	ds_read_b64_tr_b16 a[242:243], v24 offset:63488
	v_mfma_f32_16x16x32_bf16 v[100:103], a[196:199], v[192:195], v[100:103]
	ds_read_b64_tr_b16 a[244:245], v25 offset:61440
	v_mfma_f32_16x16x32_bf16 v[116:119], a[196:199], v[200:203], v[116:119]
	ds_read_b64_tr_b16 a[246:247], v25 offset:63488
	v_mfma_f32_16x16x32_bf16 v[104:107], a[200:203], v[192:195], v[104:107]
	ds_read_b64_tr_b16 a[248:249], v26 offset:61440
	v_mfma_f32_16x16x32_bf16 v[120:123], a[200:203], v[200:203], v[120:123]
	ds_read_b64_tr_b16 a[250:251], v26 offset:63488
	s_waitcnt lgkmcnt(13)
	v_mfma_f32_16x16x32_bf16 v[108:111], a[204:207], v[192:195], v[108:111]
	s_waitcnt vmcnt(28)
	s_barrier
	ds_read_b64_tr_b16 a[252:253], v27 offset:61440
	v_mfma_f32_16x16x32_bf16 v[124:127], a[204:207], v[200:203], v[124:127]
	ds_read_b64_tr_b16 a[254:255], v27 offset:63488
	v_mfma_f32_16x16x32_bf16 v[96:99], a[208:211], v[208:211], v[96:99]
	ds_read_b64_tr_b16 a[192:193], v28 offset:32768
	v_mfma_f32_16x16x32_bf16 v[112:115], a[208:211], v[216:219], v[112:115]
	ds_read_b64_tr_b16 a[194:195], v28 offset:34816
	v_mfma_f32_16x16x32_bf16 v[100:103], a[212:215], v[208:211], v[100:103]
	ds_read_b64_tr_b16 a[196:197], v29 offset:32768
	v_mfma_f32_16x16x32_bf16 v[116:119], a[212:215], v[216:219], v[116:119]
	ds_read_b64_tr_b16 a[198:199], v29 offset:34816
	v_mfma_f32_16x16x32_bf16 v[104:107], a[216:219], v[208:211], v[104:107]
	ds_read_b64_tr_b16 a[200:201], v30 offset:32768
	v_mfma_f32_16x16x32_bf16 v[120:123], a[216:219], v[216:219], v[120:123]
	ds_read_b64_tr_b16 a[202:203], v30 offset:34816
	v_mfma_f32_16x16x32_bf16 v[108:111], a[220:223], v[208:211], v[108:111]
	ds_read_b64_tr_b16 a[204:205], v31 offset:32768
	v_mfma_f32_16x16x32_bf16 v[124:127], a[220:223], v[216:219], v[124:127]
	ds_read_b64_tr_b16 a[206:207], v31 offset:34816
	s_waitcnt lgkmcnt(13)
	v_mfma_f32_16x16x32_bf16 v[96:99], a[224:227], v[224:227], v[96:99]
	ds_read_b64_tr_b16 a[208:209], v28 offset:36864
	v_mfma_f32_16x16x32_bf16 v[112:115], a[224:227], v[232:235], v[112:115]
	ds_read_b64_tr_b16 a[210:211], v28 offset:38912
	v_mfma_f32_16x16x32_bf16 v[100:103], a[228:231], v[224:227], v[100:103]
	ds_read_b64_tr_b16 a[212:213], v29 offset:36864
	v_mfma_f32_16x16x32_bf16 v[116:119], a[228:231], v[232:235], v[116:119]
	ds_read_b64_tr_b16 a[214:215], v29 offset:38912
	v_mfma_f32_16x16x32_bf16 v[104:107], a[232:235], v[224:227], v[104:107]
	ds_read_b64_tr_b16 a[216:217], v30 offset:36864
	v_mfma_f32_16x16x32_bf16 v[120:123], a[232:235], v[232:235], v[120:123]
	ds_read_b64_tr_b16 a[218:219], v30 offset:38912
	v_mfma_f32_16x16x32_bf16 v[108:111], a[236:239], v[224:227], v[108:111]
	ds_read_b64_tr_b16 a[220:221], v31 offset:36864
	v_mfma_f32_16x16x32_bf16 v[124:127], a[236:239], v[232:235], v[124:127]
	ds_read_b64_tr_b16 a[222:223], v31 offset:38912
	v_mfma_f32_16x16x32_bf16 v[96:99], a[240:243], v[240:243], v[96:99]
	ds_read_b64_tr_b16 a[224:225], v28 offset:40960
	v_mfma_f32_16x16x32_bf16 v[112:115], a[240:243], v[248:251], v[112:115]
	ds_read_b64_tr_b16 a[226:227], v28 offset:43008
	s_waitcnt lgkmcnt(13)
	v_mfma_f32_16x16x32_bf16 v[100:103], a[244:247], v[240:243], v[100:103]
	ds_read_b64_tr_b16 a[228:229], v29 offset:40960
	v_mfma_f32_16x16x32_bf16 v[116:119], a[244:247], v[248:251], v[116:119]
	ds_read_b64_tr_b16 a[230:231], v29 offset:43008
	v_mfma_f32_16x16x32_bf16 v[104:107], a[248:251], v[240:243], v[104:107]
	ds_read_b64_tr_b16 a[232:233], v30 offset:40960
	v_mfma_f32_16x16x32_bf16 v[120:123], a[248:251], v[248:251], v[120:123]
	ds_read_b64_tr_b16 a[234:235], v30 offset:43008
	v_mfma_f32_16x16x32_bf16 v[108:111], a[252:255], v[240:243], v[108:111]
	ds_read_b64_tr_b16 a[236:237], v31 offset:40960
	v_mfma_f32_16x16x32_bf16 v[124:127], a[252:255], v[248:251], v[124:127]
	ds_read_b64_tr_b16 a[238:239], v31 offset:43008
	v_mfma_f32_16x16x32_bf16 v[48:51], a[192:195], v[128:131], 0
	ds_read_b64_tr_b16 a[240:241], v28 offset:45056
	v_mfma_f32_16x16x32_bf16 v[64:67], a[192:195], v[136:139], 0
	ds_read_b64_tr_b16 a[242:243], v28 offset:47104
	v_mfma_f32_16x16x32_bf16 v[52:55], a[196:199], v[128:131], 0
	ds_read_b64_tr_b16 a[244:245], v29 offset:45056
	v_cvt_pk_bf16_f32 v96, v96, v97
	v_mfma_f32_16x16x32_bf16 v[68:71], a[196:199], v[136:139], 0
	ds_read_b64_tr_b16 a[246:247], v29 offset:47104
	v_cvt_pk_bf16_f32 v97, v98, v99
	s_waitcnt lgkmcnt(13)
	v_mfma_f32_16x16x32_bf16 v[56:59], a[200:203], v[128:131], 0
	ds_read_b64_tr_b16 a[248:249], v30 offset:45056
	v_cvt_pk_bf16_f32 v98, v100, v101
	v_mfma_f32_16x16x32_bf16 v[72:75], a[200:203], v[136:139], 0
	ds_read_b64_tr_b16 a[250:251], v30 offset:47104
	v_cvt_pk_bf16_f32 v99, v102, v103
	s_mov_b32 s53, 0xc000
	v_mfma_f32_16x16x32_bf16 v[60:63], a[204:207], v[128:131], 0
	ds_read_b64_tr_b16 a[252:253], v31 offset:45056
	buffer_store_dwordx4 v[96:99], v88, s[40:43], s53 offen offset:0 sc1
	v_mfma_f32_16x16x32_bf16 v[76:79], a[204:207], v[136:139], 0
	ds_read_b64_tr_b16 a[254:255], v31 offset:47104
	v_cvt_pk_bf16_f32 v104, v104, v105
	v_mfma_f32_16x16x32_bf16 v[48:51], a[208:211], v[144:147], v[48:51]
	ds_read_b64_tr_b16 a[192:193], v28 offset:49152
	v_cvt_pk_bf16_f32 v105, v106, v107
	v_mfma_f32_16x16x32_bf16 v[64:67], a[208:211], v[152:155], v[64:67]
	ds_read_b64_tr_b16 a[194:195], v28 offset:51200
	v_cvt_pk_bf16_f32 v106, v108, v109
	v_mfma_f32_16x16x32_bf16 v[52:55], a[212:215], v[144:147], v[52:55]
	ds_read_b64_tr_b16 a[196:197], v29 offset:49152
	v_cvt_pk_bf16_f32 v107, v110, v111
	s_mov_b32 s53, 0x28000
	v_mfma_f32_16x16x32_bf16 v[68:71], a[212:215], v[152:155], v[68:71]
	ds_read_b64_tr_b16 a[198:199], v29 offset:51200
	buffer_store_dwordx4 v[104:107], v88, s[40:43], s53 offen offset:0 sc1
	v_mfma_f32_16x16x32_bf16 v[56:59], a[216:219], v[144:147], v[56:59]
	ds_read_b64_tr_b16 a[200:201], v30 offset:49152
	v_cvt_pk_bf16_f32 v112, v112, v113
	v_mfma_f32_16x16x32_bf16 v[72:75], a[216:219], v[152:155], v[72:75]
	ds_read_b64_tr_b16 a[202:203], v30 offset:51200
	v_cvt_pk_bf16_f32 v113, v114, v115
	s_waitcnt lgkmcnt(12)
	v_mfma_f32_16x16x32_bf16 v[60:63], a[220:223], v[144:147], v[60:63]
	ds_read_b64_tr_b16 a[204:205], v31 offset:49152
	v_cvt_pk_bf16_f32 v114, v116, v117
	v_mfma_f32_16x16x32_bf16 v[76:79], a[220:223], v[152:155], v[76:79]
	ds_read_b64_tr_b16 a[206:207], v31 offset:51200
	v_cvt_pk_bf16_f32 v115, v118, v119
	s_mov_b32 s53, 0x44000
	v_mfma_f32_16x16x32_bf16 v[48:51], a[224:227], v[160:163], v[48:51]
	ds_read_b64_tr_b16 a[208:209], v28 offset:53248
	buffer_store_dwordx4 v[112:115], v88, s[40:43], s53 offen offset:0 sc1
	v_mfma_f32_16x16x32_bf16 v[64:67], a[224:227], v[168:171], v[64:67]
	ds_read_b64_tr_b16 a[210:211], v28 offset:55296
	v_cvt_pk_bf16_f32 v120, v120, v121
	v_mfma_f32_16x16x32_bf16 v[52:55], a[228:231], v[160:163], v[52:55]
	ds_read_b64_tr_b16 a[212:213], v29 offset:53248
	v_cvt_pk_bf16_f32 v121, v122, v123
	v_mfma_f32_16x16x32_bf16 v[68:71], a[228:231], v[168:171], v[68:71]
	ds_read_b64_tr_b16 a[214:215], v29 offset:55296
	v_cvt_pk_bf16_f32 v122, v124, v125
	v_mfma_f32_16x16x32_bf16 v[56:59], a[232:235], v[160:163], v[56:59]
	ds_read_b64_tr_b16 a[216:217], v30 offset:53248
	v_cvt_pk_bf16_f32 v123, v126, v127
	s_mov_b32 s53, 0x60000
	v_mfma_f32_16x16x32_bf16 v[72:75], a[232:235], v[168:171], v[72:75]
	ds_read_b64_tr_b16 a[218:219], v30 offset:55296
	buffer_store_dwordx4 v[120:123], v88, s[40:43], s53 offen offset:0 sc1
	v_mfma_f32_16x16x32_bf16 v[60:63], a[236:239], v[160:163], v[60:63]
	ds_read_b64_tr_b16 a[220:221], v31 offset:53248
	v_mfma_f32_16x16x32_bf16 v[76:79], a[236:239], v[168:171], v[76:79]
	ds_read_b64_tr_b16 a[222:223], v31 offset:55296
	v_mfma_f32_16x16x32_bf16 v[48:51], a[240:243], v[176:179], v[48:51]
	ds_read_b64_tr_b16 a[224:225], v28 offset:57344
	v_mfma_f32_16x16x32_bf16 v[64:67], a[240:243], v[184:187], v[64:67]
	ds_read_b64_tr_b16 a[226:227], v28 offset:59392
	s_waitcnt lgkmcnt(12)
	v_mfma_f32_16x16x32_bf16 v[52:55], a[244:247], v[176:179], v[52:55]
	ds_read_b64_tr_b16 a[228:229], v29 offset:57344
	v_mfma_f32_16x16x32_bf16 v[68:71], a[244:247], v[184:187], v[68:71]
	ds_read_b64_tr_b16 a[230:231], v29 offset:59392
	v_mfma_f32_16x16x32_bf16 v[56:59], a[248:251], v[176:179], v[56:59]
	ds_read_b64_tr_b16 a[232:233], v30 offset:57344
	v_mfma_f32_16x16x32_bf16 v[72:75], a[248:251], v[184:187], v[72:75]
	ds_read_b64_tr_b16 a[234:235], v30 offset:59392
	v_mfma_f32_16x16x32_bf16 v[60:63], a[252:255], v[176:179], v[60:63]
	ds_read_b64_tr_b16 a[236:237], v31 offset:57344
	v_mfma_f32_16x16x32_bf16 v[76:79], a[252:255], v[184:187], v[76:79]
	ds_read_b64_tr_b16 a[238:239], v31 offset:59392
	v_mfma_f32_16x16x32_bf16 v[48:51], a[192:195], v[192:195], v[48:51]
	ds_read_b64_tr_b16 a[240:241], v28 offset:61440
	v_mfma_f32_16x16x32_bf16 v[64:67], a[192:195], v[200:203], v[64:67]
	ds_read_b64_tr_b16 a[242:243], v28 offset:63488
	v_mfma_f32_16x16x32_bf16 v[52:55], a[196:199], v[192:195], v[52:55]
	ds_read_b64_tr_b16 a[244:245], v29 offset:61440
	v_mfma_f32_16x16x32_bf16 v[68:71], a[196:199], v[200:203], v[68:71]
	ds_read_b64_tr_b16 a[246:247], v29 offset:63488
	v_mfma_f32_16x16x32_bf16 v[56:59], a[200:203], v[192:195], v[56:59]
	ds_read_b64_tr_b16 a[248:249], v30 offset:61440
	v_mfma_f32_16x16x32_bf16 v[72:75], a[200:203], v[200:203], v[72:75]
	ds_read_b64_tr_b16 a[250:251], v30 offset:63488
	s_waitcnt lgkmcnt(13)
	v_mfma_f32_16x16x32_bf16 v[60:63], a[204:207], v[192:195], v[60:63]
	s_waitcnt vmcnt(20)
	s_barrier
	ds_read_b64_tr_b16 a[252:253], v31 offset:61440
	v_mfma_f32_16x16x32_bf16 v[76:79], a[204:207], v[200:203], v[76:79]
	ds_read_b64_tr_b16 a[254:255], v31 offset:63488
	v_mfma_f32_16x16x32_bf16 v[48:51], a[208:211], v[208:211], v[48:51]
	ds_read_b64_tr_b16 a[192:193], v32 offset:0
	v_mfma_f32_16x16x32_bf16 v[64:67], a[208:211], v[216:219], v[64:67]
	ds_read_b64_tr_b16 a[194:195], v32 offset:2048
	v_mfma_f32_16x16x32_bf16 v[52:55], a[212:215], v[208:211], v[52:55]
	ds_read_b64_tr_b16 a[196:197], v33 offset:0
	v_mfma_f32_16x16x32_bf16 v[68:71], a[212:215], v[216:219], v[68:71]
	ds_read_b64_tr_b16 a[198:199], v33 offset:2048
	v_mfma_f32_16x16x32_bf16 v[56:59], a[216:219], v[208:211], v[56:59]
	ds_read_b64_tr_b16 a[200:201], v34 offset:0
	v_mfma_f32_16x16x32_bf16 v[72:75], a[216:219], v[216:219], v[72:75]
	ds_read_b64_tr_b16 a[202:203], v34 offset:2048
	v_mfma_f32_16x16x32_bf16 v[60:63], a[220:223], v[208:211], v[60:63]
	ds_read_b64_tr_b16 a[204:205], v35 offset:0
	v_mfma_f32_16x16x32_bf16 v[76:79], a[220:223], v[216:219], v[76:79]
	ds_read_b64_tr_b16 a[206:207], v35 offset:2048
	s_waitcnt lgkmcnt(13)
	v_mfma_f32_16x16x32_bf16 v[48:51], a[224:227], v[224:227], v[48:51]
	ds_read_b64_tr_b16 a[208:209], v32 offset:4096
	v_mfma_f32_16x16x32_bf16 v[64:67], a[224:227], v[232:235], v[64:67]
	ds_read_b64_tr_b16 a[210:211], v32 offset:6144
	v_mfma_f32_16x16x32_bf16 v[52:55], a[228:231], v[224:227], v[52:55]
	ds_read_b64_tr_b16 a[212:213], v33 offset:4096
	v_mfma_f32_16x16x32_bf16 v[68:71], a[228:231], v[232:235], v[68:71]
	ds_read_b64_tr_b16 a[214:215], v33 offset:6144
	v_mfma_f32_16x16x32_bf16 v[56:59], a[232:235], v[224:227], v[56:59]
	ds_read_b64_tr_b16 a[216:217], v34 offset:4096
	v_mfma_f32_16x16x32_bf16 v[72:75], a[232:235], v[232:235], v[72:75]
	ds_read_b64_tr_b16 a[218:219], v34 offset:6144
	v_mfma_f32_16x16x32_bf16 v[60:63], a[236:239], v[224:227], v[60:63]
	ds_read_b64_tr_b16 a[220:221], v35 offset:4096
	v_mfma_f32_16x16x32_bf16 v[76:79], a[236:239], v[232:235], v[76:79]
	ds_read_b64_tr_b16 a[222:223], v35 offset:6144
	v_mfma_f32_16x16x32_bf16 v[48:51], a[240:243], v[240:243], v[48:51]
	ds_read_b64_tr_b16 a[224:225], v32 offset:8192
	v_mfma_f32_16x16x32_bf16 v[64:67], a[240:243], v[248:251], v[64:67]
	ds_read_b64_tr_b16 a[226:227], v32 offset:10240
	s_waitcnt lgkmcnt(13)
	v_mfma_f32_16x16x32_bf16 v[52:55], a[244:247], v[240:243], v[52:55]
	ds_read_b64_tr_b16 a[228:229], v33 offset:8192
	v_mfma_f32_16x16x32_bf16 v[68:71], a[244:247], v[248:251], v[68:71]
	ds_read_b64_tr_b16 a[230:231], v33 offset:10240
	v_mfma_f32_16x16x32_bf16 v[56:59], a[248:251], v[240:243], v[56:59]
	ds_read_b64_tr_b16 a[232:233], v34 offset:8192
	v_mfma_f32_16x16x32_bf16 v[72:75], a[248:251], v[248:251], v[72:75]
	ds_read_b64_tr_b16 a[234:235], v34 offset:10240
	v_mfma_f32_16x16x32_bf16 v[60:63], a[252:255], v[240:243], v[60:63]
	ds_read_b64_tr_b16 a[236:237], v35 offset:8192
	v_mfma_f32_16x16x32_bf16 v[76:79], a[252:255], v[248:251], v[76:79]
	ds_read_b64_tr_b16 a[238:239], v35 offset:10240
	v_mfma_f32_16x16x32_bf16 v[96:99], a[192:195], v[128:131], 0
	ds_read_b64_tr_b16 a[240:241], v32 offset:12288
	v_mfma_f32_16x16x32_bf16 v[112:115], a[192:195], v[136:139], 0
	ds_read_b64_tr_b16 a[242:243], v32 offset:14336
	v_mfma_f32_16x16x32_bf16 v[100:103], a[196:199], v[128:131], 0
	ds_read_b64_tr_b16 a[244:245], v33 offset:12288
	v_cvt_pk_bf16_f32 v48, v48, v49
	v_mfma_f32_16x16x32_bf16 v[116:119], a[196:199], v[136:139], 0
	ds_read_b64_tr_b16 a[246:247], v33 offset:14336
	v_cvt_pk_bf16_f32 v49, v50, v51
	s_waitcnt lgkmcnt(13)
	v_mfma_f32_16x16x32_bf16 v[104:107], a[200:203], v[128:131], 0
	ds_read_b64_tr_b16 a[248:249], v34 offset:12288
	v_cvt_pk_bf16_f32 v50, v52, v53
	v_mfma_f32_16x16x32_bf16 v[120:123], a[200:203], v[136:139], 0
	ds_read_b64_tr_b16 a[250:251], v34 offset:14336
	v_cvt_pk_bf16_f32 v51, v54, v55
	s_mov_b32 s53, 0x10000
	v_mfma_f32_16x16x32_bf16 v[108:111], a[204:207], v[128:131], 0
	ds_read_b64_tr_b16 a[252:253], v35 offset:12288
	buffer_store_dwordx4 v[48:51], v88, s[40:43], s53 offen offset:0 sc1
	v_mfma_f32_16x16x32_bf16 v[124:127], a[204:207], v[136:139], 0
	ds_read_b64_tr_b16 a[254:255], v35 offset:14336
	v_cvt_pk_bf16_f32 v56, v56, v57
	v_mfma_f32_16x16x32_bf16 v[96:99], a[208:211], v[144:147], v[96:99]
	ds_read_b64_tr_b16 a[192:193], v32 offset:16384
	v_cvt_pk_bf16_f32 v57, v58, v59
	v_mfma_f32_16x16x32_bf16 v[112:115], a[208:211], v[152:155], v[112:115]
	ds_read_b64_tr_b16 a[194:195], v32 offset:18432
	v_cvt_pk_bf16_f32 v58, v60, v61
	v_mfma_f32_16x16x32_bf16 v[100:103], a[212:215], v[144:147], v[100:103]
	ds_read_b64_tr_b16 a[196:197], v33 offset:16384
	v_cvt_pk_bf16_f32 v59, v62, v63
	s_mov_b32 s53, 0x2c000
	v_mfma_f32_16x16x32_bf16 v[116:119], a[212:215], v[152:155], v[116:119]
	ds_read_b64_tr_b16 a[198:199], v33 offset:18432
	buffer_store_dwordx4 v[56:59], v88, s[40:43], s53 offen offset:0 sc1
	v_mfma_f32_16x16x32_bf16 v[104:107], a[216:219], v[144:147], v[104:107]
	ds_read_b64_tr_b16 a[200:201], v34 offset:16384
	v_cvt_pk_bf16_f32 v64, v64, v65
	v_mfma_f32_16x16x32_bf16 v[120:123], a[216:219], v[152:155], v[120:123]
	ds_read_b64_tr_b16 a[202:203], v34 offset:18432
	v_cvt_pk_bf16_f32 v65, v66, v67
	s_waitcnt lgkmcnt(12)
	v_mfma_f32_16x16x32_bf16 v[108:111], a[220:223], v[144:147], v[108:111]
	ds_read_b64_tr_b16 a[204:205], v35 offset:16384
	v_cvt_pk_bf16_f32 v66, v68, v69
	v_mfma_f32_16x16x32_bf16 v[124:127], a[220:223], v[152:155], v[124:127]
	ds_read_b64_tr_b16 a[206:207], v35 offset:18432
	v_cvt_pk_bf16_f32 v67, v70, v71
	s_mov_b32 s53, 0x48000
	v_mfma_f32_16x16x32_bf16 v[96:99], a[224:227], v[160:163], v[96:99]
	ds_read_b64_tr_b16 a[208:209], v32 offset:20480
	buffer_store_dwordx4 v[64:67], v88, s[40:43], s53 offen offset:0 sc1
	v_mfma_f32_16x16x32_bf16 v[112:115], a[224:227], v[168:171], v[112:115]
	ds_read_b64_tr_b16 a[210:211], v32 offset:22528
	v_cvt_pk_bf16_f32 v72, v72, v73
	v_mfma_f32_16x16x32_bf16 v[100:103], a[228:231], v[160:163], v[100:103]
	ds_read_b64_tr_b16 a[212:213], v33 offset:20480
	v_cvt_pk_bf16_f32 v73, v74, v75
	v_mfma_f32_16x16x32_bf16 v[116:119], a[228:231], v[168:171], v[116:119]
	ds_read_b64_tr_b16 a[214:215], v33 offset:22528
	v_cvt_pk_bf16_f32 v74, v76, v77
	v_mfma_f32_16x16x32_bf16 v[104:107], a[232:235], v[160:163], v[104:107]
	ds_read_b64_tr_b16 a[216:217], v34 offset:20480
	v_cvt_pk_bf16_f32 v75, v78, v79
	s_mov_b32 s53, 0x64000
	v_mfma_f32_16x16x32_bf16 v[120:123], a[232:235], v[168:171], v[120:123]
	ds_read_b64_tr_b16 a[218:219], v34 offset:22528
	buffer_store_dwordx4 v[72:75], v88, s[40:43], s53 offen offset:0 sc1
	v_mfma_f32_16x16x32_bf16 v[108:111], a[236:239], v[160:163], v[108:111]
	ds_read_b64_tr_b16 a[220:221], v35 offset:20480
	v_mfma_f32_16x16x32_bf16 v[124:127], a[236:239], v[168:171], v[124:127]
	ds_read_b64_tr_b16 a[222:223], v35 offset:22528
	v_mfma_f32_16x16x32_bf16 v[96:99], a[240:243], v[176:179], v[96:99]
	ds_read_b64_tr_b16 a[224:225], v32 offset:24576
	v_mfma_f32_16x16x32_bf16 v[112:115], a[240:243], v[184:187], v[112:115]
	ds_read_b64_tr_b16 a[226:227], v32 offset:26624
	s_waitcnt lgkmcnt(12)
	v_mfma_f32_16x16x32_bf16 v[100:103], a[244:247], v[176:179], v[100:103]
	ds_read_b64_tr_b16 a[228:229], v33 offset:24576
	v_mfma_f32_16x16x32_bf16 v[116:119], a[244:247], v[184:187], v[116:119]
	ds_read_b64_tr_b16 a[230:231], v33 offset:26624
	v_mfma_f32_16x16x32_bf16 v[104:107], a[248:251], v[176:179], v[104:107]
	ds_read_b64_tr_b16 a[232:233], v34 offset:24576
	v_mfma_f32_16x16x32_bf16 v[120:123], a[248:251], v[184:187], v[120:123]
	ds_read_b64_tr_b16 a[234:235], v34 offset:26624
	v_mfma_f32_16x16x32_bf16 v[108:111], a[252:255], v[176:179], v[108:111]
	ds_read_b64_tr_b16 a[236:237], v35 offset:24576
	v_mfma_f32_16x16x32_bf16 v[124:127], a[252:255], v[184:187], v[124:127]
	ds_read_b64_tr_b16 a[238:239], v35 offset:26624
	v_mfma_f32_16x16x32_bf16 v[96:99], a[192:195], v[192:195], v[96:99]
	ds_read_b64_tr_b16 a[240:241], v32 offset:28672
	v_mfma_f32_16x16x32_bf16 v[112:115], a[192:195], v[200:203], v[112:115]
	ds_read_b64_tr_b16 a[242:243], v32 offset:30720
	v_mfma_f32_16x16x32_bf16 v[100:103], a[196:199], v[192:195], v[100:103]
	ds_read_b64_tr_b16 a[244:245], v33 offset:28672
	v_mfma_f32_16x16x32_bf16 v[116:119], a[196:199], v[200:203], v[116:119]
	ds_read_b64_tr_b16 a[246:247], v33 offset:30720
	v_mfma_f32_16x16x32_bf16 v[104:107], a[200:203], v[192:195], v[104:107]
	ds_read_b64_tr_b16 a[248:249], v34 offset:28672
	v_mfma_f32_16x16x32_bf16 v[120:123], a[200:203], v[200:203], v[120:123]
	ds_read_b64_tr_b16 a[250:251], v34 offset:30720
	s_waitcnt lgkmcnt(13)
	v_mfma_f32_16x16x32_bf16 v[108:111], a[204:207], v[192:195], v[108:111]
	s_waitcnt vmcnt(4)
	s_barrier
	ds_read_b64_tr_b16 a[252:253], v35 offset:28672
	buffer_atomic_add v92, v90, s[4:7], 0 offen offset:0 sc1
	v_mfma_f32_16x16x32_bf16 v[124:127], a[204:207], v[200:203], v[124:127]
	ds_read_b64_tr_b16 a[254:255], v35 offset:30720
	v_mfma_f32_16x16x32_bf16 v[96:99], a[208:211], v[208:211], v[96:99]
	ds_read_b64_tr_b16 a[192:193], v24 offset:0
	v_mfma_f32_16x16x32_bf16 v[112:115], a[208:211], v[216:219], v[112:115]
	ds_read_b64_tr_b16 a[194:195], v24 offset:2048
	v_mfma_f32_16x16x32_bf16 v[100:103], a[212:215], v[208:211], v[100:103]
	ds_read_b64_tr_b16 a[196:197], v25 offset:0
	v_mfma_f32_16x16x32_bf16 v[116:119], a[212:215], v[216:219], v[116:119]
	ds_read_b64_tr_b16 a[198:199], v25 offset:2048
	v_mfma_f32_16x16x32_bf16 v[104:107], a[216:219], v[208:211], v[104:107]
	ds_read_b64_tr_b16 a[200:201], v26 offset:0
	v_mfma_f32_16x16x32_bf16 v[120:123], a[216:219], v[216:219], v[120:123]
	ds_read_b64_tr_b16 a[202:203], v26 offset:2048
	v_mfma_f32_16x16x32_bf16 v[108:111], a[220:223], v[208:211], v[108:111]
	ds_read_b64_tr_b16 a[204:205], v27 offset:0
	v_mfma_f32_16x16x32_bf16 v[124:127], a[220:223], v[216:219], v[124:127]
	ds_read_b64_tr_b16 a[206:207], v27 offset:2048
	s_waitcnt lgkmcnt(13)
	v_mfma_f32_16x16x32_bf16 v[96:99], a[224:227], v[224:227], v[96:99]
	ds_read_b64_tr_b16 a[208:209], v24 offset:4096
	v_mfma_f32_16x16x32_bf16 v[112:115], a[224:227], v[232:235], v[112:115]
	ds_read_b64_tr_b16 a[210:211], v24 offset:6144
	v_mfma_f32_16x16x32_bf16 v[100:103], a[228:231], v[224:227], v[100:103]
	ds_read_b64_tr_b16 a[212:213], v25 offset:4096
	v_mfma_f32_16x16x32_bf16 v[116:119], a[228:231], v[232:235], v[116:119]
	ds_read_b64_tr_b16 a[214:215], v25 offset:6144
	v_mfma_f32_16x16x32_bf16 v[104:107], a[232:235], v[224:227], v[104:107]
	ds_read_b64_tr_b16 a[216:217], v26 offset:4096
	v_mfma_f32_16x16x32_bf16 v[120:123], a[232:235], v[232:235], v[120:123]
	ds_read_b64_tr_b16 a[218:219], v26 offset:6144
	v_mfma_f32_16x16x32_bf16 v[108:111], a[236:239], v[224:227], v[108:111]
	ds_read_b64_tr_b16 a[220:221], v27 offset:4096
	v_mfma_f32_16x16x32_bf16 v[124:127], a[236:239], v[232:235], v[124:127]
	ds_read_b64_tr_b16 a[222:223], v27 offset:6144
	v_mfma_f32_16x16x32_bf16 v[96:99], a[240:243], v[240:243], v[96:99]
	ds_read_b64_tr_b16 a[224:225], v24 offset:8192
	v_mfma_f32_16x16x32_bf16 v[112:115], a[240:243], v[248:251], v[112:115]
	ds_read_b64_tr_b16 a[226:227], v24 offset:10240
	s_waitcnt lgkmcnt(13)
	v_mfma_f32_16x16x32_bf16 v[100:103], a[244:247], v[240:243], v[100:103]
	ds_read_b64_tr_b16 a[228:229], v25 offset:8192
	v_mfma_f32_16x16x32_bf16 v[116:119], a[244:247], v[248:251], v[116:119]
	ds_read_b64_tr_b16 a[230:231], v25 offset:10240
	v_mfma_f32_16x16x32_bf16 v[104:107], a[248:251], v[240:243], v[104:107]
	ds_read_b64_tr_b16 a[232:233], v26 offset:8192
	v_mfma_f32_16x16x32_bf16 v[120:123], a[248:251], v[248:251], v[120:123]
	ds_read_b64_tr_b16 a[234:235], v26 offset:10240
	v_mfma_f32_16x16x32_bf16 v[108:111], a[252:255], v[240:243], v[108:111]
	ds_read_b64_tr_b16 a[236:237], v27 offset:8192
	v_mfma_f32_16x16x32_bf16 v[124:127], a[252:255], v[248:251], v[124:127]
	ds_read_b64_tr_b16 a[238:239], v27 offset:10240
	v_mfma_f32_16x16x32_bf16 v[48:51], a[192:195], v[128:131], 0
	ds_read_b64_tr_b16 a[240:241], v24 offset:12288
	v_mfma_f32_16x16x32_bf16 v[64:67], a[192:195], v[136:139], 0
	ds_read_b64_tr_b16 a[242:243], v24 offset:14336
	v_mfma_f32_16x16x32_bf16 v[52:55], a[196:199], v[128:131], 0
	ds_read_b64_tr_b16 a[244:245], v25 offset:12288
	v_cvt_pk_bf16_f32 v96, v96, v97
	v_mfma_f32_16x16x32_bf16 v[68:71], a[196:199], v[136:139], 0
	ds_read_b64_tr_b16 a[246:247], v25 offset:14336
	v_cvt_pk_bf16_f32 v97, v98, v99
	s_waitcnt lgkmcnt(13)
	v_mfma_f32_16x16x32_bf16 v[56:59], a[200:203], v[128:131], 0
	ds_read_b64_tr_b16 a[248:249], v26 offset:12288
	v_cvt_pk_bf16_f32 v98, v100, v101
	v_mfma_f32_16x16x32_bf16 v[72:75], a[200:203], v[136:139], 0
	ds_read_b64_tr_b16 a[250:251], v26 offset:14336
	v_cvt_pk_bf16_f32 v99, v102, v103
	s_mov_b32 s53, 0x14000
	v_mfma_f32_16x16x32_bf16 v[60:63], a[204:207], v[128:131], 0
	ds_read_b64_tr_b16 a[252:253], v27 offset:12288
	buffer_store_dwordx4 v[96:99], v88, s[40:43], s53 offen offset:0 sc1
	v_mfma_f32_16x16x32_bf16 v[76:79], a[204:207], v[136:139], 0
	ds_read_b64_tr_b16 a[254:255], v27 offset:14336
	v_cvt_pk_bf16_f32 v104, v104, v105
	v_mfma_f32_16x16x32_bf16 v[48:51], a[208:211], v[144:147], v[48:51]
	ds_read_b64_tr_b16 a[192:193], v24 offset:16384
	v_cvt_pk_bf16_f32 v105, v106, v107
	v_mfma_f32_16x16x32_bf16 v[64:67], a[208:211], v[152:155], v[64:67]
	ds_read_b64_tr_b16 a[194:195], v24 offset:18432
	v_cvt_pk_bf16_f32 v106, v108, v109
	v_mfma_f32_16x16x32_bf16 v[52:55], a[212:215], v[144:147], v[52:55]
	ds_read_b64_tr_b16 a[196:197], v25 offset:16384
	v_cvt_pk_bf16_f32 v107, v110, v111
	s_mov_b32 s53, 0x30000
	v_mfma_f32_16x16x32_bf16 v[68:71], a[212:215], v[152:155], v[68:71]
	ds_read_b64_tr_b16 a[198:199], v25 offset:18432
	buffer_store_dwordx4 v[104:107], v88, s[40:43], s53 offen offset:0 sc1
	v_mfma_f32_16x16x32_bf16 v[56:59], a[216:219], v[144:147], v[56:59]
	ds_read_b64_tr_b16 a[200:201], v26 offset:16384
	v_cvt_pk_bf16_f32 v112, v112, v113
	v_mfma_f32_16x16x32_bf16 v[72:75], a[216:219], v[152:155], v[72:75]
	ds_read_b64_tr_b16 a[202:203], v26 offset:18432
	v_cvt_pk_bf16_f32 v113, v114, v115
	s_waitcnt lgkmcnt(12)
	v_mfma_f32_16x16x32_bf16 v[60:63], a[220:223], v[144:147], v[60:63]
	ds_read_b64_tr_b16 a[204:205], v27 offset:16384
	v_cvt_pk_bf16_f32 v114, v116, v117
	v_mfma_f32_16x16x32_bf16 v[76:79], a[220:223], v[152:155], v[76:79]
	ds_read_b64_tr_b16 a[206:207], v27 offset:18432
	v_cvt_pk_bf16_f32 v115, v118, v119
	s_mov_b32 s53, 0x4c000
	v_mfma_f32_16x16x32_bf16 v[48:51], a[224:227], v[160:163], v[48:51]
	ds_read_b64_tr_b16 a[208:209], v24 offset:20480
	buffer_store_dwordx4 v[112:115], v88, s[40:43], s53 offen offset:0 sc1
	v_mfma_f32_16x16x32_bf16 v[64:67], a[224:227], v[168:171], v[64:67]
	ds_read_b64_tr_b16 a[210:211], v24 offset:22528
	v_cvt_pk_bf16_f32 v120, v120, v121
	v_mfma_f32_16x16x32_bf16 v[52:55], a[228:231], v[160:163], v[52:55]
	ds_read_b64_tr_b16 a[212:213], v25 offset:20480
	v_cvt_pk_bf16_f32 v121, v122, v123
	v_mfma_f32_16x16x32_bf16 v[68:71], a[228:231], v[168:171], v[68:71]
	ds_read_b64_tr_b16 a[214:215], v25 offset:22528
	v_cvt_pk_bf16_f32 v122, v124, v125
	v_mfma_f32_16x16x32_bf16 v[56:59], a[232:235], v[160:163], v[56:59]
	ds_read_b64_tr_b16 a[216:217], v26 offset:20480
	v_cvt_pk_bf16_f32 v123, v126, v127
	s_mov_b32 s53, 0x68000
	v_mfma_f32_16x16x32_bf16 v[72:75], a[232:235], v[168:171], v[72:75]
	ds_read_b64_tr_b16 a[218:219], v26 offset:22528
	buffer_store_dwordx4 v[120:123], v88, s[40:43], s53 offen offset:0 sc1
	v_mfma_f32_16x16x32_bf16 v[60:63], a[236:239], v[160:163], v[60:63]
	ds_read_b64_tr_b16 a[220:221], v27 offset:20480
	v_mfma_f32_16x16x32_bf16 v[76:79], a[236:239], v[168:171], v[76:79]
	ds_read_b64_tr_b16 a[222:223], v27 offset:22528
	v_mfma_f32_16x16x32_bf16 v[48:51], a[240:243], v[176:179], v[48:51]
	ds_read_b64_tr_b16 a[224:225], v24 offset:24576
	v_mfma_f32_16x16x32_bf16 v[64:67], a[240:243], v[184:187], v[64:67]
	ds_read_b64_tr_b16 a[226:227], v24 offset:26624
	s_waitcnt lgkmcnt(12)
	v_mfma_f32_16x16x32_bf16 v[52:55], a[244:247], v[176:179], v[52:55]
	ds_read_b64_tr_b16 a[228:229], v25 offset:24576
	v_mfma_f32_16x16x32_bf16 v[68:71], a[244:247], v[184:187], v[68:71]
	ds_read_b64_tr_b16 a[230:231], v25 offset:26624
	v_mfma_f32_16x16x32_bf16 v[56:59], a[248:251], v[176:179], v[56:59]
	ds_read_b64_tr_b16 a[232:233], v26 offset:24576
	v_mfma_f32_16x16x32_bf16 v[72:75], a[248:251], v[184:187], v[72:75]
	ds_read_b64_tr_b16 a[234:235], v26 offset:26624
	v_mfma_f32_16x16x32_bf16 v[60:63], a[252:255], v[176:179], v[60:63]
	ds_read_b64_tr_b16 a[236:237], v27 offset:24576
	v_mfma_f32_16x16x32_bf16 v[76:79], a[252:255], v[184:187], v[76:79]
	ds_read_b64_tr_b16 a[238:239], v27 offset:26624
	v_mfma_f32_16x16x32_bf16 v[48:51], a[192:195], v[192:195], v[48:51]
	ds_read_b64_tr_b16 a[240:241], v24 offset:28672
	v_mfma_f32_16x16x32_bf16 v[64:67], a[192:195], v[200:203], v[64:67]
	ds_read_b64_tr_b16 a[242:243], v24 offset:30720
	v_mfma_f32_16x16x32_bf16 v[52:55], a[196:199], v[192:195], v[52:55]
	ds_read_b64_tr_b16 a[244:245], v25 offset:28672
	v_mfma_f32_16x16x32_bf16 v[68:71], a[196:199], v[200:203], v[68:71]
	ds_read_b64_tr_b16 a[246:247], v25 offset:30720
	v_mfma_f32_16x16x32_bf16 v[56:59], a[200:203], v[192:195], v[56:59]
	ds_read_b64_tr_b16 a[248:249], v26 offset:28672
	buffer_load_dword v91, v89, s[4:7], 0 offen offset:0 sc1
	v_mfma_f32_16x16x32_bf16 v[72:75], a[200:203], v[200:203], v[72:75]
	ds_read_b64_tr_b16 a[250:251], v26 offset:30720
	s_waitcnt lgkmcnt(13)
	v_mfma_f32_16x16x32_bf16 v[60:63], a[204:207], v[192:195], v[60:63]
	ds_read_b64_tr_b16 a[252:253], v27 offset:28672
	v_mfma_f32_16x16x32_bf16 v[76:79], a[204:207], v[200:203], v[76:79]
	ds_read_b64_tr_b16 a[254:255], v27 offset:30720
	v_mfma_f32_16x16x32_bf16 v[48:51], a[208:211], v[208:211], v[48:51]
	v_mfma_f32_16x16x32_bf16 v[64:67], a[208:211], v[216:219], v[64:67]
	v_mfma_f32_16x16x32_bf16 v[52:55], a[212:215], v[208:211], v[52:55]
	v_mfma_f32_16x16x32_bf16 v[68:71], a[212:215], v[216:219], v[68:71]
	v_mfma_f32_16x16x32_bf16 v[56:59], a[216:219], v[208:211], v[56:59]
	v_mfma_f32_16x16x32_bf16 v[72:75], a[216:219], v[216:219], v[72:75]
	v_mfma_f32_16x16x32_bf16 v[60:63], a[220:223], v[208:211], v[60:63]
	v_mfma_f32_16x16x32_bf16 v[76:79], a[220:223], v[216:219], v[76:79]
	s_waitcnt lgkmcnt(5)
	v_mfma_f32_16x16x32_bf16 v[48:51], a[224:227], v[224:227], v[48:51]
	v_mfma_f32_16x16x32_bf16 v[64:67], a[224:227], v[232:235], v[64:67]
	v_mfma_f32_16x16x32_bf16 v[52:55], a[228:231], v[224:227], v[52:55]
	v_mfma_f32_16x16x32_bf16 v[68:71], a[228:231], v[232:235], v[68:71]
	v_mfma_f32_16x16x32_bf16 v[56:59], a[232:235], v[224:227], v[56:59]
	v_mfma_f32_16x16x32_bf16 v[72:75], a[232:235], v[232:235], v[72:75]
	v_mfma_f32_16x16x32_bf16 v[60:63], a[236:239], v[224:227], v[60:63]
	v_mfma_f32_16x16x32_bf16 v[76:79], a[236:239], v[232:235], v[76:79]
	v_mfma_f32_16x16x32_bf16 v[48:51], a[240:243], v[240:243], v[48:51]
	v_mfma_f32_16x16x32_bf16 v[64:67], a[240:243], v[248:251], v[64:67]
	s_waitcnt lgkmcnt(0)
	v_mfma_f32_16x16x32_bf16 v[52:55], a[244:247], v[240:243], v[52:55]
	v_mfma_f32_16x16x32_bf16 v[68:71], a[244:247], v[248:251], v[68:71]
	v_mfma_f32_16x16x32_bf16 v[56:59], a[248:251], v[240:243], v[56:59]
	v_mfma_f32_16x16x32_bf16 v[72:75], a[248:251], v[248:251], v[72:75]
	v_mfma_f32_16x16x32_bf16 v[60:63], a[252:255], v[240:243], v[60:63]
	v_mfma_f32_16x16x32_bf16 v[76:79], a[252:255], v[248:251], v[76:79]
	v_cvt_pk_bf16_f32 v48, v48, v49
	v_cvt_pk_bf16_f32 v49, v50, v51
	s_nop 0
	v_cvt_pk_bf16_f32 v50, v52, v53
	v_cvt_pk_bf16_f32 v51, v54, v55
	s_mov_b32 s53, 0x18000
	buffer_store_dwordx4 v[48:51], v88, s[40:43], s53 offen offset:0 sc1
	v_cvt_pk_bf16_f32 v56, v56, v57
	v_cvt_pk_bf16_f32 v57, v58, v59
	v_cvt_pk_bf16_f32 v58, v60, v61
	v_cvt_pk_bf16_f32 v59, v62, v63
	s_mov_b32 s53, 0x34000
	buffer_store_dwordx4 v[56:59], v88, s[40:43], s53 offen offset:0 sc1
	v_cvt_pk_bf16_f32 v64, v64, v65
	v_cvt_pk_bf16_f32 v65, v66, v67
	v_cvt_pk_bf16_f32 v66, v68, v69
	v_cvt_pk_bf16_f32 v67, v70, v71
	s_mov_b32 s53, 0x50000
	buffer_store_dwordx4 v[64:67], v88, s[40:43], s53 offen offset:0 sc1
	v_cvt_pk_bf16_f32 v72, v72, v73
	v_cvt_pk_bf16_f32 v73, v74, v75
	v_cvt_pk_bf16_f32 v74, v76, v77
	v_cvt_pk_bf16_f32 v75, v78, v79
	s_mov_b32 s53, 0x6c000
	buffer_store_dwordx4 v[72:75], v88, s[40:43], s53 offen offset:0 sc1
	s_waitcnt vmcnt(0)
	s_barrier
	buffer_atomic_add v92, v90, s[4:7], 0 offen offset:256 sc1
	v_readfirstlane_b32 s98, v91
	s_nop 1
	s_cmp_ge_u32 s98, 16
	s_cbranch_scc0 L_tr_poll0
L_bk_poll0:
	s_mov_b32 s51, 0
	buffer_load_dwordx4 a[0:3], v40, s[20:23], s51 offen offset:0 sc1
	s_mov_b32 s51, 0x1000
	buffer_load_dwordx4 a[4:7], v40, s[20:23], s51 offen offset:0 sc1
	s_mov_b32 s51, 0x2000
	buffer_load_dwordx4 a[8:11], v40, s[20:23], s51 offen offset:0 sc1
	s_mov_b32 s51, 0x3000
	buffer_load_dwordx4 a[12:15], v40, s[20:23], s51 offen offset:0 sc1
	s_mov_b32 s51, 0x4000
	buffer_load_dwordx4 a[16:19], v40, s[20:23], s51 offen offset:0 sc1
	s_mov_b32 s51, 0x5000
	buffer_load_dwordx4 a[20:23], v40, s[20:23], s51 offen offset:0 sc1
	s_mov_b32 s51, 0x6000
	buffer_load_dwordx4 a[24:27], v40, s[20:23], s51 offen offset:0 sc1
	s_mov_b32 s51, 0x7000
	buffer_load_dwordx4 a[28:31], v40, s[20:23], s51 offen offset:0 sc1
	s_mov_b32 s51, 0x8000
	buffer_load_dwordx4 a[32:35], v40, s[20:23], s51 offen offset:0 sc1
	s_mov_b32 s51, 0x9000
	buffer_load_dwordx4 a[36:39], v40, s[20:23], s51 offen offset:0 sc1
	s_mov_b32 s51, 0xa000
	buffer_load_dwordx4 a[40:43], v40, s[20:23], s51 offen offset:0 sc1
	s_mov_b32 s51, 0xb000
	buffer_load_dwordx4 a[44:47], v40, s[20:23], s51 offen offset:0 sc1
	s_mov_b32 s51, 0xc000
	buffer_load_dwordx4 a[48:51], v40, s[20:23], s51 offen offset:0 sc1
	s_mov_b32 s51, 0xd000
	buffer_load_dwordx4 a[52:55], v40, s[20:23], s51 offen offset:0 sc1
	s_mov_b32 s51, 0xe000
	buffer_load_dwordx4 a[56:59], v40, s[20:23], s51 offen offset:0 sc1
	s_mov_b32 s51, 0xf000
	buffer_load_dwordx4 a[60:63], v40, s[20:23], s51 offen offset:0 sc1
	buffer_load_dword v91, v89, s[4:7], 0 offen offset:256 sc1
	s_waitcnt vmcnt(16)
	v_mfma_f32_16x16x32_bf16 v[12:15], v[80:83], a[0:3], 0
	s_waitcnt vmcnt(15)
	v_mfma_f32_16x16x32_bf16 v[12:15], v[80:83], a[4:7], v[12:15]
	s_waitcnt vmcnt(14)
	v_mfma_f32_16x16x32_bf16 v[12:15], v[80:83], a[8:11], v[12:15]
	s_waitcnt vmcnt(13)
	v_mfma_f32_16x16x32_bf16 v[12:15], v[80:83], a[12:15], v[12:15]
	s_waitcnt vmcnt(12)
	v_mfma_f32_16x16x32_bf16 v[12:15], v[84:87], a[16:19], v[12:15]
	s_waitcnt vmcnt(11)
	v_mfma_f32_16x16x32_bf16 v[12:15], v[84:87], a[20:23], v[12:15]
	s_waitcnt vmcnt(10)
	v_mfma_f32_16x16x32_bf16 v[12:15], v[84:87], a[24:27], v[12:15]
	s_waitcnt vmcnt(9)
	v_mfma_f32_16x16x32_bf16 v[12:15], v[84:87], a[28:31], v[12:15]
	s_nop 7
	v_cvt_pk_bf16_f32 v12, v12, v13
	v_cvt_pk_bf16_f32 v13, v14, v15
	buffer_store_dwordx2 v[12:13], v41, s[24:27], s50 offen offset:0
	s_waitcnt vmcnt(1)
	v_readfirstlane_b32 s98, v91
	s_nop 1
	s_cmp_ge_u32 s98, 16
	s_cbranch_scc0 L_tr_poll2
L_bk_poll2:
	s_mov_b32 s51, 0x10000
	buffer_load_dwordx4 a[64:67], v40, s[20:23], s51 offen offset:0 sc1
	s_mov_b32 s51, 0x11000
	buffer_load_dwordx4 a[68:71], v40, s[20:23], s51 offen offset:0 sc1
	s_mov_b32 s51, 0x12000
	buffer_load_dwordx4 a[72:75], v40, s[20:23], s51 offen offset:0 sc1
	s_mov_b32 s51, 0x13000
	buffer_load_dwordx4 a[76:79], v40, s[20:23], s51 offen offset:0 sc1
	s_mov_b32 s51, 0x14000
	buffer_load_dwordx4 a[80:83], v40, s[20:23], s51 offen offset:0 sc1
	s_mov_b32 s51, 0x15000
	buffer_load_dwordx4 a[84:87], v40, s[20:23], s51 offen offset:0 sc1
	s_mov_b32 s51, 0x16000
	buffer_load_dwordx4 a[88:91], v40, s[20:23], s51 offen offset:0 sc1
	s_mov_b32 s51, 0x17000
	buffer_load_dwordx4 a[92:95], v40, s[20:23], s51 offen offset:0 sc1
	s_mov_b32 s51, 0x18000
	buffer_load_dwordx4 a[96:99], v40, s[20:23], s51 offen offset:0 sc1
	s_mov_b32 s51, 0x19000
	buffer_load_dwordx4 a[100:103], v40, s[20:23], s51 offen offset:0 sc1
	s_mov_b32 s51, 0x1a000
	buffer_load_dwordx4 a[104:107], v40, s[20:23], s51 offen offset:0 sc1
	s_mov_b32 s51, 0x1b000
	buffer_load_dwordx4 a[108:111], v40, s[20:23], s51 offen offset:0 sc1
	v_mfma_f32_16x16x32_bf16 v[16:19], v[80:83], a[32:35], 0
	v_mfma_f32_16x16x32_bf16 v[16:19], v[80:83], a[36:39], v[16:19]
	v_mfma_f32_16x16x32_bf16 v[16:19], v[80:83], a[40:43], v[16:19]
	v_mfma_f32_16x16x32_bf16 v[16:19], v[80:83], a[44:47], v[16:19]
	v_mfma_f32_16x16x32_bf16 v[16:19], v[84:87], a[48:51], v[16:19]
	v_mfma_f32_16x16x32_bf16 v[16:19], v[84:87], a[52:55], v[16:19]
	v_mfma_f32_16x16x32_bf16 v[16:19], v[84:87], a[56:59], v[16:19]
	v_mfma_f32_16x16x32_bf16 v[16:19], v[84:87], a[60:63], v[16:19]
	s_waitcnt vmcnt(11)
	v_mfma_f32_16x16x32_bf16 v[20:23], v[80:83], a[64:67], 0
	s_waitcnt vmcnt(10)
	v_mfma_f32_16x16x32_bf16 v[20:23], v[80:83], a[68:71], v[20:23]
	s_waitcnt vmcnt(9)
	v_mfma_f32_16x16x32_bf16 v[20:23], v[80:83], a[72:75], v[20:23]
	s_waitcnt vmcnt(8)
	v_mfma_f32_16x16x32_bf16 v[20:23], v[80:83], a[76:79], v[20:23]
	s_waitcnt vmcnt(7)
	v_mfma_f32_16x16x32_bf16 v[20:23], v[84:87], a[80:83], v[20:23]
	s_waitcnt vmcnt(6)
	v_mfma_f32_16x16x32_bf16 v[20:23], v[84:87], a[84:87], v[20:23]
	s_waitcnt vmcnt(5)
	v_mfma_f32_16x16x32_bf16 v[20:23], v[84:87], a[88:91], v[20:23]
	s_waitcnt vmcnt(4)
	v_mfma_f32_16x16x32_bf16 v[20:23], v[84:87], a[92:95], v[20:23]
	s_waitcnt vmcnt(3)
	v_mfma_f32_16x16x32_bf16 v[36:39], v[80:83], a[96:99], 0
	s_waitcnt vmcnt(2)
	v_mfma_f32_16x16x32_bf16 v[36:39], v[80:83], a[100:103], v[36:39]
	s_waitcnt vmcnt(1)
	v_mfma_f32_16x16x32_bf16 v[36:39], v[80:83], a[104:107], v[36:39]
	s_waitcnt vmcnt(0)
	v_mfma_f32_16x16x32_bf16 v[36:39], v[80:83], a[108:111], v[36:39]
	v_cvt_pk_bf16_f32 v16, v16, v17
	v_cvt_pk_bf16_f32 v17, v18, v19
	buffer_store_dwordx2 v[16:17], v41, s[24:27], s50 offen offset:256
	v_cvt_pk_bf16_f32 v20, v20, v21
	v_cvt_pk_bf16_f32 v21, v22, v23
	buffer_store_dwordx2 v[20:21], v41, s[24:27], s50 offen offset:512
	s_nop 1
	v_cvt_pk_bf16_f32 v36, v36, v37
	v_cvt_pk_bf16_f32 v37, v38, v39
	buffer_store_dwordx2 v[36:37], v42, s[24:27], s50 offen offset:768
L_exit:
	s_endpgm
L_tramp1:
	s_call_b64 s[60:61], L_rare1
	s_branch L_back1
L_tramp2:
	s_call_b64 s[60:61], L_rare0
	s_branch L_back2
L_tramp3:
	s_call_b64 s[60:61], L_rare1
	s_branch L_back3
L_tramp4:
	s_call_b64 s[60:61], L_rare0
	s_branch L_back4
L_tramp5:
	s_call_b64 s[60:61], L_rare1
	s_branch L_back5
L_tramp26:
	s_call_b64 s[60:61], L_rare0
	s_branch L_back26
L_tramp27:
	s_call_b64 s[60:61], L_rare1
	s_branch L_back27
L_tramp28:
	s_call_b64 s[60:61], L_rare0
	s_branch L_back28
L_tramp29:
	s_call_b64 s[60:61], L_rare1
	s_branch L_back29
L_tramp30:
	s_call_b64 s[60:61], L_rare0
	s_branch L_back30
L_tramp31:
	s_call_b64 s[60:61], L_rare1
	s_branch L_back31
L_tr_dec:
	s_mov_b32 s3, 0x400000
L_tr_dec_loop:
	s_sub_u32 s3, s3, 1
	s_cmp_eq_u32 s3, 0
	s_cbranch_scc1 L_bk_dec
	buffer_load_dword v91, v89, s[8:11], 0 offen offset:0 sc1
	s_waitcnt vmcnt(0)
	v_readfirstlane_b32 s98, v91
	s_nop 3
	s_cmp_ge_u32 s98, 1
	s_cbranch_scc0 L_tr_dec_loop
	s_branch L_bk_dec
L_tr_poll0:
	s_mov_b32 s3, 0x400000
L_tr_poll0_loop:
	s_sub_u32 s3, s3, 1
	s_cmp_eq_u32 s3, 0
	s_cbranch_scc1 L_bk_poll0
	buffer_load_dword v91, v89, s[4:7], 0 offen offset:0 sc1
	s_waitcnt vmcnt(0)
	v_readfirstlane_b32 s98, v91
	s_nop 3
	s_cmp_ge_u32 s98, 16
	s_cbranch_scc0 L_tr_poll0_loop
	s_branch L_bk_poll0
L_tr_poll2:
	s_mov_b32 s3, 0x400000
L_tr_poll2_loop:
	s_sub_u32 s3, s3, 1
	s_cmp_eq_u32 s3, 0
	s_cbranch_scc1 L_bk_poll2
	buffer_load_dword v91, v89, s[4:7], 0 offen offset:256 sc1
	s_waitcnt vmcnt(0)
	v_readfirstlane_b32 s98, v91
	s_nop 3
	s_cmp_ge_u32 s98, 16
	s_cbranch_scc0 L_tr_poll2_loop
	s_branch L_bk_poll2
L_rare0:
	s_nop 15
	v_max3_f32 v6, v96, v97, v98
	v_max3_f32 v7, v104, v105, v106
	v_max3_f32 v6, v6, v99, v100
	v_max3_f32 v7, v7, v107, v108
	v_max3_f32 v6, v6, v101, v102
	v_max3_f32 v7, v7, v109, v110
	v_max_f32 v6, v6, v103
	v_max_f32 v7, v7, v111
	v_mov_b32 v10, v6
	v_mov_b32 v11, v7
	s_nop 0
	v_permlane16_swap_b32 v6, v10
	v_permlane16_swap_b32 v7, v11
	v_max_f32 v6, v6, v10
	v_max_f32 v7, v7, v11
	v_mov_b32 v10, v6
	v_mov_b32 v11, v7
	s_nop 0
	v_permlane32_swap_b32 v6, v10
	v_permlane32_swap_b32 v7, v11
	v_max_f32 v6, v6, v10
	v_max_f32 v7, v7, v11
	v_max_f32 v6, 0, v6
	v_max_f32 v7, 0, v7
	v_exp_f32 v8, -v6
	v_exp_f32 v9, -v7
	v_sub_f32 v80, v80, v6
	v_sub_f32 v81, v81, v6
	v_sub_f32 v82, v82, v6
	v_sub_f32 v83, v83, v6
	v_sub_f32 v84, v84, v7
	v_sub_f32 v85, v85, v7
	v_sub_f32 v86, v86, v7
	v_sub_f32 v87, v87, v7
	v_sub_f32 v112, v112, v6
	v_sub_f32 v113, v113, v6
	v_sub_f32 v114, v114, v6
	v_sub_f32 v115, v115, v6
	v_sub_f32 v116, v116, v6
	v_sub_f32 v117, v117, v6
	v_sub_f32 v118, v118, v6
	v_sub_f32 v119, v119, v6
	v_sub_f32 v120, v120, v7
	v_sub_f32 v121, v121, v7
	v_sub_f32 v122, v122, v7
	v_sub_f32 v123, v123, v7
	v_sub_f32 v124, v124, v7
	v_sub_f32 v125, v125, v7
	v_sub_f32 v126, v126, v7
	v_sub_f32 v127, v127, v7
	v_sub_f32 v96, v96, v6
	v_sub_f32 v97, v97, v6
	v_sub_f32 v98, v98, v6
	v_sub_f32 v99, v99, v6
	v_sub_f32 v100, v100, v6
	v_sub_f32 v101, v101, v6
	v_sub_f32 v102, v102, v6
	v_sub_f32 v103, v103, v6
	v_sub_f32 v104, v104, v7
	v_sub_f32 v105, v105, v7
	v_sub_f32 v106, v106, v7
	v_sub_f32 v107, v107, v7
	v_sub_f32 v108, v108, v7
	v_sub_f32 v109, v109, v7
	v_sub_f32 v110, v110, v7
	v_sub_f32 v111, v111, v7
	v_exp_f32 v48, v96
	v_exp_f32 v49, v97
	v_exp_f32 v50, v98
	v_exp_f32 v51, v99
	v_exp_f32 v52, v100
	v_exp_f32 v53, v101
	v_exp_f32 v54, v102
	v_exp_f32 v55, v103
	v_exp_f32 v56, v104
	v_exp_f32 v57, v105
	v_exp_f32 v58, v106
	v_exp_f32 v59, v107
	v_exp_f32 v60, v108
	v_exp_f32 v61, v109
	v_exp_f32 v62, v110
	v_exp_f32 v63, v111
	v_mul_f32 v2, v2, v8
	v_mul_f32 v3, v3, v9
	v_mul_f32 v128, v128, v8
	v_mul_f32 v129, v129, v8
	v_mul_f32 v130, v130, v8
	v_mul_f32 v131, v131, v8
	v_mul_f32 v132, v132, v8
	v_mul_f32 v133, v133, v8
	v_mul_f32 v134, v134, v8
	v_mul_f32 v135, v135, v8
	v_mul_f32 v136, v136, v9
	v_mul_f32 v137, v137, v9
	v_mul_f32 v138, v138, v9
	v_mul_f32 v139, v139, v9
	v_mul_f32 v140, v140, v9
	v_mul_f32 v141, v141, v9
	v_mul_f32 v142, v142, v9
	v_mul_f32 v143, v143, v9
	v_mul_f32 v144, v144, v8
	v_mul_f32 v145, v145, v8
	v_mul_f32 v146, v146, v8
	v_mul_f32 v147, v147, v8
	v_mul_f32 v148, v148, v8
	v_mul_f32 v149, v149, v8
	v_mul_f32 v150, v150, v8
	v_mul_f32 v151, v151, v8
	v_mul_f32 v152, v152, v9
	v_mul_f32 v153, v153, v9
	v_mul_f32 v154, v154, v9
	v_mul_f32 v155, v155, v9
	v_mul_f32 v156, v156, v9
	v_mul_f32 v157, v157, v9
	v_mul_f32 v158, v158, v9
	v_mul_f32 v159, v159, v9
	v_mul_f32 v160, v160, v8
	v_mul_f32 v161, v161, v8
	v_mul_f32 v162, v162, v8
	v_mul_f32 v163, v163, v8
	v_mul_f32 v164, v164, v8
	v_mul_f32 v165, v165, v8
	v_mul_f32 v166, v166, v8
	v_mul_f32 v167, v167, v8
	v_mul_f32 v168, v168, v9
	v_mul_f32 v169, v169, v9
	v_mul_f32 v170, v170, v9
	v_mul_f32 v171, v171, v9
	v_mul_f32 v172, v172, v9
	v_mul_f32 v173, v173, v9
	v_mul_f32 v174, v174, v9
	v_mul_f32 v175, v175, v9
	v_mul_f32 v176, v176, v8
	v_mul_f32 v177, v177, v8
	v_mul_f32 v178, v178, v8
	v_mul_f32 v179, v179, v8
	v_mul_f32 v180, v180, v8
	v_mul_f32 v181, v181, v8
	v_mul_f32 v182, v182, v8
	v_mul_f32 v183, v183, v8
	v_mul_f32 v184, v184, v9
	v_mul_f32 v185, v185, v9
	v_mul_f32 v186, v186, v9
	v_mul_f32 v187, v187, v9
	v_mul_f32 v188, v188, v9
	v_mul_f32 v189, v189, v9
	v_mul_f32 v190, v190, v9
	v_mul_f32 v191, v191, v9
	v_mul_f32 v192, v192, v8
	v_mul_f32 v193, v193, v8
	v_mul_f32 v194, v194, v8
	v_mul_f32 v195, v195, v8
	v_mul_f32 v196, v196, v8
	v_mul_f32 v197, v197, v8
	v_mul_f32 v198, v198, v8
	v_mul_f32 v199, v199, v8
	v_mul_f32 v200, v200, v9
	v_mul_f32 v201, v201, v9
	v_mul_f32 v202, v202, v9
	v_mul_f32 v203, v203, v9
	v_mul_f32 v204, v204, v9
	v_mul_f32 v205, v205, v9
	v_mul_f32 v206, v206, v9
	v_mul_f32 v207, v207, v9
	v_mul_f32 v208, v208, v8
	v_mul_f32 v209, v209, v8
	v_mul_f32 v210, v210, v8
	v_mul_f32 v211, v211, v8
	v_mul_f32 v212, v212, v8
	v_mul_f32 v213, v213, v8
	v_mul_f32 v214, v214, v8
	v_mul_f32 v215, v215, v8
	v_mul_f32 v216, v216, v9
	v_mul_f32 v217, v217, v9
	v_mul_f32 v218, v218, v9
	v_mul_f32 v219, v219, v9
	v_mul_f32 v220, v220, v9
	v_mul_f32 v221, v221, v9
	v_mul_f32 v222, v222, v9
	v_mul_f32 v223, v223, v9
	v_mul_f32 v224, v224, v8
	v_mul_f32 v225, v225, v8
	v_mul_f32 v226, v226, v8
	v_mul_f32 v227, v227, v8
	v_mul_f32 v228, v228, v8
	v_mul_f32 v229, v229, v8
	v_mul_f32 v230, v230, v8
	v_mul_f32 v231, v231, v8
	v_mul_f32 v232, v232, v9
	v_mul_f32 v233, v233, v9
	v_mul_f32 v234, v234, v9
	v_mul_f32 v235, v235, v9
	v_mul_f32 v236, v236, v9
	v_mul_f32 v237, v237, v9
	v_mul_f32 v238, v238, v9
	v_mul_f32 v239, v239, v9
	v_mul_f32 v240, v240, v8
	v_mul_f32 v241, v241, v8
	v_mul_f32 v242, v242, v8
	v_mul_f32 v243, v243, v8
	v_mul_f32 v244, v244, v8
	v_mul_f32 v245, v245, v8
	v_mul_f32 v246, v246, v8
	v_mul_f32 v247, v247, v8
	v_mul_f32 v248, v248, v9
	v_mul_f32 v249, v249, v9
	v_mul_f32 v250, v250, v9
	v_mul_f32 v251, v251, v9
	v_mul_f32 v252, v252, v9
	v_mul_f32 v253, v253, v9
	v_mul_f32 v254, v254, v9
	v_mul_f32 v255, v255, v9
	v_add_f32 v4, v48, v49
	v_add_f32 v4, v4, v50
	v_add_f32 v4, v4, v51
	v_add_f32 v4, v4, v52
	v_add_f32 v4, v4, v53
	v_add_f32 v4, v4, v54
	v_add_f32 v4, v4, v55
	v_add_f32 v5, v56, v57
	v_add_f32 v5, v5, v58
	v_add_f32 v5, v5, v59
	v_add_f32 v5, v5, v60
	v_add_f32 v5, v5, v61
	v_add_f32 v5, v5, v62
	v_add_f32 v5, v5, v63
	v_cvt_pk_bf16_f32 v64, v48, v49
	v_cvt_pk_bf16_f32 v65, v50, v51
	v_cvt_pk_bf16_f32 v66, v52, v53
	v_cvt_pk_bf16_f32 v67, v54, v55
	v_cvt_pk_bf16_f32 v68, v56, v57
	v_cvt_pk_bf16_f32 v69, v58, v59
	v_cvt_pk_bf16_f32 v70, v60, v61
	v_cvt_pk_bf16_f32 v71, v62, v63
	s_nop 3
	s_setpc_b64 s[60:61]
L_rare1:
	s_nop 15
	v_max3_f32 v6, v112, v113, v114
	v_max3_f32 v7, v120, v121, v122
	v_max3_f32 v6, v6, v115, v116
	v_max3_f32 v7, v7, v123, v124
	v_max3_f32 v6, v6, v117, v118
	v_max3_f32 v7, v7, v125, v126
	v_max_f32 v6, v6, v119
	v_max_f32 v7, v7, v127
	v_mov_b32 v10, v6
	v_mov_b32 v11, v7
	s_nop 0
	v_permlane16_swap_b32 v6, v10
	v_permlane16_swap_b32 v7, v11
	v_max_f32 v6, v6, v10
	v_max_f32 v7, v7, v11
	v_mov_b32 v10, v6
	v_mov_b32 v11, v7
	s_nop 0
	v_permlane32_swap_b32 v6, v10
	v_permlane32_swap_b32 v7, v11
	v_max_f32 v6, v6, v10
	v_max_f32 v7, v7, v11
	v_max_f32 v6, 0, v6
	v_max_f32 v7, 0, v7
	v_exp_f32 v8, -v6
	v_exp_f32 v9, -v7
	v_sub_f32 v80, v80, v6
	v_sub_f32 v81, v81, v6
	v_sub_f32 v82, v82, v6
	v_sub_f32 v83, v83, v6
	v_sub_f32 v84, v84, v7
	v_sub_f32 v85, v85, v7
	v_sub_f32 v86, v86, v7
	v_sub_f32 v87, v87, v7
	v_sub_f32 v96, v96, v6
	v_sub_f32 v97, v97, v6
	v_sub_f32 v98, v98, v6
	v_sub_f32 v99, v99, v6
	v_sub_f32 v100, v100, v6
	v_sub_f32 v101, v101, v6
	v_sub_f32 v102, v102, v6
	v_sub_f32 v103, v103, v6
	v_sub_f32 v104, v104, v7
	v_sub_f32 v105, v105, v7
	v_sub_f32 v106, v106, v7
	v_sub_f32 v107, v107, v7
	v_sub_f32 v108, v108, v7
	v_sub_f32 v109, v109, v7
	v_sub_f32 v110, v110, v7
	v_sub_f32 v111, v111, v7
	v_sub_f32 v112, v112, v6
	v_sub_f32 v113, v113, v6
	v_sub_f32 v114, v114, v6
	v_sub_f32 v115, v115, v6
	v_sub_f32 v116, v116, v6
	v_sub_f32 v117, v117, v6
	v_sub_f32 v118, v118, v6
	v_sub_f32 v119, v119, v6
	v_sub_f32 v120, v120, v7
	v_sub_f32 v121, v121, v7
	v_sub_f32 v122, v122, v7
	v_sub_f32 v123, v123, v7
	v_sub_f32 v124, v124, v7
	v_sub_f32 v125, v125, v7
	v_sub_f32 v126, v126, v7
	v_sub_f32 v127, v127, v7
	v_exp_f32 v48, v112
	v_exp_f32 v49, v113
	v_exp_f32 v50, v114
	v_exp_f32 v51, v115
	v_exp_f32 v52, v116
	v_exp_f32 v53, v117
	v_exp_f32 v54, v118
	v_exp_f32 v55, v119
	v_exp_f32 v56, v120
	v_exp_f32 v57, v121
	v_exp_f32 v58, v122
	v_exp_f32 v59, v123
	v_exp_f32 v60, v124
	v_exp_f32 v61, v125
	v_exp_f32 v62, v126
	v_exp_f32 v63, v127
	v_mul_f32 v2, v2, v8
	v_mul_f32 v3, v3, v9
	v_mul_f32 v128, v128, v8
	v_mul_f32 v129, v129, v8
	v_mul_f32 v130, v130, v8
	v_mul_f32 v131, v131, v8
	v_mul_f32 v132, v132, v8
	v_mul_f32 v133, v133, v8
	v_mul_f32 v134, v134, v8
	v_mul_f32 v135, v135, v8
	v_mul_f32 v136, v136, v9
	v_mul_f32 v137, v137, v9
	v_mul_f32 v138, v138, v9
	v_mul_f32 v139, v139, v9
	v_mul_f32 v140, v140, v9
	v_mul_f32 v141, v141, v9
	v_mul_f32 v142, v142, v9
	v_mul_f32 v143, v143, v9
	v_mul_f32 v144, v144, v8
	v_mul_f32 v145, v145, v8
	v_mul_f32 v146, v146, v8
	v_mul_f32 v147, v147, v8
	v_mul_f32 v148, v148, v8
	v_mul_f32 v149, v149, v8
	v_mul_f32 v150, v150, v8
	v_mul_f32 v151, v151, v8
	v_mul_f32 v152, v152, v9
	v_mul_f32 v153, v153, v9
	v_mul_f32 v154, v154, v9
	v_mul_f32 v155, v155, v9
	v_mul_f32 v156, v156, v9
	v_mul_f32 v157, v157, v9
	v_mul_f32 v158, v158, v9
	v_mul_f32 v159, v159, v9
	v_mul_f32 v160, v160, v8
	v_mul_f32 v161, v161, v8
	v_mul_f32 v162, v162, v8
	v_mul_f32 v163, v163, v8
	v_mul_f32 v164, v164, v8
	v_mul_f32 v165, v165, v8
	v_mul_f32 v166, v166, v8
	v_mul_f32 v167, v167, v8
	v_mul_f32 v168, v168, v9
	v_mul_f32 v169, v169, v9
	v_mul_f32 v170, v170, v9
	v_mul_f32 v171, v171, v9
	v_mul_f32 v172, v172, v9
	v_mul_f32 v173, v173, v9
	v_mul_f32 v174, v174, v9
	v_mul_f32 v175, v175, v9
	v_mul_f32 v176, v176, v8
	v_mul_f32 v177, v177, v8
	v_mul_f32 v178, v178, v8
	v_mul_f32 v179, v179, v8
	v_mul_f32 v180, v180, v8
	v_mul_f32 v181, v181, v8
	v_mul_f32 v182, v182, v8
	v_mul_f32 v183, v183, v8
	v_mul_f32 v184, v184, v9
	v_mul_f32 v185, v185, v9
	v_mul_f32 v186, v186, v9
	v_mul_f32 v187, v187, v9
	v_mul_f32 v188, v188, v9
	v_mul_f32 v189, v189, v9
	v_mul_f32 v190, v190, v9
	v_mul_f32 v191, v191, v9
	v_mul_f32 v192, v192, v8
	v_mul_f32 v193, v193, v8
	v_mul_f32 v194, v194, v8
	v_mul_f32 v195, v195, v8
	v_mul_f32 v196, v196, v8
	v_mul_f32 v197, v197, v8
	v_mul_f32 v198, v198, v8
	v_mul_f32 v199, v199, v8
	v_mul_f32 v200, v200, v9
	v_mul_f32 v201, v201, v9
	v_mul_f32 v202, v202, v9
	v_mul_f32 v203, v203, v9
	v_mul_f32 v204, v204, v9
	v_mul_f32 v205, v205, v9
	v_mul_f32 v206, v206, v9
	v_mul_f32 v207, v207, v9
	v_mul_f32 v208, v208, v8
	v_mul_f32 v209, v209, v8
	v_mul_f32 v210, v210, v8
	v_mul_f32 v211, v211, v8
	v_mul_f32 v212, v212, v8
	v_mul_f32 v213, v213, v8
	v_mul_f32 v214, v214, v8
	v_mul_f32 v215, v215, v8
	v_mul_f32 v216, v216, v9
	v_mul_f32 v217, v217, v9
	v_mul_f32 v218, v218, v9
	v_mul_f32 v219, v219, v9
	v_mul_f32 v220, v220, v9
	v_mul_f32 v221, v221, v9
	v_mul_f32 v222, v222, v9
	v_mul_f32 v223, v223, v9
	v_mul_f32 v224, v224, v8
	v_mul_f32 v225, v225, v8
	v_mul_f32 v226, v226, v8
	v_mul_f32 v227, v227, v8
	v_mul_f32 v228, v228, v8
	v_mul_f32 v229, v229, v8
	v_mul_f32 v230, v230, v8
	v_mul_f32 v231, v231, v8
	v_mul_f32 v232, v232, v9
	v_mul_f32 v233, v233, v9
	v_mul_f32 v234, v234, v9
	v_mul_f32 v235, v235, v9
	v_mul_f32 v236, v236, v9
	v_mul_f32 v237, v237, v9
	v_mul_f32 v238, v238, v9
	v_mul_f32 v239, v239, v9
	v_mul_f32 v240, v240, v8
	v_mul_f32 v241, v241, v8
	v_mul_f32 v242, v242, v8
	v_mul_f32 v243, v243, v8
	v_mul_f32 v244, v244, v8
	v_mul_f32 v245, v245, v8
	v_mul_f32 v246, v246, v8
	v_mul_f32 v247, v247, v8
	v_mul_f32 v248, v248, v9
	v_mul_f32 v249, v249, v9
	v_mul_f32 v250, v250, v9
	v_mul_f32 v251, v251, v9
	v_mul_f32 v252, v252, v9
	v_mul_f32 v253, v253, v9
	v_mul_f32 v254, v254, v9
	v_mul_f32 v255, v255, v9
	v_add_f32 v4, v48, v49
	v_add_f32 v4, v4, v50
	v_add_f32 v4, v4, v51
	v_add_f32 v4, v4, v52
	v_add_f32 v4, v4, v53
	v_add_f32 v4, v4, v54
	v_add_f32 v4, v4, v55
	v_add_f32 v5, v56, v57
	v_add_f32 v5, v5, v58
	v_add_f32 v5, v5, v59
	v_add_f32 v5, v5, v60
	v_add_f32 v5, v5, v61
	v_add_f32 v5, v5, v62
	v_add_f32 v5, v5, v63
	v_cvt_pk_bf16_f32 v72, v48, v49
	v_cvt_pk_bf16_f32 v73, v50, v51
	v_cvt_pk_bf16_f32 v74, v52, v53
	v_cvt_pk_bf16_f32 v75, v54, v55
	v_cvt_pk_bf16_f32 v76, v56, v57
	v_cvt_pk_bf16_f32 v77, v58, v59
	v_cvt_pk_bf16_f32 v78, v60, v61
	v_cvt_pk_bf16_f32 v79, v62, v63
	s_nop 3
	s_setpc_b64 s[60:61]
L_code_end:
	s_endpgm
.section .rodata,"a"
.p2align 6
.amdhsa_kernel standalone__mha_block_cached__near_ridge_kernel
  .amdhsa_next_free_vgpr 512
  .amdhsa_next_free_sgpr 102
  .amdhsa_accum_offset 256
  .amdhsa_group_segment_fixed_size 0
  .amdhsa_kernarg_size 64
  .amdhsa_user_sgpr_count 2
  .amdhsa_user_sgpr_kernarg_segment_ptr 1
  .amdhsa_system_sgpr_workgroup_id_x 1
.end_amdhsa_kernel
```
